```python
import torch

def _softmax(x, axis=-1):
    return torch.softmax(x, dim=axis)

def _gelu(x):
    return torch.nn.functional.gelu(x, approximate='tanh')

def _silu(x):
    return torch.nn.functional.silu(x)

def _sigmoid(x):
    return torch.sigmoid(x)

def _layernorm(x, axis=-1, eps=1e-05):
    m = x.mean(dim=axis, keepdim=True)
    v = x.var(dim=axis, keepdim=True, unbiased=False)
    return (x - m) / torch.sqrt(v + eps)

def _scatter_add(tgt, idx, src, axis=0):
    return tgt.clone().index_add_(axis, idx, src)

def _segment_sum(src, seg, n):
    out = torch.zeros((n,) + src.shape[1:], dtype=src.dtype)
    return out.index_add_(0, seg, src)

def _pad(x, pw):
    flat = tuple((v for pair in reversed(pw) for v in pair))
    return torch.nn.functional.pad(x, flat)
kernel_name = 'concat_heads__spectral_gfnet__memory_aug_recurrent_mem_tr__prompt'

def setup_inputs():

    _w = lambda a: (lambda t: t.to(torch.bfloat16) if t.is_floating_point() else t)(torch.as_tensor(a))

    def _A_setup():
        B, S, D = (1, 2048, 448)
        Df = D // 2 + 1
        return {'x': _w((lambda *s: torch.randn(*s, dtype=torch.bfloat16) * 0.05)(B, S, D)), 'w_r': _w((lambda *s: torch.randn(*s, dtype=torch.bfloat16) * 3.2)(S, Df) * 0.02), 'w_i': _w((lambda *s: torch.randn(*s, dtype=torch.bfloat16) * 3.2)(S, Df) * 0.02)}
    _A_in = _A_setup()

    def _B_setup():
        B, S, Dm = (1, 2048, 448)
        H, Dh = (16, 256)
        M, seg = (8, 32)
        seg = min(seg, S)
        S = S // seg * seg
        return {'x': _w((lambda *s: torch.randn(*s, dtype=torch.bfloat16) * 0.05)(B, S, Dm)), 'mem0': _w((lambda *s: torch.randn(*s, dtype=torch.bfloat16) * 0.4)(B, M, Dm)), 'Wq': _w((lambda *s: torch.randn(*s, dtype=torch.bfloat16) * 6.4)(Dm, H, Dh) * Dm ** (-0.5)), 'Wk': _w((lambda *s: torch.randn(*s, dtype=torch.bfloat16) * 6.4)(Dm, H, Dh) * Dm ** (-0.5)), 'Wv': _w((lambda *s: torch.randn(*s, dtype=torch.bfloat16) * 0.4)(Dm, H, Dh) * Dm ** (-0.5)), 'Wo': _w((lambda *s: torch.randn(*s, dtype=torch.bfloat16) * 0.4)(H, Dh, Dm) * (H * Dh) ** (-0.5)), 'seg_len': seg}
    _B_in = _B_setup()
    return {'A_x': _A_in['x'], 'A_w_r': _A_in['w_r'], 'A_w_i': _A_in['w_i'], 'B_x': _B_in['x'], 'B_mem0': _B_in['mem0'], 'B_Wq': _B_in['Wq'], 'B_Wk': _B_in['Wk'], 'B_Wv': _B_in['Wv'], 'B_Wo': _B_in['Wo'], 'B_seg_len': _B_in['seg_len']}

def reference(A_x, A_w_r, A_w_i, B_x, B_mem0, B_Wq, B_Wk, B_Wv, B_Wo, B_seg_len):

    def _A_ref(x, w_r, w_i):
        B, S, D = x.shape
        X = (lambda x, axes=(-2, -1): torch.fft.rfft2(x.float(), dim=axes))(x, axes=(-2, -1))
        W = w_r + 1j * w_i
        X = X * W
        y = (lambda x, s, axes=(-2, -1): torch.fft.irfft2(x, s=s, dim=axes).to(torch.bfloat16))(X, (S, D), axes=(-2, -1))
        return y

    def _B_ref(x, mem0, Wq, Wk, Wv, Wo, seg_len):
        B, S, Dm = x.shape
        H, Dh = (Wq.shape[1], Wq.shape[2])
        M = mem0.shape[1]
        scale = Dh ** (-0.5)
        n_seg = S // seg_len
        L = M + seg_len
        idx = torch.arange(L)
        mask = (idx[:, None] < M) | (idx[:, None] >= idx[None, :])
        mem = mem0
        outs = []
        for s in range(n_seg):
            xs = x[:, s * seg_len:(s + 1) * seg_len, :].clone()
            h = torch.concatenate([mem, xs], axis=1)
            q = torch.einsum('btd,dhe->bhte', h, Wq)
            k = torch.einsum('btd,dhe->bhte', h, Wk)
            v = torch.einsum('btd,dhe->bhte', h, Wv)
            scores = torch.einsum('bhqe,bhke->bhqk', q, k) * scale
            scores = torch.where(mask[None, None], scores, -1000000000.0)
            p = _softmax(scores, axis=-1)
            o = torch.einsum('bhqk,bhke->bhqe', p, v)
            o = torch.einsum('bhte,hed->btd', o, Wo)
            mem = o[:, :M, :].clone()
            outs.append(o[:, M:, :])
        return torch.concatenate(outs, axis=1)
    a = _A_ref(A_x, A_w_r, A_w_i)
    b = _B_ref(B_x, B_mem0, B_Wq, B_Wk, B_Wv, B_Wo, B_seg_len)
    return torch.concatenate([a, b], axis=-1)
```

```asm
; @launch kernel=k1_kernel grid=(256,1,1) block=(448,1,1) lds=131072
; @launch kernel=k2_kernel grid=(256,1,1) block=(256,1,1) lds=163840
.amdgcn_target "amdgcn-amd-amdhsa--gfx950"
.text
.globl k1_kernel
.p2align 8
.type k1_kernel,@function
k1_kernel:
 s_cmp_ge_u32 s2, 256
 s_cbranch_scc1 K1_END
 s_load_dwordx2 s[4:5], s[0:1], 96
 s_load_dwordx4 s[8:11], s[0:1], 40
 s_load_dwordx4 s[12:15], s[0:1], 56
 s_load_dwordx2 s[6:7], s[0:1], 32
 v_lshrrev_b32 v1, 6, v0
 v_and_b32 v2, 63, v0
 v_readfirstlane_b32 s16, v1
 s_cmp_ge_u32 s2, 224
 s_cbranch_scc1 K1_AUX
 s_and_b32 s17, s2, 7
 s_lshr_b32 s18, s2, 3
 s_and_b32 s19, s18, 1
 s_lshl_b32 s19, s19, 3
 s_add_u32 s17, s17, s19
 s_lshr_b32 s18, s18, 1
 v_and_b32 v3, 31, v2
 v_lshrrev_b32 v4, 5, v2
 s_mov_b32 s24, 0x05040100
 s_mov_b32 s25, 0x07060302
 s_waitcnt lgkmcnt(0)
 s_cmp_ge_u32 s18, 7
 s_cbranch_scc1 K1_MATB
 s_lshl_b32 s20, s17, 9
 s_lshl_b32 s21, s18, 19
 s_add_u32 s21, s21, s20
 s_add_u32 s8, s8, s21
 s_addc_u32 s9, s9, 0
 v_lshrrev_b32 v12, 3, v2
 v_lshlrev_b32 v12, 13, v12
 v_and_b32 v13, 7, v2
 v_lshrrev_b32 v14, 4, v2
 v_xor_b32 v13, v13, v14
 v_lshl_add_u32 v5, v13, 4, v12
 v_xor_b32 v6, 64, v5
 s_lshl_b32 s26, s16, 16
 s_and_b32 s27, s16, 1
 s_lshl_b32 s27, s27, 6
 v_xor_b32 v7, s27, v5
 v_add_u32 v7, s26, v7
 v_add_u32 v8, 458752, v6
 s_lshl_b32 s28, s16, 10
 s_lshl_b32 s29, s16, 13
 s_add_u32 s29, s29, 8192
 s_lshl_b32 s21, s16, 19
 s_add_u32 s20, s20, s21
 s_add_u32 s10, s10, s20
 s_addc_u32 s11, s11, 0
 s_lshl_b32 s21, s16, 6
 v_add_u32 v9, s21, v3
 s_add_u32 m0, s28, 0
 s_nop 0
 global_load_lds_dwordx4 v7, s[8:9]
 s_mov_b32 m0, 7168
 s_nop 0
 global_load_lds_dwordx4 v8, s[8:9]
 s_add_u32 s8, s8, 128
 s_addc_u32 s9, s9, 0
 s_add_u32 m0, s29, 0
 s_add_u32 s30, s10, 0
 s_addc_u32 s31, s11, 0
 global_load_lds_dwordx4 v5, s[30:31]
 s_add_u32 m0, s29, 1024
 s_add_u32 s30, s10, 65536
 s_addc_u32 s31, s11, 0
 global_load_lds_dwordx4 v6, s[30:31]
 s_add_u32 m0, s29, 2048
 s_add_u32 s30, s10, 131072
 s_addc_u32 s31, s11, 0
 global_load_lds_dwordx4 v5, s[30:31]
 s_add_u32 m0, s29, 3072
 s_add_u32 s30, s10, 196608
 s_addc_u32 s31, s11, 0
 global_load_lds_dwordx4 v6, s[30:31]
 s_add_u32 m0, s29, 4096
 s_add_u32 s30, s10, 262144
 s_addc_u32 s31, s11, 0
 global_load_lds_dwordx4 v5, s[30:31]
 s_add_u32 m0, s29, 5120
 s_add_u32 s30, s10, 327680
 s_addc_u32 s31, s11, 0
 global_load_lds_dwordx4 v6, s[30:31]
 s_add_u32 m0, s29, 6144
 s_add_u32 s30, s10, 393216
 s_addc_u32 s31, s11, 0
 global_load_lds_dwordx4 v5, s[30:31]
 s_add_u32 m0, s29, 7168
 s_add_u32 s30, s10, 458752
 s_addc_u32 s31, s11, 0
 global_load_lds_dwordx4 v6, s[30:31]
 s_add_u32 s10, s10, 128
 s_addc_u32 s11, s11, 0
 s_add_u32 m0, s28, 65536
 s_nop 0
 global_load_lds_dwordx4 v7, s[8:9]
 s_mov_b32 m0, 72704
 s_nop 0
 global_load_lds_dwordx4 v8, s[8:9]
 s_add_u32 s8, s8, 128
 s_addc_u32 s9, s9, 0
 s_add_u32 m0, s29, 65536
 s_add_u32 s30, s10, 0
 s_addc_u32 s31, s11, 0
 global_load_lds_dwordx4 v5, s[30:31]
 s_add_u32 m0, s29, 66560
 s_add_u32 s30, s10, 65536
 s_addc_u32 s31, s11, 0
 global_load_lds_dwordx4 v6, s[30:31]
 s_add_u32 m0, s29, 67584
 s_add_u32 s30, s10, 131072
 s_addc_u32 s31, s11, 0
 global_load_lds_dwordx4 v5, s[30:31]
 s_add_u32 m0, s29, 68608
 s_add_u32 s30, s10, 196608
 s_addc_u32 s31, s11, 0
 global_load_lds_dwordx4 v6, s[30:31]
 s_add_u32 m0, s29, 69632
 s_add_u32 s30, s10, 262144
 s_addc_u32 s31, s11, 0
 global_load_lds_dwordx4 v5, s[30:31]
 s_add_u32 m0, s29, 70656
 s_add_u32 s30, s10, 327680
 s_addc_u32 s31, s11, 0
 global_load_lds_dwordx4 v6, s[30:31]
 s_add_u32 m0, s29, 71680
 s_add_u32 s30, s10, 393216
 s_addc_u32 s31, s11, 0
 global_load_lds_dwordx4 v5, s[30:31]
 s_add_u32 m0, s29, 72704
 s_add_u32 s30, s10, 458752
 s_addc_u32 s31, s11, 0
 global_load_lds_dwordx4 v6, s[30:31]
 s_add_u32 s10, s10, 128
 s_addc_u32 s11, s11, 0
 v_lshlrev_b32 v12, 13, v2
 global_load_dword v188, v12, s[8:9]
 global_load_dword v189, v12, s[8:9] offset:128
 v_lshlrev_b32 v12, 13, v2
 global_load_dword v188, v12, s[10:11]
 global_load_dword v189, v12, s[10:11] offset:128
 v_bfe_u32 v12, v3, 1, 3
 v_xor_b32 v12, v12, v4
 v_lshlrev_b32 v12, 4, v12
 v_lshl_add_u32 v176, v3, 7, v12
 v_xor_b32 v177, 32, v176
 v_xor_b32 v178, 64, v176
 v_xor_b32 v179, 96, v176
 v_mov_b32 v16, 0
 v_mov_b32 v17, 0
 v_mov_b32 v18, 0
 v_mov_b32 v19, 0
 v_mov_b32 v20, 0
 v_mov_b32 v21, 0
 v_mov_b32 v22, 0
 v_mov_b32 v23, 0
 v_mov_b32 v24, 0
 v_mov_b32 v25, 0
 v_mov_b32 v26, 0
 v_mov_b32 v27, 0
 v_mov_b32 v28, 0
 v_mov_b32 v29, 0
 v_mov_b32 v30, 0
 v_mov_b32 v31, 0
 v_mov_b32 v32, 0
 v_mov_b32 v33, 0
 v_mov_b32 v34, 0
 v_mov_b32 v35, 0
 v_mov_b32 v36, 0
 v_mov_b32 v37, 0
 v_mov_b32 v38, 0
 v_mov_b32 v39, 0
 v_mov_b32 v40, 0
 v_mov_b32 v41, 0
 v_mov_b32 v42, 0
 v_mov_b32 v43, 0
 v_mov_b32 v44, 0
 v_mov_b32 v45, 0
 v_mov_b32 v46, 0
 v_mov_b32 v47, 0
 v_mov_b32 v48, 0
 v_mov_b32 v49, 0
 v_mov_b32 v50, 0
 v_mov_b32 v51, 0
 v_mov_b32 v52, 0
 v_mov_b32 v53, 0
 v_mov_b32 v54, 0
 v_mov_b32 v55, 0
 v_mov_b32 v56, 0
 v_mov_b32 v57, 0
 v_mov_b32 v58, 0
 v_mov_b32 v59, 0
 v_mov_b32 v60, 0
 v_mov_b32 v61, 0
 v_mov_b32 v62, 0
 v_mov_b32 v63, 0
 v_mov_b32 v64, 0
 v_mov_b32 v65, 0
 v_mov_b32 v66, 0
 v_mov_b32 v67, 0
 v_mov_b32 v68, 0
 v_mov_b32 v69, 0
 v_mov_b32 v70, 0
 v_mov_b32 v71, 0
 v_mov_b32 v72, 0
 v_mov_b32 v73, 0
 v_mov_b32 v74, 0
 v_mov_b32 v75, 0
 v_mov_b32 v76, 0
 v_mov_b32 v77, 0
 v_mov_b32 v78, 0
 v_mov_b32 v79, 0
 v_add_u32 v180, s29, v176
 v_add_u32 v181, s29, v177
 v_add_u32 v182, s29, v178
 v_add_u32 v183, s29, v179
 s_mul_i32 s20, s17, 401408
 s_lshl_b32 s21, s18, 11
 s_add_u32 s20, s20, s21
 s_add_u32 s4, s4, s20
 s_addc_u32 s5, s5, 0
 s_movk_i32 s22, 14336
 v_add_u32 v12, 0, v9
 v_mov_b32 v13, 0
 v_cmp_le_u32 vcc, 112, v12
 s_nop 1
 v_addc_co_u32 v13, vcc, 0, v13, vcc
 v_cmp_le_u32 vcc, 224, v12
 s_nop 1
 v_addc_co_u32 v13, vcc, 0, v13, vcc
 v_cmp_le_u32 vcc, 336, v12
 s_nop 1
 v_addc_co_u32 v13, vcc, 0, v13, vcc
 v_mul_u32_u24 v14, 112, v13
 v_sub_u32 v12, v12, v14
 v_mul_u32_u24 v13, 7, v13
 v_lshrrev_b32 v14, 5, v12
 v_lshlrev_b32 v14, 1, v14
 v_bfe_u32 v15, v12, 2, 1
 v_add_u32 v14, v14, v15
 v_bfe_u32 v15, v12, 3, 2
 v_lshlrev_b32 v15, 2, v15
 v_and_b32 v1, 3, v12
 v_add_u32 v15, v15, v1
 v_subrev_u32 v1, 96, v12
 v_cmp_le_u32 vcc, 96, v12
 s_nop 1
 v_cndmask_b32 v14, v14, 6, vcc
 v_cndmask_b32 v15, v15, v1, vcc
 v_add_u32 v13, v13, v14
 v_mul_u32_u24 v13, s22, v13
 v_lshlrev_b32 v15, 4, v15
 v_lshlrev_b32 v14, 8, v4
 v_add3_u32 v10, v13, v14, v15
 v_add_u32 v12, 32, v9
 v_mov_b32 v13, 0
 v_cmp_le_u32 vcc, 112, v12
 s_nop 1
 v_addc_co_u32 v13, vcc, 0, v13, vcc
 v_cmp_le_u32 vcc, 224, v12
 s_nop 1
 v_addc_co_u32 v13, vcc, 0, v13, vcc
 v_cmp_le_u32 vcc, 336, v12
 s_nop 1
 v_addc_co_u32 v13, vcc, 0, v13, vcc
 v_mul_u32_u24 v14, 112, v13
 v_sub_u32 v12, v12, v14
 v_mul_u32_u24 v13, 7, v13
 v_lshrrev_b32 v14, 5, v12
 v_lshlrev_b32 v14, 1, v14
 v_bfe_u32 v15, v12, 2, 1
 v_add_u32 v14, v14, v15
 v_bfe_u32 v15, v12, 3, 2
 v_lshlrev_b32 v15, 2, v15
 v_and_b32 v1, 3, v12
 v_add_u32 v15, v15, v1
 v_subrev_u32 v1, 96, v12
 v_cmp_le_u32 vcc, 96, v12
 s_nop 1
 v_cndmask_b32 v14, v14, 6, vcc
 v_cndmask_b32 v15, v15, v1, vcc
 v_add_u32 v13, v13, v14
 v_mul_u32_u24 v13, s22, v13
 v_lshlrev_b32 v15, 4, v15
 v_lshlrev_b32 v14, 8, v4
 v_add3_u32 v11, v13, v14, v15
 s_waitcnt vmcnt(14)
 s_barrier
 ds_read_b128 v[80:83], v176 offset:0
 ds_read_b128 v[84:87], v176 offset:4096
 ds_read_b128 v[88:91], v180 offset:0
 ds_read_b128 v[92:95], v180 offset:4096
 ds_read_b128 v[96:99], v177 offset:0
 ds_read_b128 v[100:103], v177 offset:4096
 ds_read_b128 v[104:107], v181 offset:0
 ds_read_b128 v[108:111], v181 offset:4096
 s_waitcnt lgkmcnt(4)
 v_mfma_f32_32x32x16_bf16 v[16:31], v[80:83], v[88:91], v[16:31]
 v_mfma_f32_32x32x16_bf16 v[32:47], v[80:83], v[92:95], v[32:47]
 v_mfma_f32_32x32x16_bf16 v[48:63], v[84:87], v[88:91], v[48:63]
 v_mfma_f32_32x32x16_bf16 v[64:79], v[84:87], v[92:95], v[64:79]
 ds_read_b128 v[112:115], v178 offset:0
 ds_read_b128 v[116:119], v178 offset:4096
 ds_read_b128 v[120:123], v182 offset:0
 ds_read_b128 v[124:127], v182 offset:4096
 s_waitcnt lgkmcnt(4)
 v_mfma_f32_32x32x16_bf16 v[16:31], v[96:99], v[104:107], v[16:31]
 v_mfma_f32_32x32x16_bf16 v[32:47], v[96:99], v[108:111], v[32:47]
 v_mfma_f32_32x32x16_bf16 v[48:63], v[100:103], v[104:107], v[48:63]
 v_mfma_f32_32x32x16_bf16 v[64:79], v[100:103], v[108:111], v[64:79]
 ds_read_b128 v[128:131], v179 offset:0
 ds_read_b128 v[132:135], v179 offset:4096
 ds_read_b128 v[136:139], v183 offset:0
 ds_read_b128 v[140:143], v183 offset:4096
 s_waitcnt lgkmcnt(4)
 v_mfma_f32_32x32x16_bf16 v[16:31], v[112:115], v[120:123], v[16:31]
 v_mfma_f32_32x32x16_bf16 v[32:47], v[112:115], v[124:127], v[32:47]
 v_mfma_f32_32x32x16_bf16 v[48:63], v[116:119], v[120:123], v[48:63]
 v_mfma_f32_32x32x16_bf16 v[64:79], v[116:119], v[124:127], v[64:79]
 s_waitcnt lgkmcnt(0)
 v_mfma_f32_32x32x16_bf16 v[16:31], v[128:131], v[136:139], v[16:31]
 v_mfma_f32_32x32x16_bf16 v[32:47], v[128:131], v[140:143], v[32:47]
 v_mfma_f32_32x32x16_bf16 v[48:63], v[132:135], v[136:139], v[48:63]
 v_mfma_f32_32x32x16_bf16 v[64:79], v[132:135], v[140:143], v[64:79]
 v_xor_b32 v176, 0x10000, v176
 v_xor_b32 v177, 0x10000, v177
 v_xor_b32 v178, 0x10000, v178
 v_xor_b32 v179, 0x10000, v179
 v_xor_b32 v180, 0x10000, v180
 v_xor_b32 v181, 0x10000, v181
 v_xor_b32 v182, 0x10000, v182
 v_xor_b32 v183, 0x10000, v183
 s_barrier
 s_add_u32 m0, s28, 0
 s_nop 0
 global_load_lds_dwordx4 v7, s[8:9]
 s_mov_b32 m0, 7168
 s_nop 0
 global_load_lds_dwordx4 v8, s[8:9]
 s_add_u32 s8, s8, 128
 s_addc_u32 s9, s9, 0
 s_add_u32 m0, s29, 0
 s_add_u32 s30, s10, 0
 s_addc_u32 s31, s11, 0
 global_load_lds_dwordx4 v5, s[30:31]
 s_add_u32 m0, s29, 1024
 s_add_u32 s30, s10, 65536
 s_addc_u32 s31, s11, 0
 global_load_lds_dwordx4 v6, s[30:31]
 s_add_u32 m0, s29, 2048
 s_add_u32 s30, s10, 131072
 s_addc_u32 s31, s11, 0
 global_load_lds_dwordx4 v5, s[30:31]
 s_add_u32 m0, s29, 3072
 s_add_u32 s30, s10, 196608
 s_addc_u32 s31, s11, 0
 global_load_lds_dwordx4 v6, s[30:31]
 s_add_u32 m0, s29, 4096
 s_add_u32 s30, s10, 262144
 s_addc_u32 s31, s11, 0
 global_load_lds_dwordx4 v5, s[30:31]
 s_add_u32 m0, s29, 5120
 s_add_u32 s30, s10, 327680
 s_addc_u32 s31, s11, 0
 global_load_lds_dwordx4 v6, s[30:31]
 s_add_u32 m0, s29, 6144
 s_add_u32 s30, s10, 393216
 s_addc_u32 s31, s11, 0
 global_load_lds_dwordx4 v5, s[30:31]
 s_add_u32 m0, s29, 7168
 s_add_u32 s30, s10, 458752
 s_addc_u32 s31, s11, 0
 global_load_lds_dwordx4 v6, s[30:31]
 s_add_u32 s10, s10, 128
 s_addc_u32 s11, s11, 0
 s_waitcnt vmcnt(14)
 s_barrier
 ds_read_b128 v[80:83], v176 offset:0
 ds_read_b128 v[84:87], v176 offset:4096
 ds_read_b128 v[88:91], v180 offset:0
 ds_read_b128 v[92:95], v180 offset:4096
 ds_read_b128 v[96:99], v177 offset:0
 ds_read_b128 v[100:103], v177 offset:4096
 ds_read_b128 v[104:107], v181 offset:0
 ds_read_b128 v[108:111], v181 offset:4096
 s_waitcnt lgkmcnt(4)
 v_mfma_f32_32x32x16_bf16 v[16:31], v[80:83], v[88:91], v[16:31]
 v_mfma_f32_32x32x16_bf16 v[32:47], v[80:83], v[92:95], v[32:47]
 v_mfma_f32_32x32x16_bf16 v[48:63], v[84:87], v[88:91], v[48:63]
 v_mfma_f32_32x32x16_bf16 v[64:79], v[84:87], v[92:95], v[64:79]
 ds_read_b128 v[112:115], v178 offset:0
 ds_read_b128 v[116:119], v178 offset:4096
 ds_read_b128 v[120:123], v182 offset:0
 ds_read_b128 v[124:127], v182 offset:4096
 s_waitcnt lgkmcnt(4)
 v_mfma_f32_32x32x16_bf16 v[16:31], v[96:99], v[104:107], v[16:31]
 v_mfma_f32_32x32x16_bf16 v[32:47], v[96:99], v[108:111], v[32:47]
 v_mfma_f32_32x32x16_bf16 v[48:63], v[100:103], v[104:107], v[48:63]
 v_mfma_f32_32x32x16_bf16 v[64:79], v[100:103], v[108:111], v[64:79]
 ds_read_b128 v[128:131], v179 offset:0
 ds_read_b128 v[132:135], v179 offset:4096
 ds_read_b128 v[136:139], v183 offset:0
 ds_read_b128 v[140:143], v183 offset:4096
 s_waitcnt lgkmcnt(4)
 v_mfma_f32_32x32x16_bf16 v[16:31], v[112:115], v[120:123], v[16:31]
 v_mfma_f32_32x32x16_bf16 v[32:47], v[112:115], v[124:127], v[32:47]
 v_mfma_f32_32x32x16_bf16 v[48:63], v[116:119], v[120:123], v[48:63]
 v_mfma_f32_32x32x16_bf16 v[64:79], v[116:119], v[124:127], v[64:79]
 s_waitcnt lgkmcnt(0)
 v_mfma_f32_32x32x16_bf16 v[16:31], v[128:131], v[136:139], v[16:31]
 v_mfma_f32_32x32x16_bf16 v[32:47], v[128:131], v[140:143], v[32:47]
 v_mfma_f32_32x32x16_bf16 v[48:63], v[132:135], v[136:139], v[48:63]
 v_mfma_f32_32x32x16_bf16 v[64:79], v[132:135], v[140:143], v[64:79]
 v_xor_b32 v176, 0x10000, v176
 v_xor_b32 v177, 0x10000, v177
 v_xor_b32 v178, 0x10000, v178
 v_xor_b32 v179, 0x10000, v179
 v_xor_b32 v180, 0x10000, v180
 v_xor_b32 v181, 0x10000, v181
 v_xor_b32 v182, 0x10000, v182
 v_xor_b32 v183, 0x10000, v183
 s_barrier
 s_add_u32 m0, s28, 65536
 s_nop 0
 global_load_lds_dwordx4 v7, s[8:9]
 s_mov_b32 m0, 72704
 s_nop 0
 global_load_lds_dwordx4 v8, s[8:9]
 s_add_u32 s8, s8, 128
 s_addc_u32 s9, s9, 0
 s_add_u32 m0, s29, 65536
 s_add_u32 s30, s10, 0
 s_addc_u32 s31, s11, 0
 global_load_lds_dwordx4 v5, s[30:31]
 s_add_u32 m0, s29, 66560
 s_add_u32 s30, s10, 65536
 s_addc_u32 s31, s11, 0
 global_load_lds_dwordx4 v6, s[30:31]
 s_add_u32 m0, s29, 67584
 s_add_u32 s30, s10, 131072
 s_addc_u32 s31, s11, 0
 global_load_lds_dwordx4 v5, s[30:31]
 s_add_u32 m0, s29, 68608
 s_add_u32 s30, s10, 196608
 s_addc_u32 s31, s11, 0
 global_load_lds_dwordx4 v6, s[30:31]
 s_add_u32 m0, s29, 69632
 s_add_u32 s30, s10, 262144
 s_addc_u32 s31, s11, 0
 global_load_lds_dwordx4 v5, s[30:31]
 s_add_u32 m0, s29, 70656
 s_add_u32 s30, s10, 327680
 s_addc_u32 s31, s11, 0
 global_load_lds_dwordx4 v6, s[30:31]
 s_add_u32 m0, s29, 71680
 s_add_u32 s30, s10, 393216
 s_addc_u32 s31, s11, 0
 global_load_lds_dwordx4 v5, s[30:31]
 s_add_u32 m0, s29, 72704
 s_add_u32 s30, s10, 458752
 s_addc_u32 s31, s11, 0
 global_load_lds_dwordx4 v6, s[30:31]
 s_add_u32 s10, s10, 128
 s_addc_u32 s11, s11, 0
 s_waitcnt vmcnt(10)
 s_barrier
 ds_read_b128 v[80:83], v176 offset:0
 ds_read_b128 v[84:87], v176 offset:4096
 ds_read_b128 v[88:91], v180 offset:0
 ds_read_b128 v[92:95], v180 offset:4096
 ds_read_b128 v[96:99], v177 offset:0
 ds_read_b128 v[100:103], v177 offset:4096
 ds_read_b128 v[104:107], v181 offset:0
 ds_read_b128 v[108:111], v181 offset:4096
 s_waitcnt lgkmcnt(4)
 v_mfma_f32_32x32x16_bf16 v[16:31], v[80:83], v[88:91], v[16:31]
 v_mfma_f32_32x32x16_bf16 v[32:47], v[80:83], v[92:95], v[32:47]
 v_mfma_f32_32x32x16_bf16 v[48:63], v[84:87], v[88:91], v[48:63]
 v_mfma_f32_32x32x16_bf16 v[64:79], v[84:87], v[92:95], v[64:79]
 ds_read_b128 v[112:115], v178 offset:0
 ds_read_b128 v[116:119], v178 offset:4096
 ds_read_b128 v[120:123], v182 offset:0
 ds_read_b128 v[124:127], v182 offset:4096
 s_waitcnt lgkmcnt(4)
 v_mfma_f32_32x32x16_bf16 v[16:31], v[96:99], v[104:107], v[16:31]
 v_mfma_f32_32x32x16_bf16 v[32:47], v[96:99], v[108:111], v[32:47]
 v_mfma_f32_32x32x16_bf16 v[48:63], v[100:103], v[104:107], v[48:63]
 v_mfma_f32_32x32x16_bf16 v[64:79], v[100:103], v[108:111], v[64:79]
 ds_read_b128 v[128:131], v179 offset:0
 ds_read_b128 v[132:135], v179 offset:4096
 ds_read_b128 v[136:139], v183 offset:0
 ds_read_b128 v[140:143], v183 offset:4096
 s_waitcnt lgkmcnt(4)
 v_mfma_f32_32x32x16_bf16 v[16:31], v[112:115], v[120:123], v[16:31]
 v_mfma_f32_32x32x16_bf16 v[32:47], v[112:115], v[124:127], v[32:47]
 v_mfma_f32_32x32x16_bf16 v[48:63], v[116:119], v[120:123], v[48:63]
 v_mfma_f32_32x32x16_bf16 v[64:79], v[116:119], v[124:127], v[64:79]
 s_waitcnt lgkmcnt(0)
 v_mfma_f32_32x32x16_bf16 v[16:31], v[128:131], v[136:139], v[16:31]
 v_mfma_f32_32x32x16_bf16 v[32:47], v[128:131], v[140:143], v[32:47]
 v_mfma_f32_32x32x16_bf16 v[48:63], v[132:135], v[136:139], v[48:63]
 v_mfma_f32_32x32x16_bf16 v[64:79], v[132:135], v[140:143], v[64:79]
 v_xor_b32 v176, 0x10000, v176
 v_xor_b32 v177, 0x10000, v177
 v_xor_b32 v178, 0x10000, v178
 v_xor_b32 v179, 0x10000, v179
 v_xor_b32 v180, 0x10000, v180
 v_xor_b32 v181, 0x10000, v181
 v_xor_b32 v182, 0x10000, v182
 v_xor_b32 v183, 0x10000, v183
 s_waitcnt vmcnt(0)
 s_barrier
 ds_read_b128 v[80:83], v176 offset:0
 ds_read_b128 v[84:87], v176 offset:4096
 ds_read_b128 v[88:91], v180 offset:0
 ds_read_b128 v[92:95], v180 offset:4096
 ds_read_b128 v[96:99], v177 offset:0
 ds_read_b128 v[100:103], v177 offset:4096
 ds_read_b128 v[104:107], v181 offset:0
 ds_read_b128 v[108:111], v181 offset:4096
 s_waitcnt lgkmcnt(4)
 v_mfma_f32_32x32x16_bf16 v[16:31], v[80:83], v[88:91], v[16:31]
 v_mfma_f32_32x32x16_bf16 v[32:47], v[80:83], v[92:95], v[32:47]
 v_mfma_f32_32x32x16_bf16 v[48:63], v[84:87], v[88:91], v[48:63]
 v_mfma_f32_32x32x16_bf16 v[64:79], v[84:87], v[92:95], v[64:79]
 ds_read_b128 v[112:115], v178 offset:0
 ds_read_b128 v[116:119], v178 offset:4096
 ds_read_b128 v[120:123], v182 offset:0
 ds_read_b128 v[124:127], v182 offset:4096
 s_waitcnt lgkmcnt(4)
 v_mfma_f32_32x32x16_bf16 v[16:31], v[96:99], v[104:107], v[16:31]
 v_mfma_f32_32x32x16_bf16 v[32:47], v[96:99], v[108:111], v[32:47]
 v_mfma_f32_32x32x16_bf16 v[48:63], v[100:103], v[104:107], v[48:63]
 v_mfma_f32_32x32x16_bf16 v[64:79], v[100:103], v[108:111], v[64:79]
 ds_read_b128 v[128:131], v179 offset:0
 ds_read_b128 v[132:135], v179 offset:4096
 ds_read_b128 v[136:139], v183 offset:0
 ds_read_b128 v[140:143], v183 offset:4096
 s_waitcnt lgkmcnt(4)
 v_mfma_f32_32x32x16_bf16 v[16:31], v[112:115], v[120:123], v[16:31]
 v_mfma_f32_32x32x16_bf16 v[32:47], v[112:115], v[124:127], v[32:47]
 v_mfma_f32_32x32x16_bf16 v[48:63], v[116:119], v[120:123], v[48:63]
 v_mfma_f32_32x32x16_bf16 v[64:79], v[116:119], v[124:127], v[64:79]
 s_waitcnt lgkmcnt(0)
 v_mfma_f32_32x32x16_bf16 v[16:31], v[128:131], v[136:139], v[16:31]
 v_mfma_f32_32x32x16_bf16 v[32:47], v[128:131], v[140:143], v[32:47]
 v_mfma_f32_32x32x16_bf16 v[48:63], v[132:135], v[136:139], v[48:63]
 v_mfma_f32_32x32x16_bf16 v[64:79], v[132:135], v[140:143], v[64:79]
 s_nop 15
 v_cvt_pk_bf16_f32 v80, v16, v17
 v_cvt_pk_bf16_f32 v81, v20, v21
 v_cvt_pk_bf16_f32 v82, v18, v19
 v_cvt_pk_bf16_f32 v83, v22, v23
 global_store_dwordx4 v10, v[80:83], s[4:5] offset:0
 v_cvt_pk_bf16_f32 v84, v24, v25
 v_cvt_pk_bf16_f32 v85, v28, v29
 v_cvt_pk_bf16_f32 v86, v26, v27
 v_cvt_pk_bf16_f32 v87, v30, v31
 global_store_dwordx4 v10, v[84:87], s[4:5] offset:512
 v_cvt_pk_bf16_f32 v88, v32, v33
 v_cvt_pk_bf16_f32 v89, v36, v37
 v_cvt_pk_bf16_f32 v90, v34, v35
 v_cvt_pk_bf16_f32 v91, v38, v39
 global_store_dwordx4 v11, v[88:91], s[4:5] offset:0
 v_cvt_pk_bf16_f32 v92, v40, v41
 v_cvt_pk_bf16_f32 v93, v44, v45
 v_cvt_pk_bf16_f32 v94, v42, v43
 v_cvt_pk_bf16_f32 v95, v46, v47
 global_store_dwordx4 v11, v[92:95], s[4:5] offset:512
 v_cvt_pk_bf16_f32 v96, v48, v49
 v_cvt_pk_bf16_f32 v97, v52, v53
 v_cvt_pk_bf16_f32 v98, v50, v51
 v_cvt_pk_bf16_f32 v99, v54, v55
 global_store_dwordx4 v10, v[96:99], s[4:5] offset:1024
 v_cvt_pk_bf16_f32 v100, v56, v57
 v_cvt_pk_bf16_f32 v101, v60, v61
 v_cvt_pk_bf16_f32 v102, v58, v59
 v_cvt_pk_bf16_f32 v103, v62, v63
 global_store_dwordx4 v10, v[100:103], s[4:5] offset:1536
 v_cvt_pk_bf16_f32 v104, v64, v65
 v_cvt_pk_bf16_f32 v105, v68, v69
 v_cvt_pk_bf16_f32 v106, v66, v67
 v_cvt_pk_bf16_f32 v107, v70, v71
 global_store_dwordx4 v11, v[104:107], s[4:5] offset:1024
 v_cvt_pk_bf16_f32 v108, v72, v73
 v_cvt_pk_bf16_f32 v109, v76, v77
 v_cvt_pk_bf16_f32 v110, v74, v75
 v_cvt_pk_bf16_f32 v111, v78, v79
 global_store_dwordx4 v11, v[108:111], s[4:5] offset:1536
 s_endpgm
K1_MATB:
 s_sub_u32 s18, s18, 7
 s_lshl_b32 s20, s17, 9
 s_lshl_b32 s21, s18, 19
 s_add_u32 s21, s21, s20
 s_add_u32 s12, s12, s21
 s_addc_u32 s13, s13, 0
 v_lshrrev_b32 v12, 3, v2
 v_lshlrev_b32 v12, 13, v12
 v_and_b32 v13, 7, v2
 v_lshrrev_b32 v14, 4, v2
 v_xor_b32 v13, v13, v14
 v_lshl_add_u32 v5, v13, 4, v12
 v_xor_b32 v6, 64, v5
 s_lshl_b32 s26, s16, 16
 s_and_b32 s27, s16, 1
 s_lshl_b32 s27, s27, 6
 v_xor_b32 v7, s27, v5
 v_add_u32 v7, s26, v7
 v_add_u32 v8, 458752, v6
 s_lshl_b32 s28, s16, 10
 s_lshl_b32 s29, s16, 13
 s_add_u32 s29, s29, 8192
 s_mul_i32 s20, s17, 229376
 s_add_u32 s14, s14, s20
 s_addc_u32 s15, s15, 0
 s_lshl_b32 s21, s16, 6
 v_lshlrev_b32 v9, 1, v3
 v_add_u32 v9, s21, v9
 v_mul_u32_u24 v180, 7168, v4
 v_lshl_add_u32 v180, v9, 1, v180
 v_add_u32 v180, 8192, v180
 v_lshlrev_b32 v12, 4, v2
 s_lshl_b32 s21, s16, 13
 v_add_u32 v5, s21, v12
 v_add_u32 v6, 4096, v5
 s_add_u32 m0, s28, 0
 s_nop 0
 global_load_lds_dwordx4 v7, s[12:13]
 s_mov_b32 m0, 7168
 s_nop 0
 global_load_lds_dwordx4 v8, s[12:13]
 s_add_u32 s12, s12, 128
 s_addc_u32 s13, s13, 0
 s_add_u32 m0, s29, 0
 s_nop 0
 global_load_lds_dwordx4 v5, s[14:15] offset:0
 global_load_lds_dwordx4 v5, s[14:15] offset:1024
 global_load_lds_dwordx4 v5, s[14:15] offset:2048
 global_load_lds_dwordx4 v5, s[14:15] offset:3072
 s_add_u32 m0, s29, 4096
 s_nop 0
 global_load_lds_dwordx4 v6, s[14:15] offset:0
 global_load_lds_dwordx4 v6, s[14:15] offset:1024
 global_load_lds_dwordx4 v6, s[14:15] offset:2048
 global_load_lds_dwordx4 v6, s[14:15] offset:3072
 s_add_u32 s14, s14, 57344
 s_addc_u32 s15, s15, 0
 s_add_u32 m0, s28, 65536
 s_nop 0
 global_load_lds_dwordx4 v7, s[12:13]
 s_mov_b32 m0, 72704
 s_nop 0
 global_load_lds_dwordx4 v8, s[12:13]
 s_add_u32 s12, s12, 128
 s_addc_u32 s13, s13, 0
 s_add_u32 m0, s29, 65536
 s_nop 0
 global_load_lds_dwordx4 v5, s[14:15] offset:0
 global_load_lds_dwordx4 v5, s[14:15] offset:1024
 global_load_lds_dwordx4 v5, s[14:15] offset:2048
 global_load_lds_dwordx4 v5, s[14:15] offset:3072
 s_add_u32 m0, s29, 69632
 s_nop 0
 global_load_lds_dwordx4 v6, s[14:15] offset:0
 global_load_lds_dwordx4 v6, s[14:15] offset:1024
 global_load_lds_dwordx4 v6, s[14:15] offset:2048
 global_load_lds_dwordx4 v6, s[14:15] offset:3072
 s_add_u32 s14, s14, 57344
 s_addc_u32 s15, s15, 0
 v_lshlrev_b32 v12, 13, v2
 global_load_dword v188, v12, s[12:13]
 global_load_dword v189, v12, s[12:13] offset:128
 s_lshl_b32 s21, s16, 14
 v_lshlrev_b32 v12, 7, v2
 v_add_u32 v12, s21, v12
 v_add_u32 v13, 8192, v12
 global_load_dword v186, v12, s[14:15]
 global_load_dword v187, v13, s[14:15]
 v_bfe_u32 v12, v3, 1, 3
 v_xor_b32 v12, v12, v4
 v_lshlrev_b32 v12, 4, v12
 v_lshl_add_u32 v176, v3, 7, v12
 v_xor_b32 v177, 32, v176
 v_xor_b32 v178, 64, v176
 v_xor_b32 v179, 96, v176
 v_mov_b32 v16, 0
 v_mov_b32 v17, 0
 v_mov_b32 v18, 0
 v_mov_b32 v19, 0
 v_mov_b32 v20, 0
 v_mov_b32 v21, 0
 v_mov_b32 v22, 0
 v_mov_b32 v23, 0
 v_mov_b32 v24, 0
 v_mov_b32 v25, 0
 v_mov_b32 v26, 0
 v_mov_b32 v27, 0
 v_mov_b32 v28, 0
 v_mov_b32 v29, 0
 v_mov_b32 v30, 0
 v_mov_b32 v31, 0
 v_mov_b32 v32, 0
 v_mov_b32 v33, 0
 v_mov_b32 v34, 0
 v_mov_b32 v35, 0
 v_mov_b32 v36, 0
 v_mov_b32 v37, 0
 v_mov_b32 v38, 0
 v_mov_b32 v39, 0
 v_mov_b32 v40, 0
 v_mov_b32 v41, 0
 v_mov_b32 v42, 0
 v_mov_b32 v43, 0
 v_mov_b32 v44, 0
 v_mov_b32 v45, 0
 v_mov_b32 v46, 0
 v_mov_b32 v47, 0
 v_mov_b32 v48, 0
 v_mov_b32 v49, 0
 v_mov_b32 v50, 0
 v_mov_b32 v51, 0
 v_mov_b32 v52, 0
 v_mov_b32 v53, 0
 v_mov_b32 v54, 0
 v_mov_b32 v55, 0
 v_mov_b32 v56, 0
 v_mov_b32 v57, 0
 v_mov_b32 v58, 0
 v_mov_b32 v59, 0
 v_mov_b32 v60, 0
 v_mov_b32 v61, 0
 v_mov_b32 v62, 0
 v_mov_b32 v63, 0
 v_mov_b32 v64, 0
 v_mov_b32 v65, 0
 v_mov_b32 v66, 0
 v_mov_b32 v67, 0
 v_mov_b32 v68, 0
 v_mov_b32 v69, 0
 v_mov_b32 v70, 0
 v_mov_b32 v71, 0
 v_mov_b32 v72, 0
 v_mov_b32 v73, 0
 v_mov_b32 v74, 0
 v_mov_b32 v75, 0
 v_mov_b32 v76, 0
 v_mov_b32 v77, 0
 v_mov_b32 v78, 0
 v_mov_b32 v79, 0
 s_lshl_b32 s20, s17, 1
 s_mul_i32 s20, s20, 14336
 s_lshl_b32 s21, s18, 11
 s_add_u32 s20, s20, s21
 s_add_u32 s20, s20, 6422528
 s_add_u32 s4, s4, s20
 s_addc_u32 s5, s5, 0
 s_mov_b32 s22, 458752
 s_movk_i32 s23, 14336
 v_lshrrev_b32 v12, 5, v9
 v_mul_lo_u32 v12, v12, s22
 v_bfe_u32 v13, v9, 4, 1
 v_mul_u32_u24 v13, s23, v13
 v_and_b32 v14, 15, v9
 v_lshlrev_b32 v14, 4, v14
 v_add3_u32 v12, v12, v13, v14
 v_lshlrev_b32 v14, 8, v4
 v_add_u32 v10, v12, v14
 v_add_u32 v11, 16, v10
 s_waitcnt vmcnt(14)
 s_barrier
 ds_read_b128 v[80:83], v176 offset:0
 ds_read_b128 v[84:87], v176 offset:4096
 ds_read_b32 v88, v180 offset:0
 ds_read_b32 v89, v180 offset:896
 ds_read_b32 v90, v180 offset:1792
 ds_read_b32 v91, v180 offset:2688
 ds_read_b32 v92, v180 offset:3584
 ds_read_b32 v93, v180 offset:4480
 ds_read_b32 v94, v180 offset:5376
 ds_read_b32 v95, v180 offset:6272
 ds_read_b128 v[96:99], v177 offset:0
 ds_read_b128 v[100:103], v177 offset:4096
 ds_read_b32 v104, v180 offset:14336
 ds_read_b32 v105, v180 offset:15232
 ds_read_b32 v106, v180 offset:16128
 ds_read_b32 v107, v180 offset:17024
 ds_read_b32 v108, v180 offset:17920
 ds_read_b32 v109, v180 offset:18816
 ds_read_b32 v110, v180 offset:19712
 ds_read_b32 v111, v180 offset:20608
 s_waitcnt lgkmcnt(10)
 v_perm_b32 v144, v89, v88, s24
 v_perm_b32 v145, v91, v90, s24
 v_perm_b32 v146, v93, v92, s24
 v_perm_b32 v147, v95, v94, s24
 v_perm_b32 v148, v89, v88, s25
 v_perm_b32 v149, v91, v90, s25
 v_perm_b32 v150, v93, v92, s25
 v_perm_b32 v151, v95, v94, s25
 v_mfma_f32_32x32x16_bf16 v[16:31], v[80:83], v[144:147], v[16:31]
 s_nop 0
 v_mfma_f32_32x32x16_bf16 v[32:47], v[80:83], v[148:151], v[32:47]
 v_mfma_f32_32x32x16_bf16 v[48:63], v[84:87], v[144:147], v[48:63]
 v_mfma_f32_32x32x16_bf16 v[64:79], v[84:87], v[148:151], v[64:79]
 ds_read_b128 v[112:115], v178 offset:0
 ds_read_b128 v[116:119], v178 offset:4096
 ds_read_b32 v120, v180 offset:28672
 ds_read_b32 v121, v180 offset:29568
 ds_read_b32 v122, v180 offset:30464
 ds_read_b32 v123, v180 offset:31360
 ds_read_b32 v124, v180 offset:32256
 ds_read_b32 v125, v180 offset:33152
 ds_read_b32 v126, v180 offset:34048
 ds_read_b32 v127, v180 offset:34944
 s_waitcnt lgkmcnt(10)
 v_perm_b32 v152, v105, v104, s24
 v_perm_b32 v153, v107, v106, s24
 v_perm_b32 v154, v109, v108, s24
 v_perm_b32 v155, v111, v110, s24
 v_perm_b32 v156, v105, v104, s25
 v_perm_b32 v157, v107, v106, s25
 v_perm_b32 v158, v109, v108, s25
 v_perm_b32 v159, v111, v110, s25
 v_mfma_f32_32x32x16_bf16 v[16:31], v[96:99], v[152:155], v[16:31]
 s_nop 0
 v_mfma_f32_32x32x16_bf16 v[32:47], v[96:99], v[156:159], v[32:47]
 v_mfma_f32_32x32x16_bf16 v[48:63], v[100:103], v[152:155], v[48:63]
 v_mfma_f32_32x32x16_bf16 v[64:79], v[100:103], v[156:159], v[64:79]
 ds_read_b128 v[128:131], v179 offset:0
 ds_read_b128 v[132:135], v179 offset:4096
 ds_read_b32 v136, v180 offset:43008
 ds_read_b32 v137, v180 offset:43904
 ds_read_b32 v138, v180 offset:44800
 ds_read_b32 v139, v180 offset:45696
 ds_read_b32 v140, v180 offset:46592
 ds_read_b32 v141, v180 offset:47488
 ds_read_b32 v142, v180 offset:48384
 ds_read_b32 v143, v180 offset:49280
 s_waitcnt lgkmcnt(10)
 v_perm_b32 v144, v121, v120, s24
 v_perm_b32 v145, v123, v122, s24
 v_perm_b32 v146, v125, v124, s24
 v_perm_b32 v147, v127, v126, s24
 v_perm_b32 v148, v121, v120, s25
 v_perm_b32 v149, v123, v122, s25
 v_perm_b32 v150, v125, v124, s25
 v_perm_b32 v151, v127, v126, s25
 v_mfma_f32_32x32x16_bf16 v[16:31], v[112:115], v[144:147], v[16:31]
 s_nop 0
 v_mfma_f32_32x32x16_bf16 v[32:47], v[112:115], v[148:151], v[32:47]
 v_mfma_f32_32x32x16_bf16 v[48:63], v[116:119], v[144:147], v[48:63]
 v_mfma_f32_32x32x16_bf16 v[64:79], v[116:119], v[148:151], v[64:79]
 s_waitcnt lgkmcnt(0)
 v_perm_b32 v152, v137, v136, s24
 v_perm_b32 v153, v139, v138, s24
 v_perm_b32 v154, v141, v140, s24
 v_perm_b32 v155, v143, v142, s24
 v_perm_b32 v156, v137, v136, s25
 v_perm_b32 v157, v139, v138, s25
 v_perm_b32 v158, v141, v140, s25
 v_perm_b32 v159, v143, v142, s25
 v_mfma_f32_32x32x16_bf16 v[16:31], v[128:131], v[152:155], v[16:31]
 s_nop 0
 v_mfma_f32_32x32x16_bf16 v[32:47], v[128:131], v[156:159], v[32:47]
 v_mfma_f32_32x32x16_bf16 v[48:63], v[132:135], v[152:155], v[48:63]
 v_mfma_f32_32x32x16_bf16 v[64:79], v[132:135], v[156:159], v[64:79]
 v_xor_b32 v176, 0x10000, v176
 v_xor_b32 v177, 0x10000, v177
 v_xor_b32 v178, 0x10000, v178
 v_xor_b32 v179, 0x10000, v179
 v_xor_b32 v180, 0x10000, v180
 v_xor_b32 v181, 0x10000, v181
 v_xor_b32 v182, 0x10000, v182
 v_xor_b32 v183, 0x10000, v183
 s_barrier
 s_add_u32 m0, s28, 0
 s_nop 0
 global_load_lds_dwordx4 v7, s[12:13]
 s_mov_b32 m0, 7168
 s_nop 0
 global_load_lds_dwordx4 v8, s[12:13]
 s_add_u32 s12, s12, 128
 s_addc_u32 s13, s13, 0
 s_add_u32 m0, s29, 0
 s_nop 0
 global_load_lds_dwordx4 v5, s[14:15] offset:0
 global_load_lds_dwordx4 v5, s[14:15] offset:1024
 global_load_lds_dwordx4 v5, s[14:15] offset:2048
 global_load_lds_dwordx4 v5, s[14:15] offset:3072
 s_add_u32 m0, s29, 4096
 s_nop 0
 global_load_lds_dwordx4 v6, s[14:15] offset:0
 global_load_lds_dwordx4 v6, s[14:15] offset:1024
 global_load_lds_dwordx4 v6, s[14:15] offset:2048
 global_load_lds_dwordx4 v6, s[14:15] offset:3072
 s_add_u32 s14, s14, 57344
 s_addc_u32 s15, s15, 0
 s_waitcnt vmcnt(14)
 s_barrier
 ds_read_b128 v[80:83], v176 offset:0
 ds_read_b128 v[84:87], v176 offset:4096
 ds_read_b32 v88, v180 offset:0
 ds_read_b32 v89, v180 offset:896
 ds_read_b32 v90, v180 offset:1792
 ds_read_b32 v91, v180 offset:2688
 ds_read_b32 v92, v180 offset:3584
 ds_read_b32 v93, v180 offset:4480
 ds_read_b32 v94, v180 offset:5376
 ds_read_b32 v95, v180 offset:6272
 ds_read_b128 v[96:99], v177 offset:0
 ds_read_b128 v[100:103], v177 offset:4096
 ds_read_b32 v104, v180 offset:14336
 ds_read_b32 v105, v180 offset:15232
 ds_read_b32 v106, v180 offset:16128
 ds_read_b32 v107, v180 offset:17024
 ds_read_b32 v108, v180 offset:17920
 ds_read_b32 v109, v180 offset:18816
 ds_read_b32 v110, v180 offset:19712
 ds_read_b32 v111, v180 offset:20608
 s_waitcnt lgkmcnt(10)
 v_perm_b32 v144, v89, v88, s24
 v_perm_b32 v145, v91, v90, s24
 v_perm_b32 v146, v93, v92, s24
 v_perm_b32 v147, v95, v94, s24
 v_perm_b32 v148, v89, v88, s25
 v_perm_b32 v149, v91, v90, s25
 v_perm_b32 v150, v93, v92, s25
 v_perm_b32 v151, v95, v94, s25
 v_mfma_f32_32x32x16_bf16 v[16:31], v[80:83], v[144:147], v[16:31]
 s_nop 0
 v_mfma_f32_32x32x16_bf16 v[32:47], v[80:83], v[148:151], v[32:47]
 v_mfma_f32_32x32x16_bf16 v[48:63], v[84:87], v[144:147], v[48:63]
 v_mfma_f32_32x32x16_bf16 v[64:79], v[84:87], v[148:151], v[64:79]
 ds_read_b128 v[112:115], v178 offset:0
 ds_read_b128 v[116:119], v178 offset:4096
 ds_read_b32 v120, v180 offset:28672
 ds_read_b32 v121, v180 offset:29568
 ds_read_b32 v122, v180 offset:30464
 ds_read_b32 v123, v180 offset:31360
 ds_read_b32 v124, v180 offset:32256
 ds_read_b32 v125, v180 offset:33152
 ds_read_b32 v126, v180 offset:34048
 ds_read_b32 v127, v180 offset:34944
 s_waitcnt lgkmcnt(10)
 v_perm_b32 v152, v105, v104, s24
 v_perm_b32 v153, v107, v106, s24
 v_perm_b32 v154, v109, v108, s24
 v_perm_b32 v155, v111, v110, s24
 v_perm_b32 v156, v105, v104, s25
 v_perm_b32 v157, v107, v106, s25
 v_perm_b32 v158, v109, v108, s25
 v_perm_b32 v159, v111, v110, s25
 v_mfma_f32_32x32x16_bf16 v[16:31], v[96:99], v[152:155], v[16:31]
 s_nop 0
 v_mfma_f32_32x32x16_bf16 v[32:47], v[96:99], v[156:159], v[32:47]
 v_mfma_f32_32x32x16_bf16 v[48:63], v[100:103], v[152:155], v[48:63]
 v_mfma_f32_32x32x16_bf16 v[64:79], v[100:103], v[156:159], v[64:79]
 ds_read_b128 v[128:131], v179 offset:0
 ds_read_b128 v[132:135], v179 offset:4096
 ds_read_b32 v136, v180 offset:43008
 ds_read_b32 v137, v180 offset:43904
 ds_read_b32 v138, v180 offset:44800
 ds_read_b32 v139, v180 offset:45696
 ds_read_b32 v140, v180 offset:46592
 ds_read_b32 v141, v180 offset:47488
 ds_read_b32 v142, v180 offset:48384
 ds_read_b32 v143, v180 offset:49280
 s_waitcnt lgkmcnt(10)
 v_perm_b32 v144, v121, v120, s24
 v_perm_b32 v145, v123, v122, s24
 v_perm_b32 v146, v125, v124, s24
 v_perm_b32 v147, v127, v126, s24
 v_perm_b32 v148, v121, v120, s25
 v_perm_b32 v149, v123, v122, s25
 v_perm_b32 v150, v125, v124, s25
 v_perm_b32 v151, v127, v126, s25
 v_mfma_f32_32x32x16_bf16 v[16:31], v[112:115], v[144:147], v[16:31]
 s_nop 0
 v_mfma_f32_32x32x16_bf16 v[32:47], v[112:115], v[148:151], v[32:47]
 v_mfma_f32_32x32x16_bf16 v[48:63], v[116:119], v[144:147], v[48:63]
 v_mfma_f32_32x32x16_bf16 v[64:79], v[116:119], v[148:151], v[64:79]
 s_waitcnt lgkmcnt(0)
 v_perm_b32 v152, v137, v136, s24
 v_perm_b32 v153, v139, v138, s24
 v_perm_b32 v154, v141, v140, s24
 v_perm_b32 v155, v143, v142, s24
 v_perm_b32 v156, v137, v136, s25
 v_perm_b32 v157, v139, v138, s25
 v_perm_b32 v158, v141, v140, s25
 v_perm_b32 v159, v143, v142, s25
 v_mfma_f32_32x32x16_bf16 v[16:31], v[128:131], v[152:155], v[16:31]
 s_nop 0
 v_mfma_f32_32x32x16_bf16 v[32:47], v[128:131], v[156:159], v[32:47]
 v_mfma_f32_32x32x16_bf16 v[48:63], v[132:135], v[152:155], v[48:63]
 v_mfma_f32_32x32x16_bf16 v[64:79], v[132:135], v[156:159], v[64:79]
 v_xor_b32 v176, 0x10000, v176
 v_xor_b32 v177, 0x10000, v177
 v_xor_b32 v178, 0x10000, v178
 v_xor_b32 v179, 0x10000, v179
 v_xor_b32 v180, 0x10000, v180
 v_xor_b32 v181, 0x10000, v181
 v_xor_b32 v182, 0x10000, v182
 v_xor_b32 v183, 0x10000, v183
 s_barrier
 s_add_u32 m0, s28, 65536
 s_nop 0
 global_load_lds_dwordx4 v7, s[12:13]
 s_mov_b32 m0, 72704
 s_nop 0
 global_load_lds_dwordx4 v8, s[12:13]
 s_add_u32 s12, s12, 128
 s_addc_u32 s13, s13, 0
 s_add_u32 m0, s29, 65536
 s_nop 0
 global_load_lds_dwordx4 v5, s[14:15] offset:0
 global_load_lds_dwordx4 v5, s[14:15] offset:1024
 global_load_lds_dwordx4 v5, s[14:15] offset:2048
 global_load_lds_dwordx4 v5, s[14:15] offset:3072
 s_add_u32 m0, s29, 69632
 s_nop 0
 global_load_lds_dwordx4 v6, s[14:15] offset:0
 global_load_lds_dwordx4 v6, s[14:15] offset:1024
 global_load_lds_dwordx4 v6, s[14:15] offset:2048
 global_load_lds_dwordx4 v6, s[14:15] offset:3072
 s_add_u32 s14, s14, 57344
 s_addc_u32 s15, s15, 0
 s_waitcnt vmcnt(10)
 s_barrier
 ds_read_b128 v[80:83], v176 offset:0
 ds_read_b128 v[84:87], v176 offset:4096
 ds_read_b32 v88, v180 offset:0
 ds_read_b32 v89, v180 offset:896
 ds_read_b32 v90, v180 offset:1792
 ds_read_b32 v91, v180 offset:2688
 ds_read_b32 v92, v180 offset:3584
 ds_read_b32 v93, v180 offset:4480
 ds_read_b32 v94, v180 offset:5376
 ds_read_b32 v95, v180 offset:6272
 ds_read_b128 v[96:99], v177 offset:0
 ds_read_b128 v[100:103], v177 offset:4096
 ds_read_b32 v104, v180 offset:14336
 ds_read_b32 v105, v180 offset:15232
 ds_read_b32 v106, v180 offset:16128
 ds_read_b32 v107, v180 offset:17024
 ds_read_b32 v108, v180 offset:17920
 ds_read_b32 v109, v180 offset:18816
 ds_read_b32 v110, v180 offset:19712
 ds_read_b32 v111, v180 offset:20608
 s_waitcnt lgkmcnt(10)
 v_perm_b32 v144, v89, v88, s24
 v_perm_b32 v145, v91, v90, s24
 v_perm_b32 v146, v93, v92, s24
 v_perm_b32 v147, v95, v94, s24
 v_perm_b32 v148, v89, v88, s25
 v_perm_b32 v149, v91, v90, s25
 v_perm_b32 v150, v93, v92, s25
 v_perm_b32 v151, v95, v94, s25
 v_mfma_f32_32x32x16_bf16 v[16:31], v[80:83], v[144:147], v[16:31]
 s_nop 0
 v_mfma_f32_32x32x16_bf16 v[32:47], v[80:83], v[148:151], v[32:47]
 v_mfma_f32_32x32x16_bf16 v[48:63], v[84:87], v[144:147], v[48:63]
 v_mfma_f32_32x32x16_bf16 v[64:79], v[84:87], v[148:151], v[64:79]
 ds_read_b128 v[112:115], v178 offset:0
 ds_read_b128 v[116:119], v178 offset:4096
 ds_read_b32 v120, v180 offset:28672
 ds_read_b32 v121, v180 offset:29568
 ds_read_b32 v122, v180 offset:30464
 ds_read_b32 v123, v180 offset:31360
 ds_read_b32 v124, v180 offset:32256
 ds_read_b32 v125, v180 offset:33152
 ds_read_b32 v126, v180 offset:34048
 ds_read_b32 v127, v180 offset:34944
 s_waitcnt lgkmcnt(10)
 v_perm_b32 v152, v105, v104, s24
 v_perm_b32 v153, v107, v106, s24
 v_perm_b32 v154, v109, v108, s24
 v_perm_b32 v155, v111, v110, s24
 v_perm_b32 v156, v105, v104, s25
 v_perm_b32 v157, v107, v106, s25
 v_perm_b32 v158, v109, v108, s25
 v_perm_b32 v159, v111, v110, s25
 v_mfma_f32_32x32x16_bf16 v[16:31], v[96:99], v[152:155], v[16:31]
 s_nop 0
 v_mfma_f32_32x32x16_bf16 v[32:47], v[96:99], v[156:159], v[32:47]
 v_mfma_f32_32x32x16_bf16 v[48:63], v[100:103], v[152:155], v[48:63]
 v_mfma_f32_32x32x16_bf16 v[64:79], v[100:103], v[156:159], v[64:79]
 ds_read_b128 v[128:131], v179 offset:0
 ds_read_b128 v[132:135], v179 offset:4096
 ds_read_b32 v136, v180 offset:43008
 ds_read_b32 v137, v180 offset:43904
 ds_read_b32 v138, v180 offset:44800
 ds_read_b32 v139, v180 offset:45696
 ds_read_b32 v140, v180 offset:46592
 ds_read_b32 v141, v180 offset:47488
 ds_read_b32 v142, v180 offset:48384
 ds_read_b32 v143, v180 offset:49280
 s_waitcnt lgkmcnt(10)
 v_perm_b32 v144, v121, v120, s24
 v_perm_b32 v145, v123, v122, s24
 v_perm_b32 v146, v125, v124, s24
 v_perm_b32 v147, v127, v126, s24
 v_perm_b32 v148, v121, v120, s25
 v_perm_b32 v149, v123, v122, s25
 v_perm_b32 v150, v125, v124, s25
 v_perm_b32 v151, v127, v126, s25
 v_mfma_f32_32x32x16_bf16 v[16:31], v[112:115], v[144:147], v[16:31]
 s_nop 0
 v_mfma_f32_32x32x16_bf16 v[32:47], v[112:115], v[148:151], v[32:47]
 v_mfma_f32_32x32x16_bf16 v[48:63], v[116:119], v[144:147], v[48:63]
 v_mfma_f32_32x32x16_bf16 v[64:79], v[116:119], v[148:151], v[64:79]
 s_waitcnt lgkmcnt(0)
 v_perm_b32 v152, v137, v136, s24
 v_perm_b32 v153, v139, v138, s24
 v_perm_b32 v154, v141, v140, s24
 v_perm_b32 v155, v143, v142, s24
 v_perm_b32 v156, v137, v136, s25
 v_perm_b32 v157, v139, v138, s25
 v_perm_b32 v158, v141, v140, s25
 v_perm_b32 v159, v143, v142, s25
 v_mfma_f32_32x32x16_bf16 v[16:31], v[128:131], v[152:155], v[16:31]
 s_nop 0
 v_mfma_f32_32x32x16_bf16 v[32:47], v[128:131], v[156:159], v[32:47]
 v_mfma_f32_32x32x16_bf16 v[48:63], v[132:135], v[152:155], v[48:63]
 v_mfma_f32_32x32x16_bf16 v[64:79], v[132:135], v[156:159], v[64:79]
 v_xor_b32 v176, 0x10000, v176
 v_xor_b32 v177, 0x10000, v177
 v_xor_b32 v178, 0x10000, v178
 v_xor_b32 v179, 0x10000, v179
 v_xor_b32 v180, 0x10000, v180
 v_xor_b32 v181, 0x10000, v181
 v_xor_b32 v182, 0x10000, v182
 v_xor_b32 v183, 0x10000, v183
 s_waitcnt vmcnt(0)
 s_barrier
 ds_read_b128 v[80:83], v176 offset:0
 ds_read_b128 v[84:87], v176 offset:4096
 ds_read_b32 v88, v180 offset:0
 ds_read_b32 v89, v180 offset:896
 ds_read_b32 v90, v180 offset:1792
 ds_read_b32 v91, v180 offset:2688
 ds_read_b32 v92, v180 offset:3584
 ds_read_b32 v93, v180 offset:4480
 ds_read_b32 v94, v180 offset:5376
 ds_read_b32 v95, v180 offset:6272
 ds_read_b128 v[96:99], v177 offset:0
 ds_read_b128 v[100:103], v177 offset:4096
 ds_read_b32 v104, v180 offset:14336
 ds_read_b32 v105, v180 offset:15232
 ds_read_b32 v106, v180 offset:16128
 ds_read_b32 v107, v180 offset:17024
 ds_read_b32 v108, v180 offset:17920
 ds_read_b32 v109, v180 offset:18816
 ds_read_b32 v110, v180 offset:19712
 ds_read_b32 v111, v180 offset:20608
 s_waitcnt lgkmcnt(10)
 v_perm_b32 v144, v89, v88, s24
 v_perm_b32 v145, v91, v90, s24
 v_perm_b32 v146, v93, v92, s24
 v_perm_b32 v147, v95, v94, s24
 v_perm_b32 v148, v89, v88, s25
 v_perm_b32 v149, v91, v90, s25
 v_perm_b32 v150, v93, v92, s25
 v_perm_b32 v151, v95, v94, s25
 v_mfma_f32_32x32x16_bf16 v[16:31], v[80:83], v[144:147], v[16:31]
 s_nop 0
 v_mfma_f32_32x32x16_bf16 v[32:47], v[80:83], v[148:151], v[32:47]
 v_mfma_f32_32x32x16_bf16 v[48:63], v[84:87], v[144:147], v[48:63]
 v_mfma_f32_32x32x16_bf16 v[64:79], v[84:87], v[148:151], v[64:79]
 ds_read_b128 v[112:115], v178 offset:0
 ds_read_b128 v[116:119], v178 offset:4096
 ds_read_b32 v120, v180 offset:28672
 ds_read_b32 v121, v180 offset:29568
 ds_read_b32 v122, v180 offset:30464
 ds_read_b32 v123, v180 offset:31360
 ds_read_b32 v124, v180 offset:32256
 ds_read_b32 v125, v180 offset:33152
 ds_read_b32 v126, v180 offset:34048
 ds_read_b32 v127, v180 offset:34944
 s_waitcnt lgkmcnt(10)
 v_perm_b32 v152, v105, v104, s24
 v_perm_b32 v153, v107, v106, s24
 v_perm_b32 v154, v109, v108, s24
 v_perm_b32 v155, v111, v110, s24
 v_perm_b32 v156, v105, v104, s25
 v_perm_b32 v157, v107, v106, s25
 v_perm_b32 v158, v109, v108, s25
 v_perm_b32 v159, v111, v110, s25
 v_mfma_f32_32x32x16_bf16 v[16:31], v[96:99], v[152:155], v[16:31]
 s_nop 0
 v_mfma_f32_32x32x16_bf16 v[32:47], v[96:99], v[156:159], v[32:47]
 v_mfma_f32_32x32x16_bf16 v[48:63], v[100:103], v[152:155], v[48:63]
 v_mfma_f32_32x32x16_bf16 v[64:79], v[100:103], v[156:159], v[64:79]
 ds_read_b128 v[128:131], v179 offset:0
 ds_read_b128 v[132:135], v179 offset:4096
 ds_read_b32 v136, v180 offset:43008
 ds_read_b32 v137, v180 offset:43904
 ds_read_b32 v138, v180 offset:44800
 ds_read_b32 v139, v180 offset:45696
 ds_read_b32 v140, v180 offset:46592
 ds_read_b32 v141, v180 offset:47488
 ds_read_b32 v142, v180 offset:48384
 ds_read_b32 v143, v180 offset:49280
 s_waitcnt lgkmcnt(10)
 v_perm_b32 v144, v121, v120, s24
 v_perm_b32 v145, v123, v122, s24
 v_perm_b32 v146, v125, v124, s24
 v_perm_b32 v147, v127, v126, s24
 v_perm_b32 v148, v121, v120, s25
 v_perm_b32 v149, v123, v122, s25
 v_perm_b32 v150, v125, v124, s25
 v_perm_b32 v151, v127, v126, s25
 v_mfma_f32_32x32x16_bf16 v[16:31], v[112:115], v[144:147], v[16:31]
 s_nop 0
 v_mfma_f32_32x32x16_bf16 v[32:47], v[112:115], v[148:151], v[32:47]
 v_mfma_f32_32x32x16_bf16 v[48:63], v[116:119], v[144:147], v[48:63]
 v_mfma_f32_32x32x16_bf16 v[64:79], v[116:119], v[148:151], v[64:79]
 s_waitcnt lgkmcnt(0)
 v_perm_b32 v152, v137, v136, s24
 v_perm_b32 v153, v139, v138, s24
 v_perm_b32 v154, v141, v140, s24
 v_perm_b32 v155, v143, v142, s24
 v_perm_b32 v156, v137, v136, s25
 v_perm_b32 v157, v139, v138, s25
 v_perm_b32 v158, v141, v140, s25
 v_perm_b32 v159, v143, v142, s25
 v_mfma_f32_32x32x16_bf16 v[16:31], v[128:131], v[152:155], v[16:31]
 s_nop 0
 v_mfma_f32_32x32x16_bf16 v[32:47], v[128:131], v[156:159], v[32:47]
 v_mfma_f32_32x32x16_bf16 v[48:63], v[132:135], v[152:155], v[48:63]
 v_mfma_f32_32x32x16_bf16 v[64:79], v[132:135], v[156:159], v[64:79]
 s_nop 15
 v_cvt_pk_bf16_f32 v80, v16, v17
 v_cvt_pk_bf16_f32 v81, v20, v21
 v_cvt_pk_bf16_f32 v82, v18, v19
 v_cvt_pk_bf16_f32 v83, v22, v23
 global_store_dwordx4 v10, v[80:83], s[4:5] offset:0
 v_cvt_pk_bf16_f32 v84, v24, v25
 v_cvt_pk_bf16_f32 v85, v28, v29
 v_cvt_pk_bf16_f32 v86, v26, v27
 v_cvt_pk_bf16_f32 v87, v30, v31
 global_store_dwordx4 v10, v[84:87], s[4:5] offset:512
 v_cvt_pk_bf16_f32 v88, v32, v33
 v_cvt_pk_bf16_f32 v89, v36, v37
 v_cvt_pk_bf16_f32 v90, v34, v35
 v_cvt_pk_bf16_f32 v91, v38, v39
 global_store_dwordx4 v11, v[88:91], s[4:5] offset:0
 v_cvt_pk_bf16_f32 v92, v40, v41
 v_cvt_pk_bf16_f32 v93, v44, v45
 v_cvt_pk_bf16_f32 v94, v42, v43
 v_cvt_pk_bf16_f32 v95, v46, v47
 global_store_dwordx4 v11, v[92:95], s[4:5] offset:512
 v_cvt_pk_bf16_f32 v96, v48, v49
 v_cvt_pk_bf16_f32 v97, v52, v53
 v_cvt_pk_bf16_f32 v98, v50, v51
 v_cvt_pk_bf16_f32 v99, v54, v55
 global_store_dwordx4 v10, v[96:99], s[4:5] offset:1024
 v_cvt_pk_bf16_f32 v100, v56, v57
 v_cvt_pk_bf16_f32 v101, v60, v61
 v_cvt_pk_bf16_f32 v102, v58, v59
 v_cvt_pk_bf16_f32 v103, v62, v63
 global_store_dwordx4 v10, v[100:103], s[4:5] offset:1536
 v_cvt_pk_bf16_f32 v104, v64, v65
 v_cvt_pk_bf16_f32 v105, v68, v69
 v_cvt_pk_bf16_f32 v106, v66, v67
 v_cvt_pk_bf16_f32 v107, v70, v71
 global_store_dwordx4 v11, v[104:107], s[4:5] offset:1024
 v_cvt_pk_bf16_f32 v108, v72, v73
 v_cvt_pk_bf16_f32 v109, v76, v77
 v_cvt_pk_bf16_f32 v110, v74, v75
 v_cvt_pk_bf16_f32 v111, v78, v79
 global_store_dwordx4 v11, v[108:111], s[4:5] offset:1536
 s_endpgm
K1_AUX:
 s_sub_u32 s17, s2, 224
 s_mul_i32 s18, s17, 7
 s_add_u32 s18, s18, s16
 s_mul_i32 s19, s17, 448
 v_add_u32 v1, s19, v0
 v_and_b32 v3, 31, v2
 v_lshrrev_b32 v4, 5, v2
 v_and_b32 v5, 0x13, v3
 v_bfe_u32 v6, v3, 2, 1
 v_lshlrev_b32 v6, 3, v6
 v_bfe_u32 v7, v3, 3, 1
 v_lshlrev_b32 v7, 2, v7
 v_or3_b32 v5, v5, v6, v7
 s_movk_i32 s26, 9363
 s_movk_i32 s27, 448
 s_mov_b32 s28, 991054117
 s_waitcnt lgkmcnt(0)
 s_add_u32 s30, s4, 13769728
 s_addc_u32 s31, s5, 0
 v_mov_b32 v8, -1
 v_mov_b32 v9, -1
 v_mov_b32 v10, -1
 v_mov_b32 v11, -1
 v_lshlrev_b32 v12, 4, v1
 s_mov_b64 s[32:33], exec
 v_cmp_gt_u32 vcc, 14336, v1
 s_and_b64 exec, s[32:33], vcc
 global_store_dwordx4 v12, v[8:11], s[30:31]
 v_add_u32 v12, 229376, v12
 v_cmp_gt_u32 vcc, 14336, v1
 s_and_b64 exec, s[32:33], vcc
 global_store_dwordx4 v12, v[8:11], s[30:31]
 v_add_u32 v12, 229376, v12
 v_cmp_gt_u32 vcc, 14336, v1
 s_and_b64 exec, s[32:33], vcc
 global_store_dwordx4 v12, v[8:11], s[30:31]
 v_add_u32 v12, 229376, v12
 v_cmp_gt_u32 vcc, 14336, v1
 s_and_b64 exec, s[32:33], vcc
 global_store_dwordx4 v12, v[8:11], s[30:31]
 v_add_u32 v12, 229376, v12
 v_cmp_gt_u32 vcc, 11840, v1
 s_and_b64 exec, s[32:33], vcc
 global_store_dwordx4 v12, v[8:11], s[30:31]
 v_add_u32 v12, 229376, v12
 s_mov_b64 exec, s[32:33]
 s_add_u32 s30, s4, 85138432
 s_addc_u32 s31, s5, 0
 v_lshlrev_b32 v12, 4, v1
 global_store_dwordx4 v12, v[8:11], s[30:31]
 v_add_u32 v12, 229376, v12
 v_cmp_gt_u32 vcc, 13888, v1
 s_and_b64 exec, s[32:33], vcc
 global_store_dwordx4 v12, v[8:11], s[30:31]
 s_mov_b64 exec, s[32:33]
 s_add_u32 s30, s4, 85590016
 s_addc_u32 s31, s5, 0
 v_mov_b32 v24, 0
 v_mov_b32 v25, 0
 v_mov_b32 v26, 0
 v_mov_b32 v27, 0
 v_lshlrev_b32 v12, 4, v1
 v_cmp_gt_u32 vcc, 4096, v1
 s_and_b64 exec, s[32:33], vcc
 global_store_dwordx4 v12, v[24:27], s[30:31]
 s_mov_b64 exec, s[32:33]
 s_cmp_lg_u32 s17, 0
 s_cbranch_scc1 K1_NOMEM
 v_and_b32 v13, 7, v0
 v_mul_u32_u24 v13, 896, v13
 v_lshrrev_b32 v14, 3, v0
 v_lshlrev_b32 v15, 4, v14
 v_add_u32 v15, v13, v15
 global_load_dwordx4 v[16:19], v15, s[6:7]
 s_add_u32 s30, s4, 13762560
 s_addc_u32 s31, s5, 0
 s_add_u32 s34, s4, 85131264
 s_addc_u32 s35, s5, 0
 s_waitcnt vmcnt(0)
 v_min_u32 v16, -2, v16
 v_min_u32 v17, -2, v17
 v_min_u32 v18, -2, v18
 v_min_u32 v19, -2, v19
 global_store_dwordx4 v12, v[16:19], s[30:31]
 global_store_dwordx4 v12, v[16:19], s[34:35]
K1_NOMEM:
 v_lshlrev_b32 v12, 4, v2
 s_load_dwordx2 s[36:37], s[0:1], 24
 v_mul_u32_u24 v13, 896, v3
 v_lshlrev_b32 v14, 3, v4
 v_add_u32 v13, v13, v14
 s_waitcnt lgkmcnt(0)
 s_add_u32 s20, s18, 0
 s_mul_i32 s21, s20, 2341
 s_lshr_b32 s21, s21, 16
 s_mul_i32 s22, s21, 28
 s_sub_u32 s22, s20, s22
 s_mul_i32 s21, s21, 28672
 s_lshl_b32 s22, s22, 5
 s_add_u32 s21, s21, s22
 s_add_u32 s30, s36, s21
 s_addc_u32 s31, s37, 0
 global_load_dwordx2 v[64:65], v13, s[30:31]
 global_load_dwordx2 v[66:67], v13, s[30:31] offset:16
 s_add_u32 s20, s18, 224
 s_mul_i32 s21, s20, 2341
 s_lshr_b32 s21, s21, 16
 s_mul_i32 s22, s21, 28
 s_sub_u32 s22, s20, s22
 s_mul_i32 s21, s21, 28672
 s_lshl_b32 s22, s22, 5
 s_add_u32 s21, s21, s22
 s_add_u32 s30, s36, s21
 s_addc_u32 s31, s37, 0
 global_load_dwordx2 v[68:69], v13, s[30:31]
 global_load_dwordx2 v[70:71], v13, s[30:31] offset:16
 s_add_u32 s20, s18, 448
 s_mul_i32 s21, s20, 2341
 s_lshr_b32 s21, s21, 16
 s_mul_i32 s22, s21, 28
 s_sub_u32 s22, s20, s22
 s_mul_i32 s21, s21, 28672
 s_lshl_b32 s22, s22, 5
 s_add_u32 s21, s21, s22
 s_add_u32 s30, s36, s21
 s_addc_u32 s31, s37, 0
 global_load_dwordx2 v[72:73], v13, s[30:31]
 global_load_dwordx2 v[74:75], v13, s[30:31] offset:16
 s_add_u32 s20, s18, 672
 s_mul_i32 s21, s20, 2341
 s_lshr_b32 s21, s21, 16
 s_mul_i32 s22, s21, 28
 s_sub_u32 s22, s20, s22
 s_mul_i32 s21, s21, 28672
 s_lshl_b32 s22, s22, 5
 s_add_u32 s21, s21, s22
 s_add_u32 s30, s36, s21
 s_addc_u32 s31, s37, 0
 global_load_dwordx2 v[76:77], v13, s[30:31]
 global_load_dwordx2 v[78:79], v13, s[30:31] offset:16
 s_add_u32 s20, s18, 896
 s_mul_i32 s21, s20, 2341
 s_lshr_b32 s21, s21, 16
 s_mul_i32 s22, s21, 28
 s_sub_u32 s22, s20, s22
 s_mul_i32 s21, s21, 28672
 s_lshl_b32 s22, s22, 5
 s_add_u32 s21, s21, s22
 s_add_u32 s30, s36, s21
 s_addc_u32 s31, s37, 0
 global_load_dwordx2 v[80:81], v13, s[30:31]
 global_load_dwordx2 v[82:83], v13, s[30:31] offset:16
 s_add_u32 s20, s18, 1120
 s_mul_i32 s21, s20, 2341
 s_lshr_b32 s21, s21, 16
 s_mul_i32 s22, s21, 28
 s_sub_u32 s22, s20, s22
 s_mul_i32 s21, s21, 28672
 s_lshl_b32 s22, s22, 5
 s_add_u32 s21, s21, s22
 s_add_u32 s30, s36, s21
 s_addc_u32 s31, s37, 0
 global_load_dwordx2 v[84:85], v13, s[30:31]
 global_load_dwordx2 v[86:87], v13, s[30:31] offset:16
 s_add_u32 s20, s18, 1344
 s_mul_i32 s21, s20, 2341
 s_lshr_b32 s21, s21, 16
 s_mul_i32 s22, s21, 28
 s_sub_u32 s22, s20, s22
 s_mul_i32 s21, s21, 28672
 s_lshl_b32 s22, s22, 5
 s_add_u32 s21, s21, s22
 s_add_u32 s30, s36, s21
 s_addc_u32 s31, s37, 0
 global_load_dwordx2 v[88:89], v13, s[30:31]
 global_load_dwordx2 v[90:91], v13, s[30:31] offset:16
 s_add_u32 s20, s18, 1568
 s_mul_i32 s21, s20, 2341
 s_lshr_b32 s21, s21, 16
 s_mul_i32 s22, s21, 28
 s_sub_u32 s22, s20, s22
 s_mul_i32 s21, s21, 28672
 s_lshl_b32 s22, s22, 5
 s_add_u32 s21, s21, s22
 s_add_u32 s30, s36, s21
 s_addc_u32 s31, s37, 0
 global_load_dwordx2 v[92:93], v13, s[30:31]
 global_load_dwordx2 v[94:95], v13, s[30:31] offset:16
 v_and_b32 v15, 15, v2
 v_bfe_u32 v16, v15, 2, 1
 v_lshlrev_b32 v16, 4, v16
 v_bfe_u32 v17, v15, 1, 1
 v_lshl_add_u32 v16, v17, 3, v16
 v_lshrrev_b32 v17, 3, v15
 v_lshl_add_u32 v16, v17, 2, v16
 v_and_b32 v17, 1, v15
 v_add_u32 v16, v16, v17
 v_mul_u32_u24 v16, 896, v16
 v_lshrrev_b32 v17, 4, v2
 v_lshl_add_u32 v28, v17, 4, v16
 v_and_b32 v17, 1, v17
 v_lshl_add_u32 v29, v17, 4, v16
 v_mul_u32_u24 v17, 1792, v4
 v_add_u32 v29, v29, v17
 s_add_u32 s20, s18, 0
 s_mul_i32 s21, s20, 2341
 s_lshr_b32 s21, s21, 16
 s_mul_i32 s22, s21, 28
 s_sub_u32 s22, s20, s22
 s_mul_i32 s21, s21, 28672
 s_mul_i32 s23, s22, 9363
 s_lshr_b32 s23, s23, 16
 s_mul_i32 s24, s23, 7
 s_sub_u32 s22, s22, s24
 s_mul_i32 s23, s23, 224
 s_add_u32 s21, s21, s23
 s_lshr_b32 s23, s22, 1
 s_lshl_b32 s23, s23, 6
 s_add_u32 s21, s21, s23
 s_and_b32 s23, s22, 1
 s_mul_i32 s23, s23, 1792
 s_add_u32 s21, s21, s23
 s_add_u32 s30, s36, s21
 s_addc_u32 s31, s37, 0
 s_cmp_eq_u32 s22, 6
 s_cselect_b64 vcc, -1, 0
 v_cndmask_b32 v30, v28, v29, vcc
 global_load_dwordx4 v[96:99], v30, s[30:31]
 s_add_u32 s20, s18, 224
 s_mul_i32 s21, s20, 2341
 s_lshr_b32 s21, s21, 16
 s_mul_i32 s22, s21, 28
 s_sub_u32 s22, s20, s22
 s_mul_i32 s21, s21, 28672
 s_mul_i32 s23, s22, 9363
 s_lshr_b32 s23, s23, 16
 s_mul_i32 s24, s23, 7
 s_sub_u32 s22, s22, s24
 s_mul_i32 s23, s23, 224
 s_add_u32 s21, s21, s23
 s_lshr_b32 s23, s22, 1
 s_lshl_b32 s23, s23, 6
 s_add_u32 s21, s21, s23
 s_and_b32 s23, s22, 1
 s_mul_i32 s23, s23, 1792
 s_add_u32 s21, s21, s23
 s_add_u32 s30, s36, s21
 s_addc_u32 s31, s37, 0
 s_cmp_eq_u32 s22, 6
 s_cselect_b64 vcc, -1, 0
 v_cndmask_b32 v30, v28, v29, vcc
 global_load_dwordx4 v[100:103], v30, s[30:31]
 s_add_u32 s20, s18, 448
 s_mul_i32 s21, s20, 2341
 s_lshr_b32 s21, s21, 16
 s_mul_i32 s22, s21, 28
 s_sub_u32 s22, s20, s22
 s_mul_i32 s21, s21, 28672
 s_mul_i32 s23, s22, 9363
 s_lshr_b32 s23, s23, 16
 s_mul_i32 s24, s23, 7
 s_sub_u32 s22, s22, s24
 s_mul_i32 s23, s23, 224
 s_add_u32 s21, s21, s23
 s_lshr_b32 s23, s22, 1
 s_lshl_b32 s23, s23, 6
 s_add_u32 s21, s21, s23
 s_and_b32 s23, s22, 1
 s_mul_i32 s23, s23, 1792
 s_add_u32 s21, s21, s23
 s_add_u32 s30, s36, s21
 s_addc_u32 s31, s37, 0
 s_cmp_eq_u32 s22, 6
 s_cselect_b64 vcc, -1, 0
 v_cndmask_b32 v30, v28, v29, vcc
 global_load_dwordx4 v[104:107], v30, s[30:31]
 s_add_u32 s20, s18, 672
 s_mul_i32 s21, s20, 2341
 s_lshr_b32 s21, s21, 16
 s_mul_i32 s22, s21, 28
 s_sub_u32 s22, s20, s22
 s_mul_i32 s21, s21, 28672
 s_mul_i32 s23, s22, 9363
 s_lshr_b32 s23, s23, 16
 s_mul_i32 s24, s23, 7
 s_sub_u32 s22, s22, s24
 s_mul_i32 s23, s23, 224
 s_add_u32 s21, s21, s23
 s_lshr_b32 s23, s22, 1
 s_lshl_b32 s23, s23, 6
 s_add_u32 s21, s21, s23
 s_and_b32 s23, s22, 1
 s_mul_i32 s23, s23, 1792
 s_add_u32 s21, s21, s23
 s_add_u32 s30, s36, s21
 s_addc_u32 s31, s37, 0
 s_cmp_eq_u32 s22, 6
 s_cselect_b64 vcc, -1, 0
 v_cndmask_b32 v30, v28, v29, vcc
 global_load_dwordx4 v[108:111], v30, s[30:31]
 s_add_u32 s20, s18, 896
 s_mul_i32 s21, s20, 2341
 s_lshr_b32 s21, s21, 16
 s_mul_i32 s22, s21, 28
 s_sub_u32 s22, s20, s22
 s_mul_i32 s21, s21, 28672
 s_mul_i32 s23, s22, 9363
 s_lshr_b32 s23, s23, 16
 s_mul_i32 s24, s23, 7
 s_sub_u32 s22, s22, s24
 s_mul_i32 s23, s23, 224
 s_add_u32 s21, s21, s23
 s_lshr_b32 s23, s22, 1
 s_lshl_b32 s23, s23, 6
 s_add_u32 s21, s21, s23
 s_and_b32 s23, s22, 1
 s_mul_i32 s23, s23, 1792
 s_add_u32 s21, s21, s23
 s_add_u32 s30, s36, s21
 s_addc_u32 s31, s37, 0
 s_cmp_eq_u32 s22, 6
 s_cselect_b64 vcc, -1, 0
 v_cndmask_b32 v30, v28, v29, vcc
 global_load_dwordx4 v[112:115], v30, s[30:31]
 s_add_u32 s20, s18, 1120
 s_mul_i32 s21, s20, 2341
 s_lshr_b32 s21, s21, 16
 s_mul_i32 s22, s21, 28
 s_sub_u32 s22, s20, s22
 s_mul_i32 s21, s21, 28672
 s_mul_i32 s23, s22, 9363
 s_lshr_b32 s23, s23, 16
 s_mul_i32 s24, s23, 7
 s_sub_u32 s22, s22, s24
 s_mul_i32 s23, s23, 224
 s_add_u32 s21, s21, s23
 s_lshr_b32 s23, s22, 1
 s_lshl_b32 s23, s23, 6
 s_add_u32 s21, s21, s23
 s_and_b32 s23, s22, 1
 s_mul_i32 s23, s23, 1792
 s_add_u32 s21, s21, s23
 s_add_u32 s30, s36, s21
 s_addc_u32 s31, s37, 0
 s_cmp_eq_u32 s22, 6
 s_cselect_b64 vcc, -1, 0
 v_cndmask_b32 v30, v28, v29, vcc
 global_load_dwordx4 v[116:119], v30, s[30:31]
 s_add_u32 s20, s18, 1344
 s_mul_i32 s21, s20, 2341
 s_lshr_b32 s21, s21, 16
 s_mul_i32 s22, s21, 28
 s_sub_u32 s22, s20, s22
 s_mul_i32 s21, s21, 28672
 s_mul_i32 s23, s22, 9363
 s_lshr_b32 s23, s23, 16
 s_mul_i32 s24, s23, 7
 s_sub_u32 s22, s22, s24
 s_mul_i32 s23, s23, 224
 s_add_u32 s21, s21, s23
 s_lshr_b32 s23, s22, 1
 s_lshl_b32 s23, s23, 6
 s_add_u32 s21, s21, s23
 s_and_b32 s23, s22, 1
 s_mul_i32 s23, s23, 1792
 s_add_u32 s21, s21, s23
 s_add_u32 s30, s36, s21
 s_addc_u32 s31, s37, 0
 s_cmp_eq_u32 s22, 6
 s_cselect_b64 vcc, -1, 0
 v_cndmask_b32 v30, v28, v29, vcc
 global_load_dwordx4 v[120:123], v30, s[30:31]
 s_add_u32 s20, s18, 1568
 s_mul_i32 s21, s20, 2341
 s_lshr_b32 s21, s21, 16
 s_mul_i32 s22, s21, 28
 s_sub_u32 s22, s20, s22
 s_mul_i32 s21, s21, 28672
 s_mul_i32 s23, s22, 9363
 s_lshr_b32 s23, s23, 16
 s_mul_i32 s24, s23, 7
 s_sub_u32 s22, s22, s24
 s_mul_i32 s23, s23, 224
 s_add_u32 s21, s21, s23
 s_lshr_b32 s23, s22, 1
 s_lshl_b32 s23, s23, 6
 s_add_u32 s21, s21, s23
 s_and_b32 s23, s22, 1
 s_mul_i32 s23, s23, 1792
 s_add_u32 s21, s21, s23
 s_add_u32 s30, s36, s21
 s_addc_u32 s31, s37, 0
 s_cmp_eq_u32 s22, 6
 s_cselect_b64 vcc, -1, 0
 v_cndmask_b32 v30, v28, v29, vcc
 global_load_dwordx4 v[124:127], v30, s[30:31]
 s_add_u32 s20, s18, 0
 s_mul_i32 s21, s20, 2341
 s_lshr_b32 s21, s21, 16
 s_mul_i32 s22, s21, 28
 s_sub_u32 s22, s20, s22
 s_lshr_b32 s23, s21, 1
 s_lshl_b32 s23, s23, 5
 v_add_u32 v13, s23, v5
 s_lshl_b32 s22, s22, 4
 v_lshlrev_b32 v14, 3, v4
 v_add_u32 v14, s22, v14
 s_and_b32 s21, s21, 1
 s_cmp_eq_u32 s21, 0
 s_cselect_b32 s21, 0x3e800000, 0
 v_cmp_ge_u32 vcc, 224, v13
 s_nop 1
 v_cndmask_b32 v15, 0, 1.0, vcc
 v_add_u32 v16, 0, v14
 v_mul_u32_u24 v16, v13, v16
 v_lshrrev_b32 v17, 6, v16
 v_mul_u32_u24 v17, s26, v17
 v_lshrrev_b32 v17, 16, v17
 v_mul_u32_u24 v17, s27, v17
 v_sub_u32 v16, v16, v17
 v_cvt_f32_u32 v16, v16
 v_mov_b32 v17, s21
 v_fma_f32 v16, v16, s28, v17
 v_sin_f32 v16, v16
 s_nop 0
 v_mul_f32 v20, v16, v15
 v_add_u32 v16, 1, v14
 v_mul_u32_u24 v16, v13, v16
 v_lshrrev_b32 v17, 6, v16
 v_mul_u32_u24 v17, s26, v17
 v_lshrrev_b32 v17, 16, v17
 v_mul_u32_u24 v17, s27, v17
 v_sub_u32 v16, v16, v17
 v_cvt_f32_u32 v16, v16
 v_mov_b32 v17, s21
 v_fma_f32 v16, v16, s28, v17
 v_sin_f32 v16, v16
 s_nop 0
 v_mul_f32 v21, v16, v15
 v_add_u32 v16, 2, v14
 v_mul_u32_u24 v16, v13, v16
 v_lshrrev_b32 v17, 6, v16
 v_mul_u32_u24 v17, s26, v17
 v_lshrrev_b32 v17, 16, v17
 v_mul_u32_u24 v17, s27, v17
 v_sub_u32 v16, v16, v17
 v_cvt_f32_u32 v16, v16
 v_mov_b32 v17, s21
 v_fma_f32 v16, v16, s28, v17
 v_sin_f32 v16, v16
 s_nop 0
 v_mul_f32 v22, v16, v15
 v_add_u32 v16, 3, v14
 v_mul_u32_u24 v16, v13, v16
 v_lshrrev_b32 v17, 6, v16
 v_mul_u32_u24 v17, s26, v17
 v_lshrrev_b32 v17, 16, v17
 v_mul_u32_u24 v17, s27, v17
 v_sub_u32 v16, v16, v17
 v_cvt_f32_u32 v16, v16
 v_mov_b32 v17, s21
 v_fma_f32 v16, v16, s28, v17
 v_sin_f32 v16, v16
 s_nop 0
 v_mul_f32 v23, v16, v15
 v_add_u32 v16, 4, v14
 v_mul_u32_u24 v16, v13, v16
 v_lshrrev_b32 v17, 6, v16
 v_mul_u32_u24 v17, s26, v17
 v_lshrrev_b32 v17, 16, v17
 v_mul_u32_u24 v17, s27, v17
 v_sub_u32 v16, v16, v17
 v_cvt_f32_u32 v16, v16
 v_mov_b32 v17, s21
 v_fma_f32 v16, v16, s28, v17
 v_sin_f32 v16, v16
 s_nop 0
 v_mul_f32 v24, v16, v15
 v_add_u32 v16, 5, v14
 v_mul_u32_u24 v16, v13, v16
 v_lshrrev_b32 v17, 6, v16
 v_mul_u32_u24 v17, s26, v17
 v_lshrrev_b32 v17, 16, v17
 v_mul_u32_u24 v17, s27, v17
 v_sub_u32 v16, v16, v17
 v_cvt_f32_u32 v16, v16
 v_mov_b32 v17, s21
 v_fma_f32 v16, v16, s28, v17
 v_sin_f32 v16, v16
 s_nop 0
 v_mul_f32 v25, v16, v15
 v_add_u32 v16, 6, v14
 v_mul_u32_u24 v16, v13, v16
 v_lshrrev_b32 v17, 6, v16
 v_mul_u32_u24 v17, s26, v17
 v_lshrrev_b32 v17, 16, v17
 v_mul_u32_u24 v17, s27, v17
 v_sub_u32 v16, v16, v17
 v_cvt_f32_u32 v16, v16
 v_mov_b32 v17, s21
 v_fma_f32 v16, v16, s28, v17
 v_sin_f32 v16, v16
 s_nop 0
 v_mul_f32 v26, v16, v15
 v_add_u32 v16, 7, v14
 v_mul_u32_u24 v16, v13, v16
 v_lshrrev_b32 v17, 6, v16
 v_mul_u32_u24 v17, s26, v17
 v_lshrrev_b32 v17, 16, v17
 v_mul_u32_u24 v17, s27, v17
 v_sub_u32 v16, v16, v17
 v_cvt_f32_u32 v16, v16
 v_mov_b32 v17, s21
 v_fma_f32 v16, v16, s28, v17
 v_sin_f32 v16, v16
 s_nop 0
 v_mul_f32 v27, v16, v15
 v_cvt_pk_bf16_f32 v32, v20, v21
 v_cvt_pk_bf16_f32 v33, v22, v23
 v_cvt_pk_bf16_f32 v34, v24, v25
 v_cvt_pk_bf16_f32 v35, v26, v27
 s_lshl_b32 s20, s20, 10
 s_add_u32 s20, s20, 12845056
 s_add_u32 s30, s4, s20
 s_addc_u32 s31, s5, 0
 global_store_dwordx4 v12, v[32:35], s[30:31]
 s_add_u32 s20, s18, 224
 s_mul_i32 s21, s20, 2341
 s_lshr_b32 s21, s21, 16
 s_mul_i32 s22, s21, 28
 s_sub_u32 s22, s20, s22
 s_lshr_b32 s23, s21, 1
 s_lshl_b32 s23, s23, 5
 v_add_u32 v13, s23, v5
 s_lshl_b32 s22, s22, 4
 v_lshlrev_b32 v14, 3, v4
 v_add_u32 v14, s22, v14
 s_and_b32 s21, s21, 1
 s_cmp_eq_u32 s21, 0
 s_cselect_b32 s21, 0x3e800000, 0
 v_cmp_ge_u32 vcc, 224, v13
 s_nop 1
 v_cndmask_b32 v15, 0, 1.0, vcc
 v_add_u32 v16, 0, v14
 v_mul_u32_u24 v16, v13, v16
 v_lshrrev_b32 v17, 6, v16
 v_mul_u32_u24 v17, s26, v17
 v_lshrrev_b32 v17, 16, v17
 v_mul_u32_u24 v17, s27, v17
 v_sub_u32 v16, v16, v17
 v_cvt_f32_u32 v16, v16
 v_mov_b32 v17, s21
 v_fma_f32 v16, v16, s28, v17
 v_sin_f32 v16, v16
 s_nop 0
 v_mul_f32 v20, v16, v15
 v_add_u32 v16, 1, v14
 v_mul_u32_u24 v16, v13, v16
 v_lshrrev_b32 v17, 6, v16
 v_mul_u32_u24 v17, s26, v17
 v_lshrrev_b32 v17, 16, v17
 v_mul_u32_u24 v17, s27, v17
 v_sub_u32 v16, v16, v17
 v_cvt_f32_u32 v16, v16
 v_mov_b32 v17, s21
 v_fma_f32 v16, v16, s28, v17
 v_sin_f32 v16, v16
 s_nop 0
 v_mul_f32 v21, v16, v15
 v_add_u32 v16, 2, v14
 v_mul_u32_u24 v16, v13, v16
 v_lshrrev_b32 v17, 6, v16
 v_mul_u32_u24 v17, s26, v17
 v_lshrrev_b32 v17, 16, v17
 v_mul_u32_u24 v17, s27, v17
 v_sub_u32 v16, v16, v17
 v_cvt_f32_u32 v16, v16
 v_mov_b32 v17, s21
 v_fma_f32 v16, v16, s28, v17
 v_sin_f32 v16, v16
 s_nop 0
 v_mul_f32 v22, v16, v15
 v_add_u32 v16, 3, v14
 v_mul_u32_u24 v16, v13, v16
 v_lshrrev_b32 v17, 6, v16
 v_mul_u32_u24 v17, s26, v17
 v_lshrrev_b32 v17, 16, v17
 v_mul_u32_u24 v17, s27, v17
 v_sub_u32 v16, v16, v17
 v_cvt_f32_u32 v16, v16
 v_mov_b32 v17, s21
 v_fma_f32 v16, v16, s28, v17
 v_sin_f32 v16, v16
 s_nop 0
 v_mul_f32 v23, v16, v15
 v_add_u32 v16, 4, v14
 v_mul_u32_u24 v16, v13, v16
 v_lshrrev_b32 v17, 6, v16
 v_mul_u32_u24 v17, s26, v17
 v_lshrrev_b32 v17, 16, v17
 v_mul_u32_u24 v17, s27, v17
 v_sub_u32 v16, v16, v17
 v_cvt_f32_u32 v16, v16
 v_mov_b32 v17, s21
 v_fma_f32 v16, v16, s28, v17
 v_sin_f32 v16, v16
 s_nop 0
 v_mul_f32 v24, v16, v15
 v_add_u32 v16, 5, v14
 v_mul_u32_u24 v16, v13, v16
 v_lshrrev_b32 v17, 6, v16
 v_mul_u32_u24 v17, s26, v17
 v_lshrrev_b32 v17, 16, v17
 v_mul_u32_u24 v17, s27, v17
 v_sub_u32 v16, v16, v17
 v_cvt_f32_u32 v16, v16
 v_mov_b32 v17, s21
 v_fma_f32 v16, v16, s28, v17
 v_sin_f32 v16, v16
 s_nop 0
 v_mul_f32 v25, v16, v15
 v_add_u32 v16, 6, v14
 v_mul_u32_u24 v16, v13, v16
 v_lshrrev_b32 v17, 6, v16
 v_mul_u32_u24 v17, s26, v17
 v_lshrrev_b32 v17, 16, v17
 v_mul_u32_u24 v17, s27, v17
 v_sub_u32 v16, v16, v17
 v_cvt_f32_u32 v16, v16
 v_mov_b32 v17, s21
 v_fma_f32 v16, v16, s28, v17
 v_sin_f32 v16, v16
 s_nop 0
 v_mul_f32 v26, v16, v15
 v_add_u32 v16, 7, v14
 v_mul_u32_u24 v16, v13, v16
 v_lshrrev_b32 v17, 6, v16
 v_mul_u32_u24 v17, s26, v17
 v_lshrrev_b32 v17, 16, v17
 v_mul_u32_u24 v17, s27, v17
 v_sub_u32 v16, v16, v17
 v_cvt_f32_u32 v16, v16
 v_mov_b32 v17, s21
 v_fma_f32 v16, v16, s28, v17
 v_sin_f32 v16, v16
 s_nop 0
 v_mul_f32 v27, v16, v15
 v_cvt_pk_bf16_f32 v36, v20, v21
 v_cvt_pk_bf16_f32 v37, v22, v23
 v_cvt_pk_bf16_f32 v38, v24, v25
 v_cvt_pk_bf16_f32 v39, v26, v27
 s_lshl_b32 s20, s20, 10
 s_add_u32 s20, s20, 12845056
 s_add_u32 s30, s4, s20
 s_addc_u32 s31, s5, 0
 global_store_dwordx4 v12, v[36:39], s[30:31]
 s_add_u32 s20, s18, 0
 s_lshr_b32 s21, s20, 5
 s_lshl_b32 s21, s21, 5
 v_add_u32 v13, s21, v5
 s_and_b32 s22, s20, 31
 s_lshr_b32 s23, s22, 3
 s_lshl_b32 s23, s23, 6
 s_bfe_u32 s21, s22, 0x10002
 s_add_u32 s23, s23, s21
 s_and_b32 s21, s22, 1
 s_lshl_b32 s21, s21, 5
 s_add_u32 s23, s23, s21
 v_lshlrev_b32 v14, 3, v4
 v_add_u32 v14, s23, v14
 s_bitcmp1_b32 s22, 1
 s_cselect_b32 s21, 0x3f000000, 0x3e800000
 v_add_u32 v18, 0, v14
 v_mul_u32_u24 v16, v13, v18
 v_lshrrev_b32 v17, 6, v16
 v_mul_u32_u24 v17, s26, v17
 v_lshrrev_b32 v17, 16, v17
 v_mul_u32_u24 v17, s27, v17
 v_sub_u32 v16, v16, v17
 v_cvt_f32_u32 v16, v16
 v_mov_b32 v17, s21
 v_fma_f32 v16, v16, s28, v17
 v_sin_f32 v16, v16
 v_mov_b32 v15, 907168037
 v_mov_b32 v17, 898779429
 v_cmp_eq_u32 vcc, 0, v18
 s_nop 1
 v_cndmask_b32 v15, v15, v17, vcc
 v_cmp_eq_u32 vcc, 224, v18
 s_nop 1
 v_cndmask_b32 v15, v15, v17, vcc
 v_cmp_gt_u32 vcc, 225, v18
 s_nop 1
 v_cndmask_b32 v15, 0, v15, vcc
 v_mul_f32 v20, v16, v15
 v_add_u32 v18, 2, v14
 v_mul_u32_u24 v16, v13, v18
 v_lshrrev_b32 v17, 6, v16
 v_mul_u32_u24 v17, s26, v17
 v_lshrrev_b32 v17, 16, v17
 v_mul_u32_u24 v17, s27, v17
 v_sub_u32 v16, v16, v17
 v_cvt_f32_u32 v16, v16
 v_mov_b32 v17, s21
 v_fma_f32 v16, v16, s28, v17
 v_sin_f32 v16, v16
 v_mov_b32 v15, 907168037
 v_mov_b32 v17, 898779429
 v_cmp_eq_u32 vcc, 0, v18
 s_nop 1
 v_cndmask_b32 v15, v15, v17, vcc
 v_cmp_eq_u32 vcc, 224, v18
 s_nop 1
 v_cndmask_b32 v15, v15, v17, vcc
 v_cmp_gt_u32 vcc, 225, v18
 s_nop 1
 v_cndmask_b32 v15, 0, v15, vcc
 v_mul_f32 v21, v16, v15
 v_add_u32 v18, 4, v14
 v_mul_u32_u24 v16, v13, v18
 v_lshrrev_b32 v17, 6, v16
 v_mul_u32_u24 v17, s26, v17
 v_lshrrev_b32 v17, 16, v17
 v_mul_u32_u24 v17, s27, v17
 v_sub_u32 v16, v16, v17
 v_cvt_f32_u32 v16, v16
 v_mov_b32 v17, s21
 v_fma_f32 v16, v16, s28, v17
 v_sin_f32 v16, v16
 v_mov_b32 v15, 907168037
 v_mov_b32 v17, 898779429
 v_cmp_eq_u32 vcc, 0, v18
 s_nop 1
 v_cndmask_b32 v15, v15, v17, vcc
 v_cmp_eq_u32 vcc, 224, v18
 s_nop 1
 v_cndmask_b32 v15, v15, v17, vcc
 v_cmp_gt_u32 vcc, 225, v18
 s_nop 1
 v_cndmask_b32 v15, 0, v15, vcc
 v_mul_f32 v22, v16, v15
 v_add_u32 v18, 6, v14
 v_mul_u32_u24 v16, v13, v18
 v_lshrrev_b32 v17, 6, v16
 v_mul_u32_u24 v17, s26, v17
 v_lshrrev_b32 v17, 16, v17
 v_mul_u32_u24 v17, s27, v17
 v_sub_u32 v16, v16, v17
 v_cvt_f32_u32 v16, v16
 v_mov_b32 v17, s21
 v_fma_f32 v16, v16, s28, v17
 v_sin_f32 v16, v16
 v_mov_b32 v15, 907168037
 v_mov_b32 v17, 898779429
 v_cmp_eq_u32 vcc, 0, v18
 s_nop 1
 v_cndmask_b32 v15, v15, v17, vcc
 v_cmp_eq_u32 vcc, 224, v18
 s_nop 1
 v_cndmask_b32 v15, v15, v17, vcc
 v_cmp_gt_u32 vcc, 225, v18
 s_nop 1
 v_cndmask_b32 v15, 0, v15, vcc
 v_mul_f32 v23, v16, v15
 v_add_u32 v18, 16, v14
 v_mul_u32_u24 v16, v13, v18
 v_lshrrev_b32 v17, 6, v16
 v_mul_u32_u24 v17, s26, v17
 v_lshrrev_b32 v17, 16, v17
 v_mul_u32_u24 v17, s27, v17
 v_sub_u32 v16, v16, v17
 v_cvt_f32_u32 v16, v16
 v_mov_b32 v17, s21
 v_fma_f32 v16, v16, s28, v17
 v_sin_f32 v16, v16
 v_mov_b32 v15, 907168037
 v_mov_b32 v17, 898779429
 v_cmp_eq_u32 vcc, 0, v18
 s_nop 1
 v_cndmask_b32 v15, v15, v17, vcc
 v_cmp_eq_u32 vcc, 224, v18
 s_nop 1
 v_cndmask_b32 v15, v15, v17, vcc
 v_cmp_gt_u32 vcc, 225, v18
 s_nop 1
 v_cndmask_b32 v15, 0, v15, vcc
 v_mul_f32 v24, v16, v15
 v_add_u32 v18, 18, v14
 v_mul_u32_u24 v16, v13, v18
 v_lshrrev_b32 v17, 6, v16
 v_mul_u32_u24 v17, s26, v17
 v_lshrrev_b32 v17, 16, v17
 v_mul_u32_u24 v17, s27, v17
 v_sub_u32 v16, v16, v17
 v_cvt_f32_u32 v16, v16
 v_mov_b32 v17, s21
 v_fma_f32 v16, v16, s28, v17
 v_sin_f32 v16, v16
 v_mov_b32 v15, 907168037
 v_mov_b32 v17, 898779429
 v_cmp_eq_u32 vcc, 0, v18
 s_nop 1
 v_cndmask_b32 v15, v15, v17, vcc
 v_cmp_eq_u32 vcc, 224, v18
 s_nop 1
 v_cndmask_b32 v15, v15, v17, vcc
 v_cmp_gt_u32 vcc, 225, v18
 s_nop 1
 v_cndmask_b32 v15, 0, v15, vcc
 v_mul_f32 v25, v16, v15
 v_add_u32 v18, 20, v14
 v_mul_u32_u24 v16, v13, v18
 v_lshrrev_b32 v17, 6, v16
 v_mul_u32_u24 v17, s26, v17
 v_lshrrev_b32 v17, 16, v17
 v_mul_u32_u24 v17, s27, v17
 v_sub_u32 v16, v16, v17
 v_cvt_f32_u32 v16, v16
 v_mov_b32 v17, s21
 v_fma_f32 v16, v16, s28, v17
 v_sin_f32 v16, v16
 v_mov_b32 v15, 907168037
 v_mov_b32 v17, 898779429
 v_cmp_eq_u32 vcc, 0, v18
 s_nop 1
 v_cndmask_b32 v15, v15, v17, vcc
 v_cmp_eq_u32 vcc, 224, v18
 s_nop 1
 v_cndmask_b32 v15, v15, v17, vcc
 v_cmp_gt_u32 vcc, 225, v18
 s_nop 1
 v_cndmask_b32 v15, 0, v15, vcc
 v_mul_f32 v26, v16, v15
 v_add_u32 v18, 22, v14
 v_mul_u32_u24 v16, v13, v18
 v_lshrrev_b32 v17, 6, v16
 v_mul_u32_u24 v17, s26, v17
 v_lshrrev_b32 v17, 16, v17
 v_mul_u32_u24 v17, s27, v17
 v_sub_u32 v16, v16, v17
 v_cvt_f32_u32 v16, v16
 v_mov_b32 v17, s21
 v_fma_f32 v16, v16, s28, v17
 v_sin_f32 v16, v16
 v_mov_b32 v15, 907168037
 v_mov_b32 v17, 898779429
 v_cmp_eq_u32 vcc, 0, v18
 s_nop 1
 v_cndmask_b32 v15, v15, v17, vcc
 v_cmp_eq_u32 vcc, 224, v18
 s_nop 1
 v_cndmask_b32 v15, v15, v17, vcc
 v_cmp_gt_u32 vcc, 225, v18
 s_nop 1
 v_cndmask_b32 v15, 0, v15, vcc
 v_mul_f32 v27, v16, v15
 v_cvt_pk_bf16_f32 v40, v20, v21
 v_cvt_pk_bf16_f32 v41, v22, v23
 v_cvt_pk_bf16_f32 v42, v24, v25
 v_cvt_pk_bf16_f32 v43, v26, v27
 s_lshl_b32 s20, s20, 10
 s_add_u32 s20, s20, 13303808
 s_add_u32 s30, s4, s20
 s_addc_u32 s31, s5, 0
 global_store_dwordx4 v12, v[40:43], s[30:31]
 s_add_u32 s20, s18, 224
 s_lshr_b32 s21, s20, 5
 s_lshl_b32 s21, s21, 5
 v_add_u32 v13, s21, v5
 s_and_b32 s22, s20, 31
 s_lshr_b32 s23, s22, 3
 s_lshl_b32 s23, s23, 6
 s_bfe_u32 s21, s22, 0x10002
 s_add_u32 s23, s23, s21
 s_and_b32 s21, s22, 1
 s_lshl_b32 s21, s21, 5
 s_add_u32 s23, s23, s21
 v_lshlrev_b32 v14, 3, v4
 v_add_u32 v14, s23, v14
 s_bitcmp1_b32 s22, 1
 s_cselect_b32 s21, 0x3f000000, 0x3e800000
 v_add_u32 v18, 0, v14
 v_mul_u32_u24 v16, v13, v18
 v_lshrrev_b32 v17, 6, v16
 v_mul_u32_u24 v17, s26, v17
 v_lshrrev_b32 v17, 16, v17
 v_mul_u32_u24 v17, s27, v17
 v_sub_u32 v16, v16, v17
 v_cvt_f32_u32 v16, v16
 v_mov_b32 v17, s21
 v_fma_f32 v16, v16, s28, v17
 v_sin_f32 v16, v16
 v_mov_b32 v15, 907168037
 v_mov_b32 v17, 898779429
 v_cmp_eq_u32 vcc, 0, v18
 s_nop 1
 v_cndmask_b32 v15, v15, v17, vcc
 v_cmp_eq_u32 vcc, 224, v18
 s_nop 1
 v_cndmask_b32 v15, v15, v17, vcc
 v_cmp_gt_u32 vcc, 225, v18
 s_nop 1
 v_cndmask_b32 v15, 0, v15, vcc
 v_mul_f32 v20, v16, v15
 v_add_u32 v18, 2, v14
 v_mul_u32_u24 v16, v13, v18
 v_lshrrev_b32 v17, 6, v16
 v_mul_u32_u24 v17, s26, v17
 v_lshrrev_b32 v17, 16, v17
 v_mul_u32_u24 v17, s27, v17
 v_sub_u32 v16, v16, v17
 v_cvt_f32_u32 v16, v16
 v_mov_b32 v17, s21
 v_fma_f32 v16, v16, s28, v17
 v_sin_f32 v16, v16
 v_mov_b32 v15, 907168037
 v_mov_b32 v17, 898779429
 v_cmp_eq_u32 vcc, 0, v18
 s_nop 1
 v_cndmask_b32 v15, v15, v17, vcc
 v_cmp_eq_u32 vcc, 224, v18
 s_nop 1
 v_cndmask_b32 v15, v15, v17, vcc
 v_cmp_gt_u32 vcc, 225, v18
 s_nop 1
 v_cndmask_b32 v15, 0, v15, vcc
 v_mul_f32 v21, v16, v15
 v_add_u32 v18, 4, v14
 v_mul_u32_u24 v16, v13, v18
 v_lshrrev_b32 v17, 6, v16
 v_mul_u32_u24 v17, s26, v17
 v_lshrrev_b32 v17, 16, v17
 v_mul_u32_u24 v17, s27, v17
 v_sub_u32 v16, v16, v17
 v_cvt_f32_u32 v16, v16
 v_mov_b32 v17, s21
 v_fma_f32 v16, v16, s28, v17
 v_sin_f32 v16, v16
 v_mov_b32 v15, 907168037
 v_mov_b32 v17, 898779429
 v_cmp_eq_u32 vcc, 0, v18
 s_nop 1
 v_cndmask_b32 v15, v15, v17, vcc
 v_cmp_eq_u32 vcc, 224, v18
 s_nop 1
 v_cndmask_b32 v15, v15, v17, vcc
 v_cmp_gt_u32 vcc, 225, v18
 s_nop 1
 v_cndmask_b32 v15, 0, v15, vcc
 v_mul_f32 v22, v16, v15
 v_add_u32 v18, 6, v14
 v_mul_u32_u24 v16, v13, v18
 v_lshrrev_b32 v17, 6, v16
 v_mul_u32_u24 v17, s26, v17
 v_lshrrev_b32 v17, 16, v17
 v_mul_u32_u24 v17, s27, v17
 v_sub_u32 v16, v16, v17
 v_cvt_f32_u32 v16, v16
 v_mov_b32 v17, s21
 v_fma_f32 v16, v16, s28, v17
 v_sin_f32 v16, v16
 v_mov_b32 v15, 907168037
 v_mov_b32 v17, 898779429
 v_cmp_eq_u32 vcc, 0, v18
 s_nop 1
 v_cndmask_b32 v15, v15, v17, vcc
 v_cmp_eq_u32 vcc, 224, v18
 s_nop 1
 v_cndmask_b32 v15, v15, v17, vcc
 v_cmp_gt_u32 vcc, 225, v18
 s_nop 1
 v_cndmask_b32 v15, 0, v15, vcc
 v_mul_f32 v23, v16, v15
 v_add_u32 v18, 16, v14
 v_mul_u32_u24 v16, v13, v18
 v_lshrrev_b32 v17, 6, v16
 v_mul_u32_u24 v17, s26, v17
 v_lshrrev_b32 v17, 16, v17
 v_mul_u32_u24 v17, s27, v17
 v_sub_u32 v16, v16, v17
 v_cvt_f32_u32 v16, v16
 v_mov_b32 v17, s21
 v_fma_f32 v16, v16, s28, v17
 v_sin_f32 v16, v16
 v_mov_b32 v15, 907168037
 v_mov_b32 v17, 898779429
 v_cmp_eq_u32 vcc, 0, v18
 s_nop 1
 v_cndmask_b32 v15, v15, v17, vcc
 v_cmp_eq_u32 vcc, 224, v18
 s_nop 1
 v_cndmask_b32 v15, v15, v17, vcc
 v_cmp_gt_u32 vcc, 225, v18
 s_nop 1
 v_cndmask_b32 v15, 0, v15, vcc
 v_mul_f32 v24, v16, v15
 v_add_u32 v18, 18, v14
 v_mul_u32_u24 v16, v13, v18
 v_lshrrev_b32 v17, 6, v16
 v_mul_u32_u24 v17, s26, v17
 v_lshrrev_b32 v17, 16, v17
 v_mul_u32_u24 v17, s27, v17
 v_sub_u32 v16, v16, v17
 v_cvt_f32_u32 v16, v16
 v_mov_b32 v17, s21
 v_fma_f32 v16, v16, s28, v17
 v_sin_f32 v16, v16
 v_mov_b32 v15, 907168037
 v_mov_b32 v17, 898779429
 v_cmp_eq_u32 vcc, 0, v18
 s_nop 1
 v_cndmask_b32 v15, v15, v17, vcc
 v_cmp_eq_u32 vcc, 224, v18
 s_nop 1
 v_cndmask_b32 v15, v15, v17, vcc
 v_cmp_gt_u32 vcc, 225, v18
 s_nop 1
 v_cndmask_b32 v15, 0, v15, vcc
 v_mul_f32 v25, v16, v15
 v_add_u32 v18, 20, v14
 v_mul_u32_u24 v16, v13, v18
 v_lshrrev_b32 v17, 6, v16
 v_mul_u32_u24 v17, s26, v17
 v_lshrrev_b32 v17, 16, v17
 v_mul_u32_u24 v17, s27, v17
 v_sub_u32 v16, v16, v17
 v_cvt_f32_u32 v16, v16
 v_mov_b32 v17, s21
 v_fma_f32 v16, v16, s28, v17
 v_sin_f32 v16, v16
 v_mov_b32 v15, 907168037
 v_mov_b32 v17, 898779429
 v_cmp_eq_u32 vcc, 0, v18
 s_nop 1
 v_cndmask_b32 v15, v15, v17, vcc
 v_cmp_eq_u32 vcc, 224, v18
 s_nop 1
 v_cndmask_b32 v15, v15, v17, vcc
 v_cmp_gt_u32 vcc, 225, v18
 s_nop 1
 v_cndmask_b32 v15, 0, v15, vcc
 v_mul_f32 v26, v16, v15
 v_add_u32 v18, 22, v14
 v_mul_u32_u24 v16, v13, v18
 v_lshrrev_b32 v17, 6, v16
 v_mul_u32_u24 v17, s26, v17
 v_lshrrev_b32 v17, 16, v17
 v_mul_u32_u24 v17, s27, v17
 v_sub_u32 v16, v16, v17
 v_cvt_f32_u32 v16, v16
 v_mov_b32 v17, s21
 v_fma_f32 v16, v16, s28, v17
 v_sin_f32 v16, v16
 v_mov_b32 v15, 907168037
 v_mov_b32 v17, 898779429
 v_cmp_eq_u32 vcc, 0, v18
 s_nop 1
 v_cndmask_b32 v15, v15, v17, vcc
 v_cmp_eq_u32 vcc, 224, v18
 s_nop 1
 v_cndmask_b32 v15, v15, v17, vcc
 v_cmp_gt_u32 vcc, 225, v18
 s_nop 1
 v_cndmask_b32 v15, 0, v15, vcc
 v_mul_f32 v27, v16, v15
 v_cvt_pk_bf16_f32 v44, v20, v21
 v_cvt_pk_bf16_f32 v45, v22, v23
 v_cvt_pk_bf16_f32 v46, v24, v25
 v_cvt_pk_bf16_f32 v47, v26, v27
 s_lshl_b32 s20, s20, 10
 s_add_u32 s20, s20, 13303808
 s_add_u32 s30, s4, s20
 s_addc_u32 s31, s5, 0
 global_store_dwordx4 v12, v[44:47], s[30:31]
 s_waitcnt vmcnt(4)
 s_add_u32 s20, s18, 0
 s_lshl_b32 s20, s20, 10
 s_add_u32 s20, s20, 85655552
 s_add_u32 s30, s4, s20
 s_addc_u32 s31, s5, 0
 v_swap_b32 v65, v66
 s_nop 0
 global_store_dwordx4 v12, v[64:67], s[30:31]
 s_add_u32 s30, s30, 1835008
 s_addc_u32 s31, s31, 0
 global_store_dwordx4 v12, v[96:99], s[30:31]
 s_add_u32 s20, s18, 224
 s_lshl_b32 s20, s20, 10
 s_add_u32 s20, s20, 85655552
 s_add_u32 s30, s4, s20
 s_addc_u32 s31, s5, 0
 v_swap_b32 v69, v70
 s_nop 0
 global_store_dwordx4 v12, v[68:71], s[30:31]
 s_add_u32 s30, s30, 1835008
 s_addc_u32 s31, s31, 0
 global_store_dwordx4 v12, v[100:103], s[30:31]
 s_add_u32 s20, s18, 448
 s_lshl_b32 s20, s20, 10
 s_add_u32 s20, s20, 85655552
 s_add_u32 s30, s4, s20
 s_addc_u32 s31, s5, 0
 v_swap_b32 v73, v74
 s_nop 0
 global_store_dwordx4 v12, v[72:75], s[30:31]
 s_add_u32 s30, s30, 1835008
 s_addc_u32 s31, s31, 0
 global_store_dwordx4 v12, v[104:107], s[30:31]
 s_add_u32 s20, s18, 672
 s_lshl_b32 s20, s20, 10
 s_add_u32 s20, s20, 85655552
 s_add_u32 s30, s4, s20
 s_addc_u32 s31, s5, 0
 v_swap_b32 v77, v78
 s_nop 0
 global_store_dwordx4 v12, v[76:79], s[30:31]
 s_add_u32 s30, s30, 1835008
 s_addc_u32 s31, s31, 0
 global_store_dwordx4 v12, v[108:111], s[30:31]
 s_add_u32 s20, s18, 896
 s_lshl_b32 s20, s20, 10
 s_add_u32 s20, s20, 85655552
 s_add_u32 s30, s4, s20
 s_addc_u32 s31, s5, 0
 v_swap_b32 v81, v82
 s_nop 0
 global_store_dwordx4 v12, v[80:83], s[30:31]
 s_add_u32 s30, s30, 1835008
 s_addc_u32 s31, s31, 0
 global_store_dwordx4 v12, v[112:115], s[30:31]
 s_add_u32 s20, s18, 1120
 s_lshl_b32 s20, s20, 10
 s_add_u32 s20, s20, 85655552
 s_add_u32 s30, s4, s20
 s_addc_u32 s31, s5, 0
 v_swap_b32 v85, v86
 s_nop 0
 global_store_dwordx4 v12, v[84:87], s[30:31]
 s_add_u32 s30, s30, 1835008
 s_addc_u32 s31, s31, 0
 global_store_dwordx4 v12, v[116:119], s[30:31]
 s_add_u32 s20, s18, 1344
 s_lshl_b32 s20, s20, 10
 s_add_u32 s20, s20, 85655552
 s_add_u32 s30, s4, s20
 s_addc_u32 s31, s5, 0
 v_swap_b32 v89, v90
 s_nop 0
 global_store_dwordx4 v12, v[88:91], s[30:31]
 s_add_u32 s30, s30, 1835008
 s_addc_u32 s31, s31, 0
 global_store_dwordx4 v12, v[120:123], s[30:31]
 s_add_u32 s20, s18, 1568
 s_lshl_b32 s20, s20, 10
 s_add_u32 s20, s20, 85655552
 s_add_u32 s30, s4, s20
 s_addc_u32 s31, s5, 0
 v_swap_b32 v93, v94
 s_nop 0
 global_store_dwordx4 v12, v[92:95], s[30:31]
 s_add_u32 s30, s30, 1835008
 s_addc_u32 s31, s31, 0
 global_store_dwordx4 v12, v[124:127], s[30:31]
K1_END:
 s_endpgm
.globl k2_kernel
.p2align 8
.type k2_kernel,@function
k2_kernel:
 s_cmp_ge_u32 s2, 256
 s_cbranch_scc1 K2_END
 s_load_dwordx2 s[4:5], s[0:1], 96
 s_load_dwordx2 s[6:7], s[0:1], 80
 s_load_dwordx2 s[8:9], s[0:1], 24
 s_load_dwordx2 s[10:11], s[0:1], 0
 s_load_dwordx4 s[12:15], s[0:1], 8
 s_getreg_b32 s19, hwreg(HW_REG_XCC_ID)
 s_and_b32 s19, s19, 15
 v_lshrrev_b32 v1, 6, v0
 s_nop 0
 v_readfirstlane_b32 s16, v1
 s_mov_b32 s51, 0
 s_sub_u32 s50, s19, 1
 s_cmp_ge_u32 s50, 7
 s_cselect_b32 s50, 0, s50
 s_waitcnt lgkmcnt(0)
 s_cmp_lg_u32 s19, 0
 s_cbranch_scc1 K2_WORK
 s_barrier
 s_cmp_lg_u32 s16, 0
 s_cbranch_scc1 R0_C1
 v_mov_b32 v1, 85590016
 v_mov_b32 v2, 1
 s_mov_b64 exec, 1
 global_atomic_add v3, v1, v2, s[4:5] sc0 sc1
 v_mov_b32 v1, 0x27F00
 s_waitcnt vmcnt(0)
 ds_write_b32 v1, v3
 s_mov_b64 exec, -1
 s_waitcnt lgkmcnt(0)
R0_C1:
 s_barrier
 v_mov_b32 v1, 0x27F00
 ds_read_b32 v2, v1
 s_waitcnt lgkmcnt(0)
 v_readfirstlane_b32 s17, v2
 s_cmp_lt_u32 s17, 32
 s_cbranch_scc1 K2_TEAM
K2_WORK:
 s_mov_b32 s17, 0
PV0_L:
 s_waitcnt vmcnt(0)
 s_barrier
 s_cmp_lg_u32 s16, 0
 s_cbranch_scc1 PV0_C1
 s_mov_b64 exec, 1
 v_mov_b32 v2, 1
 s_cmp_eq_u32 s51, 0
 s_cbranch_scc1 PV0_T
 v_mov_b32 v1, s51
 v_mov_b32 v3, s52
 global_atomic_add v1, v3, s[4:5] sc1
PV0_T:
 s_lshl_b32 s20, s17, 8
 s_add_u32 s20, s20, 85603328
 v_mov_b32 v1, s20
 global_atomic_add v3, v1, v2, s[4:5] sc0 sc1
 s_cmp_lt_u32 s17, 4
 s_cselect_b32 s20, 224, 224
 s_waitcnt vmcnt(0)
 v_readfirstlane_b32 s18, v3
 s_cmp_lt_u32 s18, s20
 s_cbranch_scc1 PV0_W
 s_mov_b32 s18, -1
PV0_W:
 v_mov_b32 v1, 0x27F00
 v_mov_b32 v2, s18
 v_mov_b32 v3, s17
 ds_write_b64 v1, v[2:3]
 s_mov_b64 exec, -1
 s_waitcnt lgkmcnt(0)
PV0_C1:
 s_barrier
 v_mov_b32 v1, 0x27F00
 ds_read_b64 v[2:3], v1
 s_mov_b32 s51, 0
 s_mov_b32 s52, 1
 s_waitcnt lgkmcnt(0)
 v_readfirstlane_b32 s18, v2
 v_readfirstlane_b32 s17, v3
 s_cmp_eq_u32 s18, -1
 s_cbranch_scc1 PV0_X
 v_and_b32 v2, 63, v0
 v_and_b32 v3, 31, v2
 v_lshrrev_b32 v4, 5, v2
 s_and_b32 s20, s18, 7
 s_lshr_b32 s21, s18, 3
 s_mov_b32 s20, 0
 s_lshr_b32 s22, s18, 4
 s_and_b32 s23, s18, 15
 s_mov_b32 s52, 1
 s_mul_i32 s24, s22, 458752
 s_mul_i32 s25, s23, 28672
 s_add_u32 s24, s24, s25
 s_add_u32 s24, s24, 6422528
 s_lshr_b32 s25, s16, 1
 s_mul_i32 s25, s25, 14336
 s_add_u32 s24, s24, s25
 s_lshl_b32 s26, s22, 15
 s_mul_i32 s25, s23, 2048
 s_add_u32 s26, s26, s25
 s_add_u32 s26, s26, 26411008
 s_lshl_b32 s51, s20, 8
 s_add_u32 s51, s51, 85607424
 s_lshl_b32 s20, s20, 3
 s_lshl_b32 s25, s16, 1
 s_add_u32 s20, s20, s25
 s_mul_i32 s25, s20, 458752
 s_add_u32 s26, s26, s25
 s_add_u32 s30, s4, s26
 s_addc_u32 s31, s5, 0
 s_add_u32 s32, s30, 458752
 s_addc_u32 s33, s31, 0
 s_mul_i32 s25, s20, 28672
 s_add_u32 s25, s25, 85655552
 s_add_u32 s34, s4, s25
 s_addc_u32 s35, s5, 0
 s_and_b32 s25, s16, 1
 s_mul_i32 s25, s25, 7168
 v_lshlrev_b32 v5, 4, v2
 v_add_u32 v6, s25, v5
 v_add_u32 v7, 4096, v6
 s_lshr_b32 s28, s16, 1
 s_mul_i32 s28, s28, 14464
 s_add_u32 s28, s28, s25
 s_barrier
 s_add_u32 s36, s24, 0
 s_add_u32 s36, s4, s36
 s_addc_u32 s37, s5, 0
 s_add_u32 m0, s28, 0
 s_nop 0
 global_load_lds_dwordx4 v6, s[36:37] offset:0
 global_load_lds_dwordx4 v6, s[36:37] offset:1024
 global_load_lds_dwordx4 v6, s[36:37] offset:2048
 global_load_lds_dwordx4 v6, s[36:37] offset:3072
 s_add_u32 m0, s28, 4096
 s_nop 0
 global_load_lds_dwordx4 v7, s[36:37] offset:0
 global_load_lds_dwordx4 v7, s[36:37] offset:1024
 global_load_lds_dwordx4 v7, s[36:37] offset:2048
 v_mov_b32 v8, v5
 global_load_dwordx4 a[0:3], v8, s[34:35] offset:0
 global_load_dwordx4 a[4:7], v8, s[34:35] offset:1024
 global_load_dwordx4 a[8:11], v8, s[34:35] offset:2048
 global_load_dwordx4 a[12:15], v8, s[34:35] offset:3072
 v_add_u32 v8, 4096, v8
 global_load_dwordx4 a[16:19], v8, s[34:35] offset:0
 global_load_dwordx4 a[20:23], v8, s[34:35] offset:1024
 global_load_dwordx4 a[24:27], v8, s[34:35] offset:2048
 global_load_dwordx4 a[28:31], v8, s[34:35] offset:3072
 v_add_u32 v8, 4096, v8
 global_load_dwordx4 a[32:35], v8, s[34:35] offset:0
 global_load_dwordx4 a[36:39], v8, s[34:35] offset:1024
 global_load_dwordx4 a[40:43], v8, s[34:35] offset:2048
 global_load_dwordx4 a[44:47], v8, s[34:35] offset:3072
 v_add_u32 v8, 4096, v8
 global_load_dwordx4 a[48:51], v8, s[34:35] offset:0
 global_load_dwordx4 a[52:55], v8, s[34:35] offset:1024
 global_load_dwordx4 a[56:59], v8, s[34:35] offset:2048
 global_load_dwordx4 a[60:63], v8, s[34:35] offset:3072
 v_add_u32 v8, 4096, v8
 global_load_dwordx4 a[64:67], v8, s[34:35] offset:0
 global_load_dwordx4 a[68:71], v8, s[34:35] offset:1024
 global_load_dwordx4 a[72:75], v8, s[34:35] offset:2048
 global_load_dwordx4 a[76:79], v8, s[34:35] offset:3072
 v_add_u32 v8, 4096, v8
 global_load_dwordx4 a[80:83], v8, s[34:35] offset:0
 global_load_dwordx4 a[84:87], v8, s[34:35] offset:1024
 global_load_dwordx4 a[88:91], v8, s[34:35] offset:2048
 global_load_dwordx4 a[92:95], v8, s[34:35] offset:3072
 v_add_u32 v8, 4096, v8
 global_load_dwordx4 a[96:99], v8, s[34:35] offset:0
 global_load_dwordx4 a[100:103], v8, s[34:35] offset:1024
 global_load_dwordx4 a[104:107], v8, s[34:35] offset:2048
 global_load_dwordx4 a[108:111], v8, s[34:35] offset:3072
 v_add_u32 v8, 4096, v8
 global_load_dwordx4 a[112:115], v8, s[34:35] offset:0
 global_load_dwordx4 a[116:119], v8, s[34:35] offset:1024
 global_load_dwordx4 a[120:123], v8, s[34:35] offset:2048
 global_load_dwordx4 a[124:127], v8, s[34:35] offset:3072
 v_add_u32 v8, 4096, v8
 global_load_dwordx4 a[128:131], v8, s[34:35] offset:0
 global_load_dwordx4 a[132:135], v8, s[34:35] offset:1024
 global_load_dwordx4 a[136:139], v8, s[34:35] offset:2048
 global_load_dwordx4 a[140:143], v8, s[34:35] offset:3072
 v_add_u32 v8, 4096, v8
 global_load_dwordx4 a[144:147], v8, s[34:35] offset:0
 global_load_dwordx4 a[148:151], v8, s[34:35] offset:1024
 global_load_dwordx4 a[152:155], v8, s[34:35] offset:2048
 global_load_dwordx4 a[156:159], v8, s[34:35] offset:3072
 v_add_u32 v8, 4096, v8
 global_load_dwordx4 a[160:163], v8, s[34:35] offset:0
 global_load_dwordx4 a[164:167], v8, s[34:35] offset:1024
 global_load_dwordx4 a[168:171], v8, s[34:35] offset:2048
 global_load_dwordx4 a[172:175], v8, s[34:35] offset:3072
 v_add_u32 v8, 4096, v8
 global_load_dwordx4 a[176:179], v8, s[34:35] offset:0
 global_load_dwordx4 a[180:183], v8, s[34:35] offset:1024
 global_load_dwordx4 a[184:187], v8, s[34:35] offset:2048
 global_load_dwordx4 a[188:191], v8, s[34:35] offset:3072
 v_add_u32 v8, 4096, v8
 global_load_dwordx4 a[192:195], v8, s[34:35] offset:0
 global_load_dwordx4 a[196:199], v8, s[34:35] offset:1024
 global_load_dwordx4 a[200:203], v8, s[34:35] offset:2048
 global_load_dwordx4 a[204:207], v8, s[34:35] offset:3072
 v_add_u32 v8, 4096, v8
 global_load_dwordx4 a[208:211], v8, s[34:35] offset:0
 global_load_dwordx4 a[212:215], v8, s[34:35] offset:1024
 global_load_dwordx4 a[216:219], v8, s[34:35] offset:2048
 global_load_dwordx4 a[220:223], v8, s[34:35] offset:3072
 v_lshrrev_b32 v9, 4, v3
 v_mul_u32_u24 v9, 14464, v9
 v_and_b32 v10, 15, v3
 v_lshlrev_b32 v10, 4, v10
 v_lshlrev_b32 v11, 8, v4
 v_add3_u32 v9, v9, v10, v11
 v_lshrrev_b32 v12, 4, v3
 v_lshlrev_b32 v12, 10, v12
 v_lshlrev_b32 v11, 9, v4
 v_add3_u32 v11, v11, v12, v10
 s_waitcnt vmcnt(0)
 s_barrier
 v_add_u32 v12, 0, v9
 ds_read_b128 v[32:35], v12 offset:0
 ds_read_b128 v[36:39], v12 offset:512
 ds_read_b128 v[40:43], v12 offset:1024
 ds_read_b128 v[44:47], v12 offset:1536
 ds_read_b128 v[48:51], v12 offset:2048
 ds_read_b128 v[52:55], v12 offset:2560
 s_waitcnt lgkmcnt(5)
 v_mfma_f32_32x32x16_bf16 v[64:79], a[0:3], v[32:35], 0
 v_mfma_f32_32x32x16_bf16 v[80:95], a[112:115], v[32:35], 0
 ds_read_b128 v[56:59], v12 offset:3072
 s_waitcnt lgkmcnt(5)
 v_mfma_f32_32x32x16_bf16 v[64:79], a[4:7], v[36:39], v[64:79]
 v_mfma_f32_32x32x16_bf16 v[80:95], a[116:119], v[36:39], v[80:95]
 ds_read_b128 v[60:63], v12 offset:3584
 s_waitcnt lgkmcnt(5)
 v_mfma_f32_32x32x16_bf16 v[64:79], a[8:11], v[40:43], v[64:79]
 v_mfma_f32_32x32x16_bf16 v[80:95], a[120:123], v[40:43], v[80:95]
 ds_read_b128 v[32:35], v12 offset:4096
 s_waitcnt lgkmcnt(5)
 v_mfma_f32_32x32x16_bf16 v[64:79], a[12:15], v[44:47], v[64:79]
 v_mfma_f32_32x32x16_bf16 v[80:95], a[124:127], v[44:47], v[80:95]
 ds_read_b128 v[36:39], v12 offset:4608
 s_waitcnt lgkmcnt(5)
 v_mfma_f32_32x32x16_bf16 v[64:79], a[16:19], v[48:51], v[64:79]
 v_mfma_f32_32x32x16_bf16 v[80:95], a[128:131], v[48:51], v[80:95]
 ds_read_b128 v[40:43], v12 offset:5120
 s_waitcnt lgkmcnt(5)
 v_mfma_f32_32x32x16_bf16 v[64:79], a[20:23], v[52:55], v[64:79]
 v_mfma_f32_32x32x16_bf16 v[80:95], a[132:135], v[52:55], v[80:95]
 ds_read_b128 v[44:47], v12 offset:5632
 s_waitcnt lgkmcnt(5)
 v_mfma_f32_32x32x16_bf16 v[64:79], a[24:27], v[56:59], v[64:79]
 v_mfma_f32_32x32x16_bf16 v[80:95], a[136:139], v[56:59], v[80:95]
 ds_read_b128 v[48:51], v12 offset:6144
 s_waitcnt lgkmcnt(5)
 v_mfma_f32_32x32x16_bf16 v[64:79], a[28:31], v[60:63], v[64:79]
 v_mfma_f32_32x32x16_bf16 v[80:95], a[140:143], v[60:63], v[80:95]
 ds_read_b128 v[52:55], v12 offset:6656
 s_waitcnt lgkmcnt(5)
 v_mfma_f32_32x32x16_bf16 v[64:79], a[32:35], v[32:35], v[64:79]
 v_mfma_f32_32x32x16_bf16 v[80:95], a[144:147], v[32:35], v[80:95]
 ds_read_b128 v[56:59], v12 offset:7168
 s_waitcnt lgkmcnt(5)
 v_mfma_f32_32x32x16_bf16 v[64:79], a[36:39], v[36:39], v[64:79]
 v_mfma_f32_32x32x16_bf16 v[80:95], a[148:151], v[36:39], v[80:95]
 ds_read_b128 v[60:63], v12 offset:7680
 s_waitcnt lgkmcnt(5)
 v_mfma_f32_32x32x16_bf16 v[64:79], a[40:43], v[40:43], v[64:79]
 v_mfma_f32_32x32x16_bf16 v[80:95], a[152:155], v[40:43], v[80:95]
 ds_read_b128 v[32:35], v12 offset:8192
 s_waitcnt lgkmcnt(5)
 v_mfma_f32_32x32x16_bf16 v[64:79], a[44:47], v[44:47], v[64:79]
 v_mfma_f32_32x32x16_bf16 v[80:95], a[156:159], v[44:47], v[80:95]
 ds_read_b128 v[36:39], v12 offset:8704
 s_waitcnt lgkmcnt(5)
 v_mfma_f32_32x32x16_bf16 v[64:79], a[48:51], v[48:51], v[64:79]
 v_mfma_f32_32x32x16_bf16 v[80:95], a[160:163], v[48:51], v[80:95]
 ds_read_b128 v[40:43], v12 offset:9216
 s_waitcnt lgkmcnt(5)
 v_mfma_f32_32x32x16_bf16 v[64:79], a[52:55], v[52:55], v[64:79]
 v_mfma_f32_32x32x16_bf16 v[80:95], a[164:167], v[52:55], v[80:95]
 ds_read_b128 v[44:47], v12 offset:9728
 s_waitcnt lgkmcnt(5)
 v_mfma_f32_32x32x16_bf16 v[64:79], a[56:59], v[56:59], v[64:79]
 v_mfma_f32_32x32x16_bf16 v[80:95], a[168:171], v[56:59], v[80:95]
 ds_read_b128 v[48:51], v12 offset:10240
 s_waitcnt lgkmcnt(5)
 v_mfma_f32_32x32x16_bf16 v[64:79], a[60:63], v[60:63], v[64:79]
 v_mfma_f32_32x32x16_bf16 v[80:95], a[172:175], v[60:63], v[80:95]
 ds_read_b128 v[52:55], v12 offset:10752
 s_waitcnt lgkmcnt(5)
 v_mfma_f32_32x32x16_bf16 v[64:79], a[64:67], v[32:35], v[64:79]
 v_mfma_f32_32x32x16_bf16 v[80:95], a[176:179], v[32:35], v[80:95]
 ds_read_b128 v[56:59], v12 offset:11264
 s_waitcnt lgkmcnt(5)
 v_mfma_f32_32x32x16_bf16 v[64:79], a[68:71], v[36:39], v[64:79]
 v_mfma_f32_32x32x16_bf16 v[80:95], a[180:183], v[36:39], v[80:95]
 ds_read_b128 v[60:63], v12 offset:11776
 s_waitcnt lgkmcnt(5)
 v_mfma_f32_32x32x16_bf16 v[64:79], a[72:75], v[40:43], v[64:79]
 v_mfma_f32_32x32x16_bf16 v[80:95], a[184:187], v[40:43], v[80:95]
 ds_read_b128 v[32:35], v12 offset:12288
 s_waitcnt lgkmcnt(5)
 v_mfma_f32_32x32x16_bf16 v[64:79], a[76:79], v[44:47], v[64:79]
 v_mfma_f32_32x32x16_bf16 v[80:95], a[188:191], v[44:47], v[80:95]
 ds_read_b128 v[36:39], v12 offset:12800
 s_waitcnt lgkmcnt(5)
 v_mfma_f32_32x32x16_bf16 v[64:79], a[80:83], v[48:51], v[64:79]
 v_mfma_f32_32x32x16_bf16 v[80:95], a[192:195], v[48:51], v[80:95]
 ds_read_b128 v[40:43], v12 offset:13312
 s_waitcnt lgkmcnt(5)
 v_mfma_f32_32x32x16_bf16 v[64:79], a[84:87], v[52:55], v[64:79]
 v_mfma_f32_32x32x16_bf16 v[80:95], a[196:199], v[52:55], v[80:95]
 ds_read_b128 v[44:47], v12 offset:13824
 s_waitcnt lgkmcnt(5)
 v_mfma_f32_32x32x16_bf16 v[64:79], a[88:91], v[56:59], v[64:79]
 v_mfma_f32_32x32x16_bf16 v[80:95], a[200:203], v[56:59], v[80:95]
 s_waitcnt lgkmcnt(4)
 v_mfma_f32_32x32x16_bf16 v[64:79], a[92:95], v[60:63], v[64:79]
 v_mfma_f32_32x32x16_bf16 v[80:95], a[204:207], v[60:63], v[80:95]
 s_waitcnt lgkmcnt(3)
 v_mfma_f32_32x32x16_bf16 v[64:79], a[96:99], v[32:35], v[64:79]
 v_mfma_f32_32x32x16_bf16 v[80:95], a[208:211], v[32:35], v[80:95]
 s_waitcnt lgkmcnt(2)
 v_mfma_f32_32x32x16_bf16 v[64:79], a[100:103], v[36:39], v[64:79]
 v_mfma_f32_32x32x16_bf16 v[80:95], a[212:215], v[36:39], v[80:95]
 s_waitcnt lgkmcnt(1)
 v_mfma_f32_32x32x16_bf16 v[64:79], a[104:107], v[40:43], v[64:79]
 v_mfma_f32_32x32x16_bf16 v[80:95], a[216:219], v[40:43], v[80:95]
 s_waitcnt lgkmcnt(0)
 v_mfma_f32_32x32x16_bf16 v[64:79], a[108:111], v[44:47], v[64:79]
 v_mfma_f32_32x32x16_bf16 v[80:95], a[220:223], v[44:47], v[80:95]
 s_nop 7
 v_cvt_pk_bf16_f32 v128, v64, v65
 v_cvt_pk_bf16_f32 v129, v66, v67
 v_cvt_pk_bf16_f32 v130, v68, v69
 v_cvt_pk_bf16_f32 v131, v70, v71
 v_add_u32 v13, 0, v11
 global_store_dwordx4 v13, v[128:131], s[30:31] sc1
 v_cvt_pk_bf16_f32 v132, v72, v73
 v_cvt_pk_bf16_f32 v133, v74, v75
 v_cvt_pk_bf16_f32 v134, v76, v77
 v_cvt_pk_bf16_f32 v135, v78, v79
 v_add_u32 v13, 256, v11
 global_store_dwordx4 v13, v[132:135], s[30:31] sc1
 s_nop 3
 v_cvt_pk_bf16_f32 v136, v80, v81
 v_cvt_pk_bf16_f32 v137, v82, v83
 v_cvt_pk_bf16_f32 v138, v84, v85
 v_cvt_pk_bf16_f32 v139, v86, v87
 v_add_u32 v13, 0, v11
 global_store_dwordx4 v13, v[136:139], s[32:33] sc1
 v_cvt_pk_bf16_f32 v140, v88, v89
 v_cvt_pk_bf16_f32 v141, v90, v91
 v_cvt_pk_bf16_f32 v142, v92, v93
 v_cvt_pk_bf16_f32 v143, v94, v95
 v_add_u32 v13, 256, v11
 global_store_dwordx4 v13, v[140:143], s[32:33] sc1
 s_branch PV0_L
PV0_X:
 s_mov_b32 s17, s50
PVX_L:
 s_waitcnt vmcnt(0)
 s_barrier
 s_cmp_lg_u32 s16, 0
 s_cbranch_scc1 PVX_C1
 s_mov_b64 exec, 1
 v_mov_b32 v2, 1
 s_cmp_eq_u32 s51, 0
 s_cbranch_scc1 PVX_T
 v_mov_b32 v1, s51
 v_mov_b32 v3, s52
 global_atomic_add v1, v3, s[4:5] sc1
PVX_T:
 s_lshl_b32 s20, s17, 8
 s_add_u32 s20, s20, 85591040
 v_mov_b32 v1, s20
 global_atomic_add v3, v1, v2, s[4:5] sc0 sc1
 s_cmp_lt_u32 s17, 4
 s_cselect_b32 s20, 56, 56
 s_waitcnt vmcnt(0)
 v_readfirstlane_b32 s18, v3
 s_cmp_lt_u32 s18, s20
 s_cbranch_scc1 PVX_W
 s_mov_b32 s18, -1
 s_mov_b64 exec, 127
 v_lshlrev_b32 v1, 8, v0
 v_add_u32 v1, 85591040, v1
 global_load_dword v3, v1, s[4:5] sc1
 v_mov_b32 v4, 56
 v_mov_b32 v5, 56
 v_cmp_gt_u32 vcc, 4, v0
 s_nop 1
 v_cndmask_b32 v4, v4, v5, vcc
 s_waitcnt vmcnt(0)
 v_cmp_lt_u32 vcc, v3, v4
 s_mov_b64 exec, 1
 s_cbranch_vccz PVX_W
 s_ff1_i32_b32 s17, vcc_lo
 s_branch PVX_T
PVX_W:
 v_mov_b32 v1, 0x27F00
 v_mov_b32 v2, s18
 v_mov_b32 v3, s17
 ds_write_b64 v1, v[2:3]
 s_mov_b64 exec, -1
 s_waitcnt lgkmcnt(0)
PVX_C1:
 s_barrier
 v_mov_b32 v1, 0x27F00
 ds_read_b64 v[2:3], v1
 s_mov_b32 s51, 0
 s_mov_b32 s52, 1
 s_waitcnt lgkmcnt(0)
 v_readfirstlane_b32 s18, v2
 v_readfirstlane_b32 s17, v3
 s_cmp_eq_u32 s18, -1
 s_cbranch_scc1 PVX_X
 v_and_b32 v2, 63, v0
 v_and_b32 v3, 31, v2
 v_lshrrev_b32 v4, 5, v2
 s_and_b32 s20, s18, 7
 s_lshr_b32 s21, s18, 3
 s_lshr_b32 s20, s18, 3
 s_add_u32 s20, s20, 1
 s_and_b32 s21, s18, 7
 s_lshl_b32 s22, s17, 3
 s_add_u32 s21, s21, s22
 s_lshr_b32 s22, s21, 2
 s_and_b32 s23, s21, 3
 s_mov_b32 s52, 4
 s_mul_i32 s24, s22, 458752
 s_mul_i32 s25, s23, 114688
 s_add_u32 s24, s24, s25
 s_add_u32 s24, s24, 6422528
 s_lshr_b32 s25, s16, 1
 s_mul_i32 s25, s25, 14336
 s_add_u32 s24, s24, s25
 s_lshl_b32 s26, s22, 15
 s_mul_i32 s25, s23, 8192
 s_add_u32 s26, s26, s25
 s_add_u32 s26, s26, 26411008
 s_lshl_b32 s51, s20, 8
 s_add_u32 s51, s51, 85607424
 s_lshl_b32 s20, s20, 3
 s_lshl_b32 s25, s16, 1
 s_add_u32 s20, s20, s25
 s_mul_i32 s25, s20, 458752
 s_add_u32 s26, s26, s25
 s_add_u32 s30, s4, s26
 s_addc_u32 s31, s5, 0
 s_add_u32 s32, s30, 458752
 s_addc_u32 s33, s31, 0
 s_mul_i32 s25, s20, 28672
 s_add_u32 s25, s25, 85655552
 s_add_u32 s34, s4, s25
 s_addc_u32 s35, s5, 0
 s_and_b32 s25, s16, 1
 s_mul_i32 s25, s25, 7168
 v_lshlrev_b32 v5, 4, v2
 v_add_u32 v6, s25, v5
 v_add_u32 v7, 4096, v6
 s_lshr_b32 s28, s16, 1
 s_mul_i32 s28, s28, 14464
 s_add_u32 s28, s28, s25
 s_barrier
 s_add_u32 s36, s24, 0
 s_add_u32 s36, s4, s36
 s_addc_u32 s37, s5, 0
 s_add_u32 m0, s28, 0
 s_nop 0
 global_load_lds_dwordx4 v6, s[36:37] offset:0
 global_load_lds_dwordx4 v6, s[36:37] offset:1024
 global_load_lds_dwordx4 v6, s[36:37] offset:2048
 global_load_lds_dwordx4 v6, s[36:37] offset:3072
 s_add_u32 m0, s28, 4096
 s_nop 0
 global_load_lds_dwordx4 v7, s[36:37] offset:0
 global_load_lds_dwordx4 v7, s[36:37] offset:1024
 global_load_lds_dwordx4 v7, s[36:37] offset:2048
 v_mov_b32 v8, v5
 global_load_dwordx4 a[0:3], v8, s[34:35] offset:0
 global_load_dwordx4 a[4:7], v8, s[34:35] offset:1024
 global_load_dwordx4 a[8:11], v8, s[34:35] offset:2048
 global_load_dwordx4 a[12:15], v8, s[34:35] offset:3072
 v_add_u32 v8, 4096, v8
 global_load_dwordx4 a[16:19], v8, s[34:35] offset:0
 global_load_dwordx4 a[20:23], v8, s[34:35] offset:1024
 global_load_dwordx4 a[24:27], v8, s[34:35] offset:2048
 global_load_dwordx4 a[28:31], v8, s[34:35] offset:3072
 v_add_u32 v8, 4096, v8
 global_load_dwordx4 a[32:35], v8, s[34:35] offset:0
 global_load_dwordx4 a[36:39], v8, s[34:35] offset:1024
 global_load_dwordx4 a[40:43], v8, s[34:35] offset:2048
 global_load_dwordx4 a[44:47], v8, s[34:35] offset:3072
 v_add_u32 v8, 4096, v8
 global_load_dwordx4 a[48:51], v8, s[34:35] offset:0
 global_load_dwordx4 a[52:55], v8, s[34:35] offset:1024
 global_load_dwordx4 a[56:59], v8, s[34:35] offset:2048
 global_load_dwordx4 a[60:63], v8, s[34:35] offset:3072
 v_add_u32 v8, 4096, v8
 global_load_dwordx4 a[64:67], v8, s[34:35] offset:0
 global_load_dwordx4 a[68:71], v8, s[34:35] offset:1024
 global_load_dwordx4 a[72:75], v8, s[34:35] offset:2048
 global_load_dwordx4 a[76:79], v8, s[34:35] offset:3072
 v_add_u32 v8, 4096, v8
 global_load_dwordx4 a[80:83], v8, s[34:35] offset:0
 global_load_dwordx4 a[84:87], v8, s[34:35] offset:1024
 global_load_dwordx4 a[88:91], v8, s[34:35] offset:2048
 global_load_dwordx4 a[92:95], v8, s[34:35] offset:3072
 v_add_u32 v8, 4096, v8
 global_load_dwordx4 a[96:99], v8, s[34:35] offset:0
 global_load_dwordx4 a[100:103], v8, s[34:35] offset:1024
 global_load_dwordx4 a[104:107], v8, s[34:35] offset:2048
 global_load_dwordx4 a[108:111], v8, s[34:35] offset:3072
 v_add_u32 v8, 4096, v8
 global_load_dwordx4 a[112:115], v8, s[34:35] offset:0
 global_load_dwordx4 a[116:119], v8, s[34:35] offset:1024
 global_load_dwordx4 a[120:123], v8, s[34:35] offset:2048
 global_load_dwordx4 a[124:127], v8, s[34:35] offset:3072
 v_add_u32 v8, 4096, v8
 global_load_dwordx4 a[128:131], v8, s[34:35] offset:0
 global_load_dwordx4 a[132:135], v8, s[34:35] offset:1024
 global_load_dwordx4 a[136:139], v8, s[34:35] offset:2048
 global_load_dwordx4 a[140:143], v8, s[34:35] offset:3072
 v_add_u32 v8, 4096, v8
 global_load_dwordx4 a[144:147], v8, s[34:35] offset:0
 global_load_dwordx4 a[148:151], v8, s[34:35] offset:1024
 global_load_dwordx4 a[152:155], v8, s[34:35] offset:2048
 global_load_dwordx4 a[156:159], v8, s[34:35] offset:3072
 v_add_u32 v8, 4096, v8
 global_load_dwordx4 a[160:163], v8, s[34:35] offset:0
 s_add_u32 s36, s24, 28672
 s_add_u32 s36, s4, s36
 s_addc_u32 s37, s5, 0
 s_add_u32 m0, s28, 28800
 s_nop 0
 global_load_lds_dwordx4 v6, s[36:37] offset:0
 global_load_lds_dwordx4 v6, s[36:37] offset:1024
 global_load_lds_dwordx4 v6, s[36:37] offset:2048
 global_load_lds_dwordx4 v6, s[36:37] offset:3072
 s_add_u32 m0, s28, 32896
 s_nop 0
 global_load_lds_dwordx4 v7, s[36:37] offset:0
 global_load_lds_dwordx4 v7, s[36:37] offset:1024
 global_load_lds_dwordx4 v7, s[36:37] offset:2048
 global_load_dwordx4 a[164:167], v8, s[34:35] offset:1024
 global_load_dwordx4 a[168:171], v8, s[34:35] offset:2048
 global_load_dwordx4 a[172:175], v8, s[34:35] offset:3072
 v_add_u32 v8, 4096, v8
 global_load_dwordx4 a[176:179], v8, s[34:35] offset:0
 global_load_dwordx4 a[180:183], v8, s[34:35] offset:1024
 global_load_dwordx4 a[184:187], v8, s[34:35] offset:2048
 global_load_dwordx4 a[188:191], v8, s[34:35] offset:3072
 v_add_u32 v8, 4096, v8
 global_load_dwordx4 a[192:195], v8, s[34:35] offset:0
 global_load_dwordx4 a[196:199], v8, s[34:35] offset:1024
 global_load_dwordx4 a[200:203], v8, s[34:35] offset:2048
 global_load_dwordx4 a[204:207], v8, s[34:35] offset:3072
 v_add_u32 v8, 4096, v8
 global_load_dwordx4 a[208:211], v8, s[34:35] offset:0
 global_load_dwordx4 a[212:215], v8, s[34:35] offset:1024
 global_load_dwordx4 a[216:219], v8, s[34:35] offset:2048
 global_load_dwordx4 a[220:223], v8, s[34:35] offset:3072
 v_lshrrev_b32 v9, 4, v3
 v_mul_u32_u24 v9, 14464, v9
 v_and_b32 v10, 15, v3
 v_lshlrev_b32 v10, 4, v10
 v_lshlrev_b32 v11, 8, v4
 v_add3_u32 v9, v9, v10, v11
 v_lshrrev_b32 v12, 4, v3
 v_lshlrev_b32 v12, 10, v12
 v_lshlrev_b32 v11, 9, v4
 v_add3_u32 v11, v11, v12, v10
 s_waitcnt vmcnt(0)
 s_barrier
 s_add_u32 s36, s24, 57344
 s_add_u32 s36, s4, s36
 s_addc_u32 s37, s5, 0
 s_add_u32 m0, s28, 57600
 s_nop 0
 global_load_lds_dwordx4 v6, s[36:37] offset:0
 global_load_lds_dwordx4 v6, s[36:37] offset:1024
 global_load_lds_dwordx4 v6, s[36:37] offset:2048
 global_load_lds_dwordx4 v6, s[36:37] offset:3072
 s_add_u32 m0, s28, 61696
 s_nop 0
 global_load_lds_dwordx4 v7, s[36:37] offset:0
 global_load_lds_dwordx4 v7, s[36:37] offset:1024
 global_load_lds_dwordx4 v7, s[36:37] offset:2048
 v_add_u32 v12, 0, v9
 ds_read_b128 v[32:35], v12 offset:0
 ds_read_b128 v[36:39], v12 offset:512
 ds_read_b128 v[40:43], v12 offset:1024
 ds_read_b128 v[44:47], v12 offset:1536
 ds_read_b128 v[48:51], v12 offset:2048
 ds_read_b128 v[52:55], v12 offset:2560
 s_waitcnt lgkmcnt(5)
 v_mfma_f32_32x32x16_bf16 v[64:79], a[0:3], v[32:35], 0
 v_mfma_f32_32x32x16_bf16 v[80:95], a[112:115], v[32:35], 0
 ds_read_b128 v[56:59], v12 offset:3072
 s_waitcnt lgkmcnt(5)
 v_mfma_f32_32x32x16_bf16 v[64:79], a[4:7], v[36:39], v[64:79]
 v_mfma_f32_32x32x16_bf16 v[80:95], a[116:119], v[36:39], v[80:95]
 ds_read_b128 v[60:63], v12 offset:3584
 s_waitcnt lgkmcnt(5)
 v_mfma_f32_32x32x16_bf16 v[64:79], a[8:11], v[40:43], v[64:79]
 v_mfma_f32_32x32x16_bf16 v[80:95], a[120:123], v[40:43], v[80:95]
 ds_read_b128 v[32:35], v12 offset:4096
 s_waitcnt lgkmcnt(5)
 v_mfma_f32_32x32x16_bf16 v[64:79], a[12:15], v[44:47], v[64:79]
 v_mfma_f32_32x32x16_bf16 v[80:95], a[124:127], v[44:47], v[80:95]
 ds_read_b128 v[36:39], v12 offset:4608
 s_waitcnt lgkmcnt(5)
 v_mfma_f32_32x32x16_bf16 v[64:79], a[16:19], v[48:51], v[64:79]
 v_mfma_f32_32x32x16_bf16 v[80:95], a[128:131], v[48:51], v[80:95]
 ds_read_b128 v[40:43], v12 offset:5120
 s_waitcnt lgkmcnt(5)
 v_mfma_f32_32x32x16_bf16 v[64:79], a[20:23], v[52:55], v[64:79]
 v_mfma_f32_32x32x16_bf16 v[80:95], a[132:135], v[52:55], v[80:95]
 ds_read_b128 v[44:47], v12 offset:5632
 s_waitcnt lgkmcnt(5)
 v_mfma_f32_32x32x16_bf16 v[64:79], a[24:27], v[56:59], v[64:79]
 v_mfma_f32_32x32x16_bf16 v[80:95], a[136:139], v[56:59], v[80:95]
 ds_read_b128 v[48:51], v12 offset:6144
 s_waitcnt lgkmcnt(5)
 v_mfma_f32_32x32x16_bf16 v[64:79], a[28:31], v[60:63], v[64:79]
 v_mfma_f32_32x32x16_bf16 v[80:95], a[140:143], v[60:63], v[80:95]
 ds_read_b128 v[52:55], v12 offset:6656
 s_waitcnt lgkmcnt(5)
 v_mfma_f32_32x32x16_bf16 v[64:79], a[32:35], v[32:35], v[64:79]
 v_mfma_f32_32x32x16_bf16 v[80:95], a[144:147], v[32:35], v[80:95]
 ds_read_b128 v[56:59], v12 offset:7168
 s_waitcnt lgkmcnt(5)
 v_mfma_f32_32x32x16_bf16 v[64:79], a[36:39], v[36:39], v[64:79]
 v_mfma_f32_32x32x16_bf16 v[80:95], a[148:151], v[36:39], v[80:95]
 ds_read_b128 v[60:63], v12 offset:7680
 s_waitcnt lgkmcnt(5)
 v_mfma_f32_32x32x16_bf16 v[64:79], a[40:43], v[40:43], v[64:79]
 v_mfma_f32_32x32x16_bf16 v[80:95], a[152:155], v[40:43], v[80:95]
 ds_read_b128 v[32:35], v12 offset:8192
 s_waitcnt lgkmcnt(5)
 v_mfma_f32_32x32x16_bf16 v[64:79], a[44:47], v[44:47], v[64:79]
 v_mfma_f32_32x32x16_bf16 v[80:95], a[156:159], v[44:47], v[80:95]
 ds_read_b128 v[36:39], v12 offset:8704
 s_waitcnt lgkmcnt(5)
 v_mfma_f32_32x32x16_bf16 v[64:79], a[48:51], v[48:51], v[64:79]
 v_mfma_f32_32x32x16_bf16 v[80:95], a[160:163], v[48:51], v[80:95]
 ds_read_b128 v[40:43], v12 offset:9216
 s_waitcnt lgkmcnt(5)
 v_mfma_f32_32x32x16_bf16 v[64:79], a[52:55], v[52:55], v[64:79]
 v_mfma_f32_32x32x16_bf16 v[80:95], a[164:167], v[52:55], v[80:95]
 ds_read_b128 v[44:47], v12 offset:9728
 s_waitcnt lgkmcnt(5)
 v_mfma_f32_32x32x16_bf16 v[64:79], a[56:59], v[56:59], v[64:79]
 v_mfma_f32_32x32x16_bf16 v[80:95], a[168:171], v[56:59], v[80:95]
 ds_read_b128 v[48:51], v12 offset:10240
 s_waitcnt lgkmcnt(5)
 v_mfma_f32_32x32x16_bf16 v[64:79], a[60:63], v[60:63], v[64:79]
 v_mfma_f32_32x32x16_bf16 v[80:95], a[172:175], v[60:63], v[80:95]
 ds_read_b128 v[52:55], v12 offset:10752
 s_waitcnt lgkmcnt(5)
 v_mfma_f32_32x32x16_bf16 v[64:79], a[64:67], v[32:35], v[64:79]
 v_mfma_f32_32x32x16_bf16 v[80:95], a[176:179], v[32:35], v[80:95]
 ds_read_b128 v[56:59], v12 offset:11264
 s_waitcnt lgkmcnt(5)
 v_mfma_f32_32x32x16_bf16 v[64:79], a[68:71], v[36:39], v[64:79]
 v_mfma_f32_32x32x16_bf16 v[80:95], a[180:183], v[36:39], v[80:95]
 ds_read_b128 v[60:63], v12 offset:11776
 s_waitcnt lgkmcnt(5)
 v_mfma_f32_32x32x16_bf16 v[64:79], a[72:75], v[40:43], v[64:79]
 v_mfma_f32_32x32x16_bf16 v[80:95], a[184:187], v[40:43], v[80:95]
 ds_read_b128 v[32:35], v12 offset:12288
 s_waitcnt lgkmcnt(5)
 v_mfma_f32_32x32x16_bf16 v[64:79], a[76:79], v[44:47], v[64:79]
 v_mfma_f32_32x32x16_bf16 v[80:95], a[188:191], v[44:47], v[80:95]
 ds_read_b128 v[36:39], v12 offset:12800
 s_waitcnt lgkmcnt(5)
 v_mfma_f32_32x32x16_bf16 v[64:79], a[80:83], v[48:51], v[64:79]
 v_mfma_f32_32x32x16_bf16 v[80:95], a[192:195], v[48:51], v[80:95]
 ds_read_b128 v[40:43], v12 offset:13312
 s_waitcnt lgkmcnt(5)
 v_mfma_f32_32x32x16_bf16 v[64:79], a[84:87], v[52:55], v[64:79]
 v_mfma_f32_32x32x16_bf16 v[80:95], a[196:199], v[52:55], v[80:95]
 ds_read_b128 v[44:47], v12 offset:13824
 s_waitcnt lgkmcnt(5)
 v_mfma_f32_32x32x16_bf16 v[64:79], a[88:91], v[56:59], v[64:79]
 v_mfma_f32_32x32x16_bf16 v[80:95], a[200:203], v[56:59], v[80:95]
 s_waitcnt lgkmcnt(4)
 v_mfma_f32_32x32x16_bf16 v[64:79], a[92:95], v[60:63], v[64:79]
 v_mfma_f32_32x32x16_bf16 v[80:95], a[204:207], v[60:63], v[80:95]
 s_waitcnt lgkmcnt(3)
 v_mfma_f32_32x32x16_bf16 v[64:79], a[96:99], v[32:35], v[64:79]
 v_mfma_f32_32x32x16_bf16 v[80:95], a[208:211], v[32:35], v[80:95]
 s_waitcnt lgkmcnt(2)
 v_mfma_f32_32x32x16_bf16 v[64:79], a[100:103], v[36:39], v[64:79]
 v_mfma_f32_32x32x16_bf16 v[80:95], a[212:215], v[36:39], v[80:95]
 s_waitcnt lgkmcnt(1)
 v_mfma_f32_32x32x16_bf16 v[64:79], a[104:107], v[40:43], v[64:79]
 v_mfma_f32_32x32x16_bf16 v[80:95], a[216:219], v[40:43], v[80:95]
 s_waitcnt lgkmcnt(0)
 v_mfma_f32_32x32x16_bf16 v[64:79], a[108:111], v[44:47], v[64:79]
 v_mfma_f32_32x32x16_bf16 v[80:95], a[220:223], v[44:47], v[80:95]
 s_nop 7
 v_cvt_pk_bf16_f32 v128, v64, v65
 v_cvt_pk_bf16_f32 v129, v66, v67
 v_cvt_pk_bf16_f32 v130, v68, v69
 v_cvt_pk_bf16_f32 v131, v70, v71
 v_add_u32 v13, 0, v11
 global_store_dwordx4 v13, v[128:131], s[30:31] sc1
 v_cvt_pk_bf16_f32 v132, v72, v73
 v_cvt_pk_bf16_f32 v133, v74, v75
 v_cvt_pk_bf16_f32 v134, v76, v77
 v_cvt_pk_bf16_f32 v135, v78, v79
 v_add_u32 v13, 256, v11
 global_store_dwordx4 v13, v[132:135], s[30:31] sc1
 s_nop 3
 v_cvt_pk_bf16_f32 v136, v80, v81
 v_cvt_pk_bf16_f32 v137, v82, v83
 v_cvt_pk_bf16_f32 v138, v84, v85
 v_cvt_pk_bf16_f32 v139, v86, v87
 v_add_u32 v13, 0, v11
 global_store_dwordx4 v13, v[136:139], s[32:33] sc1
 v_cvt_pk_bf16_f32 v140, v88, v89
 v_cvt_pk_bf16_f32 v141, v90, v91
 v_cvt_pk_bf16_f32 v142, v92, v93
 v_cvt_pk_bf16_f32 v143, v94, v95
 v_add_u32 v13, 256, v11
 global_store_dwordx4 v13, v[140:143], s[32:33] sc1
 s_waitcnt vmcnt(11)
 s_barrier
 s_add_u32 s36, s24, 86016
 s_add_u32 s36, s4, s36
 s_addc_u32 s37, s5, 0
 s_add_u32 m0, s28, 0
 s_nop 0
 global_load_lds_dwordx4 v6, s[36:37] offset:0
 global_load_lds_dwordx4 v6, s[36:37] offset:1024
 global_load_lds_dwordx4 v6, s[36:37] offset:2048
 global_load_lds_dwordx4 v6, s[36:37] offset:3072
 s_add_u32 m0, s28, 4096
 s_nop 0
 global_load_lds_dwordx4 v7, s[36:37] offset:0
 global_load_lds_dwordx4 v7, s[36:37] offset:1024
 global_load_lds_dwordx4 v7, s[36:37] offset:2048
 v_add_u32 v12, 28800, v9
 ds_read_b128 v[32:35], v12 offset:0
 ds_read_b128 v[36:39], v12 offset:512
 ds_read_b128 v[40:43], v12 offset:1024
 ds_read_b128 v[44:47], v12 offset:1536
 ds_read_b128 v[48:51], v12 offset:2048
 ds_read_b128 v[52:55], v12 offset:2560
 s_waitcnt lgkmcnt(5)
 v_mfma_f32_32x32x16_bf16 v[64:79], a[0:3], v[32:35], 0
 v_mfma_f32_32x32x16_bf16 v[80:95], a[112:115], v[32:35], 0
 ds_read_b128 v[56:59], v12 offset:3072
 s_waitcnt lgkmcnt(5)
 v_mfma_f32_32x32x16_bf16 v[64:79], a[4:7], v[36:39], v[64:79]
 v_mfma_f32_32x32x16_bf16 v[80:95], a[116:119], v[36:39], v[80:95]
 ds_read_b128 v[60:63], v12 offset:3584
 s_waitcnt lgkmcnt(5)
 v_mfma_f32_32x32x16_bf16 v[64:79], a[8:11], v[40:43], v[64:79]
 v_mfma_f32_32x32x16_bf16 v[80:95], a[120:123], v[40:43], v[80:95]
 ds_read_b128 v[32:35], v12 offset:4096
 s_waitcnt lgkmcnt(5)
 v_mfma_f32_32x32x16_bf16 v[64:79], a[12:15], v[44:47], v[64:79]
 v_mfma_f32_32x32x16_bf16 v[80:95], a[124:127], v[44:47], v[80:95]
 ds_read_b128 v[36:39], v12 offset:4608
 s_waitcnt lgkmcnt(5)
 v_mfma_f32_32x32x16_bf16 v[64:79], a[16:19], v[48:51], v[64:79]
 v_mfma_f32_32x32x16_bf16 v[80:95], a[128:131], v[48:51], v[80:95]
 ds_read_b128 v[40:43], v12 offset:5120
 s_waitcnt lgkmcnt(5)
 v_mfma_f32_32x32x16_bf16 v[64:79], a[20:23], v[52:55], v[64:79]
 v_mfma_f32_32x32x16_bf16 v[80:95], a[132:135], v[52:55], v[80:95]
 ds_read_b128 v[44:47], v12 offset:5632
 s_waitcnt lgkmcnt(5)
 v_mfma_f32_32x32x16_bf16 v[64:79], a[24:27], v[56:59], v[64:79]
 v_mfma_f32_32x32x16_bf16 v[80:95], a[136:139], v[56:59], v[80:95]
 ds_read_b128 v[48:51], v12 offset:6144
 s_waitcnt lgkmcnt(5)
 v_mfma_f32_32x32x16_bf16 v[64:79], a[28:31], v[60:63], v[64:79]
 v_mfma_f32_32x32x16_bf16 v[80:95], a[140:143], v[60:63], v[80:95]
 ds_read_b128 v[52:55], v12 offset:6656
 s_waitcnt lgkmcnt(5)
 v_mfma_f32_32x32x16_bf16 v[64:79], a[32:35], v[32:35], v[64:79]
 v_mfma_f32_32x32x16_bf16 v[80:95], a[144:147], v[32:35], v[80:95]
 ds_read_b128 v[56:59], v12 offset:7168
 s_waitcnt lgkmcnt(5)
 v_mfma_f32_32x32x16_bf16 v[64:79], a[36:39], v[36:39], v[64:79]
 v_mfma_f32_32x32x16_bf16 v[80:95], a[148:151], v[36:39], v[80:95]
 ds_read_b128 v[60:63], v12 offset:7680
 s_waitcnt lgkmcnt(5)
 v_mfma_f32_32x32x16_bf16 v[64:79], a[40:43], v[40:43], v[64:79]
 v_mfma_f32_32x32x16_bf16 v[80:95], a[152:155], v[40:43], v[80:95]
 ds_read_b128 v[32:35], v12 offset:8192
 s_waitcnt lgkmcnt(5)
 v_mfma_f32_32x32x16_bf16 v[64:79], a[44:47], v[44:47], v[64:79]
 v_mfma_f32_32x32x16_bf16 v[80:95], a[156:159], v[44:47], v[80:95]
 ds_read_b128 v[36:39], v12 offset:8704
 s_waitcnt lgkmcnt(5)
 v_mfma_f32_32x32x16_bf16 v[64:79], a[48:51], v[48:51], v[64:79]
 v_mfma_f32_32x32x16_bf16 v[80:95], a[160:163], v[48:51], v[80:95]
 ds_read_b128 v[40:43], v12 offset:9216
 s_waitcnt lgkmcnt(5)
 v_mfma_f32_32x32x16_bf16 v[64:79], a[52:55], v[52:55], v[64:79]
 v_mfma_f32_32x32x16_bf16 v[80:95], a[164:167], v[52:55], v[80:95]
 ds_read_b128 v[44:47], v12 offset:9728
 s_waitcnt lgkmcnt(5)
 v_mfma_f32_32x32x16_bf16 v[64:79], a[56:59], v[56:59], v[64:79]
 v_mfma_f32_32x32x16_bf16 v[80:95], a[168:171], v[56:59], v[80:95]
 ds_read_b128 v[48:51], v12 offset:10240
 s_waitcnt lgkmcnt(5)
 v_mfma_f32_32x32x16_bf16 v[64:79], a[60:63], v[60:63], v[64:79]
 v_mfma_f32_32x32x16_bf16 v[80:95], a[172:175], v[60:63], v[80:95]
 ds_read_b128 v[52:55], v12 offset:10752
 s_waitcnt lgkmcnt(5)
 v_mfma_f32_32x32x16_bf16 v[64:79], a[64:67], v[32:35], v[64:79]
 v_mfma_f32_32x32x16_bf16 v[80:95], a[176:179], v[32:35], v[80:95]
 ds_read_b128 v[56:59], v12 offset:11264
 s_waitcnt lgkmcnt(5)
 v_mfma_f32_32x32x16_bf16 v[64:79], a[68:71], v[36:39], v[64:79]
 v_mfma_f32_32x32x16_bf16 v[80:95], a[180:183], v[36:39], v[80:95]
 ds_read_b128 v[60:63], v12 offset:11776
 s_waitcnt lgkmcnt(5)
 v_mfma_f32_32x32x16_bf16 v[64:79], a[72:75], v[40:43], v[64:79]
 v_mfma_f32_32x32x16_bf16 v[80:95], a[184:187], v[40:43], v[80:95]
 ds_read_b128 v[32:35], v12 offset:12288
 s_waitcnt lgkmcnt(5)
 v_mfma_f32_32x32x16_bf16 v[64:79], a[76:79], v[44:47], v[64:79]
 v_mfma_f32_32x32x16_bf16 v[80:95], a[188:191], v[44:47], v[80:95]
 ds_read_b128 v[36:39], v12 offset:12800
 s_waitcnt lgkmcnt(5)
 v_mfma_f32_32x32x16_bf16 v[64:79], a[80:83], v[48:51], v[64:79]
 v_mfma_f32_32x32x16_bf16 v[80:95], a[192:195], v[48:51], v[80:95]
 ds_read_b128 v[40:43], v12 offset:13312
 s_waitcnt lgkmcnt(5)
 v_mfma_f32_32x32x16_bf16 v[64:79], a[84:87], v[52:55], v[64:79]
 v_mfma_f32_32x32x16_bf16 v[80:95], a[196:199], v[52:55], v[80:95]
 ds_read_b128 v[44:47], v12 offset:13824
 s_waitcnt lgkmcnt(5)
 v_mfma_f32_32x32x16_bf16 v[64:79], a[88:91], v[56:59], v[64:79]
 v_mfma_f32_32x32x16_bf16 v[80:95], a[200:203], v[56:59], v[80:95]
 s_waitcnt lgkmcnt(4)
 v_mfma_f32_32x32x16_bf16 v[64:79], a[92:95], v[60:63], v[64:79]
 v_mfma_f32_32x32x16_bf16 v[80:95], a[204:207], v[60:63], v[80:95]
 s_waitcnt lgkmcnt(3)
 v_mfma_f32_32x32x16_bf16 v[64:79], a[96:99], v[32:35], v[64:79]
 v_mfma_f32_32x32x16_bf16 v[80:95], a[208:211], v[32:35], v[80:95]
 s_waitcnt lgkmcnt(2)
 v_mfma_f32_32x32x16_bf16 v[64:79], a[100:103], v[36:39], v[64:79]
 v_mfma_f32_32x32x16_bf16 v[80:95], a[212:215], v[36:39], v[80:95]
 s_waitcnt lgkmcnt(1)
 v_mfma_f32_32x32x16_bf16 v[64:79], a[104:107], v[40:43], v[64:79]
 v_mfma_f32_32x32x16_bf16 v[80:95], a[216:219], v[40:43], v[80:95]
 s_waitcnt lgkmcnt(0)
 v_mfma_f32_32x32x16_bf16 v[64:79], a[108:111], v[44:47], v[64:79]
 v_mfma_f32_32x32x16_bf16 v[80:95], a[220:223], v[44:47], v[80:95]
 s_nop 7
 v_cvt_pk_bf16_f32 v128, v64, v65
 v_cvt_pk_bf16_f32 v129, v66, v67
 v_cvt_pk_bf16_f32 v130, v68, v69
 v_cvt_pk_bf16_f32 v131, v70, v71
 v_add_u32 v13, 2048, v11
 global_store_dwordx4 v13, v[128:131], s[30:31] sc1
 v_cvt_pk_bf16_f32 v132, v72, v73
 v_cvt_pk_bf16_f32 v133, v74, v75
 v_cvt_pk_bf16_f32 v134, v76, v77
 v_cvt_pk_bf16_f32 v135, v78, v79
 v_add_u32 v13, 2304, v11
 global_store_dwordx4 v13, v[132:135], s[30:31] sc1
 s_nop 3
 v_cvt_pk_bf16_f32 v136, v80, v81
 v_cvt_pk_bf16_f32 v137, v82, v83
 v_cvt_pk_bf16_f32 v138, v84, v85
 v_cvt_pk_bf16_f32 v139, v86, v87
 v_add_u32 v13, 2048, v11
 global_store_dwordx4 v13, v[136:139], s[32:33] sc1
 v_cvt_pk_bf16_f32 v140, v88, v89
 v_cvt_pk_bf16_f32 v141, v90, v91
 v_cvt_pk_bf16_f32 v142, v92, v93
 v_cvt_pk_bf16_f32 v143, v94, v95
 v_add_u32 v13, 2304, v11
 global_store_dwordx4 v13, v[140:143], s[32:33] sc1
 s_waitcnt vmcnt(15)
 s_barrier
 v_add_u32 v12, 57600, v9
 ds_read_b128 v[32:35], v12 offset:0
 ds_read_b128 v[36:39], v12 offset:512
 ds_read_b128 v[40:43], v12 offset:1024
 ds_read_b128 v[44:47], v12 offset:1536
 ds_read_b128 v[48:51], v12 offset:2048
 ds_read_b128 v[52:55], v12 offset:2560
 s_waitcnt lgkmcnt(5)
 v_mfma_f32_32x32x16_bf16 v[64:79], a[0:3], v[32:35], 0
 v_mfma_f32_32x32x16_bf16 v[80:95], a[112:115], v[32:35], 0
 ds_read_b128 v[56:59], v12 offset:3072
 s_waitcnt lgkmcnt(5)
 v_mfma_f32_32x32x16_bf16 v[64:79], a[4:7], v[36:39], v[64:79]
 v_mfma_f32_32x32x16_bf16 v[80:95], a[116:119], v[36:39], v[80:95]
 ds_read_b128 v[60:63], v12 offset:3584
 s_waitcnt lgkmcnt(5)
 v_mfma_f32_32x32x16_bf16 v[64:79], a[8:11], v[40:43], v[64:79]
 v_mfma_f32_32x32x16_bf16 v[80:95], a[120:123], v[40:43], v[80:95]
 ds_read_b128 v[32:35], v12 offset:4096
 s_waitcnt lgkmcnt(5)
 v_mfma_f32_32x32x16_bf16 v[64:79], a[12:15], v[44:47], v[64:79]
 v_mfma_f32_32x32x16_bf16 v[80:95], a[124:127], v[44:47], v[80:95]
 ds_read_b128 v[36:39], v12 offset:4608
 s_waitcnt lgkmcnt(5)
 v_mfma_f32_32x32x16_bf16 v[64:79], a[16:19], v[48:51], v[64:79]
 v_mfma_f32_32x32x16_bf16 v[80:95], a[128:131], v[48:51], v[80:95]
 ds_read_b128 v[40:43], v12 offset:5120
 s_waitcnt lgkmcnt(5)
 v_mfma_f32_32x32x16_bf16 v[64:79], a[20:23], v[52:55], v[64:79]
 v_mfma_f32_32x32x16_bf16 v[80:95], a[132:135], v[52:55], v[80:95]
 ds_read_b128 v[44:47], v12 offset:5632
 s_waitcnt lgkmcnt(5)
 v_mfma_f32_32x32x16_bf16 v[64:79], a[24:27], v[56:59], v[64:79]
 v_mfma_f32_32x32x16_bf16 v[80:95], a[136:139], v[56:59], v[80:95]
 ds_read_b128 v[48:51], v12 offset:6144
 s_waitcnt lgkmcnt(5)
 v_mfma_f32_32x32x16_bf16 v[64:79], a[28:31], v[60:63], v[64:79]
 v_mfma_f32_32x32x16_bf16 v[80:95], a[140:143], v[60:63], v[80:95]
 ds_read_b128 v[52:55], v12 offset:6656
 s_waitcnt lgkmcnt(5)
 v_mfma_f32_32x32x16_bf16 v[64:79], a[32:35], v[32:35], v[64:79]
 v_mfma_f32_32x32x16_bf16 v[80:95], a[144:147], v[32:35], v[80:95]
 ds_read_b128 v[56:59], v12 offset:7168
 s_waitcnt lgkmcnt(5)
 v_mfma_f32_32x32x16_bf16 v[64:79], a[36:39], v[36:39], v[64:79]
 v_mfma_f32_32x32x16_bf16 v[80:95], a[148:151], v[36:39], v[80:95]
 ds_read_b128 v[60:63], v12 offset:7680
 s_waitcnt lgkmcnt(5)
 v_mfma_f32_32x32x16_bf16 v[64:79], a[40:43], v[40:43], v[64:79]
 v_mfma_f32_32x32x16_bf16 v[80:95], a[152:155], v[40:43], v[80:95]
 ds_read_b128 v[32:35], v12 offset:8192
 s_waitcnt lgkmcnt(5)
 v_mfma_f32_32x32x16_bf16 v[64:79], a[44:47], v[44:47], v[64:79]
 v_mfma_f32_32x32x16_bf16 v[80:95], a[156:159], v[44:47], v[80:95]
 ds_read_b128 v[36:39], v12 offset:8704
 s_waitcnt lgkmcnt(5)
 v_mfma_f32_32x32x16_bf16 v[64:79], a[48:51], v[48:51], v[64:79]
 v_mfma_f32_32x32x16_bf16 v[80:95], a[160:163], v[48:51], v[80:95]
 ds_read_b128 v[40:43], v12 offset:9216
 s_waitcnt lgkmcnt(5)
 v_mfma_f32_32x32x16_bf16 v[64:79], a[52:55], v[52:55], v[64:79]
 v_mfma_f32_32x32x16_bf16 v[80:95], a[164:167], v[52:55], v[80:95]
 ds_read_b128 v[44:47], v12 offset:9728
 s_waitcnt lgkmcnt(5)
 v_mfma_f32_32x32x16_bf16 v[64:79], a[56:59], v[56:59], v[64:79]
 v_mfma_f32_32x32x16_bf16 v[80:95], a[168:171], v[56:59], v[80:95]
 ds_read_b128 v[48:51], v12 offset:10240
 s_waitcnt lgkmcnt(5)
 v_mfma_f32_32x32x16_bf16 v[64:79], a[60:63], v[60:63], v[64:79]
 v_mfma_f32_32x32x16_bf16 v[80:95], a[172:175], v[60:63], v[80:95]
 ds_read_b128 v[52:55], v12 offset:10752
 s_waitcnt lgkmcnt(5)
 v_mfma_f32_32x32x16_bf16 v[64:79], a[64:67], v[32:35], v[64:79]
 v_mfma_f32_32x32x16_bf16 v[80:95], a[176:179], v[32:35], v[80:95]
 ds_read_b128 v[56:59], v12 offset:11264
 s_waitcnt lgkmcnt(5)
 v_mfma_f32_32x32x16_bf16 v[64:79], a[68:71], v[36:39], v[64:79]
 v_mfma_f32_32x32x16_bf16 v[80:95], a[180:183], v[36:39], v[80:95]
 ds_read_b128 v[60:63], v12 offset:11776
 s_waitcnt lgkmcnt(5)
 v_mfma_f32_32x32x16_bf16 v[64:79], a[72:75], v[40:43], v[64:79]
 v_mfma_f32_32x32x16_bf16 v[80:95], a[184:187], v[40:43], v[80:95]
 ds_read_b128 v[32:35], v12 offset:12288
 s_waitcnt lgkmcnt(5)
 v_mfma_f32_32x32x16_bf16 v[64:79], a[76:79], v[44:47], v[64:79]
 v_mfma_f32_32x32x16_bf16 v[80:95], a[188:191], v[44:47], v[80:95]
 ds_read_b128 v[36:39], v12 offset:12800
 s_waitcnt lgkmcnt(5)
 v_mfma_f32_32x32x16_bf16 v[64:79], a[80:83], v[48:51], v[64:79]
 v_mfma_f32_32x32x16_bf16 v[80:95], a[192:195], v[48:51], v[80:95]
 ds_read_b128 v[40:43], v12 offset:13312
 s_waitcnt lgkmcnt(5)
 v_mfma_f32_32x32x16_bf16 v[64:79], a[84:87], v[52:55], v[64:79]
 v_mfma_f32_32x32x16_bf16 v[80:95], a[196:199], v[52:55], v[80:95]
 ds_read_b128 v[44:47], v12 offset:13824
 s_waitcnt lgkmcnt(5)
 v_mfma_f32_32x32x16_bf16 v[64:79], a[88:91], v[56:59], v[64:79]
 v_mfma_f32_32x32x16_bf16 v[80:95], a[200:203], v[56:59], v[80:95]
 s_waitcnt lgkmcnt(4)
 v_mfma_f32_32x32x16_bf16 v[64:79], a[92:95], v[60:63], v[64:79]
 v_mfma_f32_32x32x16_bf16 v[80:95], a[204:207], v[60:63], v[80:95]
 s_waitcnt lgkmcnt(3)
 v_mfma_f32_32x32x16_bf16 v[64:79], a[96:99], v[32:35], v[64:79]
 v_mfma_f32_32x32x16_bf16 v[80:95], a[208:211], v[32:35], v[80:95]
 s_waitcnt lgkmcnt(2)
 v_mfma_f32_32x32x16_bf16 v[64:79], a[100:103], v[36:39], v[64:79]
 v_mfma_f32_32x32x16_bf16 v[80:95], a[212:215], v[36:39], v[80:95]
 s_waitcnt lgkmcnt(1)
 v_mfma_f32_32x32x16_bf16 v[64:79], a[104:107], v[40:43], v[64:79]
 v_mfma_f32_32x32x16_bf16 v[80:95], a[216:219], v[40:43], v[80:95]
 s_waitcnt lgkmcnt(0)
 v_mfma_f32_32x32x16_bf16 v[64:79], a[108:111], v[44:47], v[64:79]
 v_mfma_f32_32x32x16_bf16 v[80:95], a[220:223], v[44:47], v[80:95]
 s_nop 7
 v_cvt_pk_bf16_f32 v128, v64, v65
 v_cvt_pk_bf16_f32 v129, v66, v67
 v_cvt_pk_bf16_f32 v130, v68, v69
 v_cvt_pk_bf16_f32 v131, v70, v71
 v_add_u32 v13, 4096, v11
 global_store_dwordx4 v13, v[128:131], s[30:31] sc1
 v_cvt_pk_bf16_f32 v132, v72, v73
 v_cvt_pk_bf16_f32 v133, v74, v75
 v_cvt_pk_bf16_f32 v134, v76, v77
 v_cvt_pk_bf16_f32 v135, v78, v79
 v_add_u32 v13, 4352, v11
 global_store_dwordx4 v13, v[132:135], s[30:31] sc1
 s_nop 3
 v_cvt_pk_bf16_f32 v136, v80, v81
 v_cvt_pk_bf16_f32 v137, v82, v83
 v_cvt_pk_bf16_f32 v138, v84, v85
 v_cvt_pk_bf16_f32 v139, v86, v87
 v_add_u32 v13, 4096, v11
 global_store_dwordx4 v13, v[136:139], s[32:33] sc1
 v_cvt_pk_bf16_f32 v140, v88, v89
 v_cvt_pk_bf16_f32 v141, v90, v91
 v_cvt_pk_bf16_f32 v142, v92, v93
 v_cvt_pk_bf16_f32 v143, v94, v95
 v_add_u32 v13, 4352, v11
 global_store_dwordx4 v13, v[140:143], s[32:33] sc1
 s_waitcnt vmcnt(8)
 s_barrier
 v_add_u32 v12, 0, v9
 ds_read_b128 v[32:35], v12 offset:0
 ds_read_b128 v[36:39], v12 offset:512
 ds_read_b128 v[40:43], v12 offset:1024
 ds_read_b128 v[44:47], v12 offset:1536
 ds_read_b128 v[48:51], v12 offset:2048
 ds_read_b128 v[52:55], v12 offset:2560
 s_waitcnt lgkmcnt(5)
 v_mfma_f32_32x32x16_bf16 v[64:79], a[0:3], v[32:35], 0
 v_mfma_f32_32x32x16_bf16 v[80:95], a[112:115], v[32:35], 0
 ds_read_b128 v[56:59], v12 offset:3072
 s_waitcnt lgkmcnt(5)
 v_mfma_f32_32x32x16_bf16 v[64:79], a[4:7], v[36:39], v[64:79]
 v_mfma_f32_32x32x16_bf16 v[80:95], a[116:119], v[36:39], v[80:95]
 ds_read_b128 v[60:63], v12 offset:3584
 s_waitcnt lgkmcnt(5)
 v_mfma_f32_32x32x16_bf16 v[64:79], a[8:11], v[40:43], v[64:79]
 v_mfma_f32_32x32x16_bf16 v[80:95], a[120:123], v[40:43], v[80:95]
 ds_read_b128 v[32:35], v12 offset:4096
 s_waitcnt lgkmcnt(5)
 v_mfma_f32_32x32x16_bf16 v[64:79], a[12:15], v[44:47], v[64:79]
 v_mfma_f32_32x32x16_bf16 v[80:95], a[124:127], v[44:47], v[80:95]
 ds_read_b128 v[36:39], v12 offset:4608
 s_waitcnt lgkmcnt(5)
 v_mfma_f32_32x32x16_bf16 v[64:79], a[16:19], v[48:51], v[64:79]
 v_mfma_f32_32x32x16_bf16 v[80:95], a[128:131], v[48:51], v[80:95]
 ds_read_b128 v[40:43], v12 offset:5120
 s_waitcnt lgkmcnt(5)
 v_mfma_f32_32x32x16_bf16 v[64:79], a[20:23], v[52:55], v[64:79]
 v_mfma_f32_32x32x16_bf16 v[80:95], a[132:135], v[52:55], v[80:95]
 ds_read_b128 v[44:47], v12 offset:5632
 s_waitcnt lgkmcnt(5)
 v_mfma_f32_32x32x16_bf16 v[64:79], a[24:27], v[56:59], v[64:79]
 v_mfma_f32_32x32x16_bf16 v[80:95], a[136:139], v[56:59], v[80:95]
 ds_read_b128 v[48:51], v12 offset:6144
 s_waitcnt lgkmcnt(5)
 v_mfma_f32_32x32x16_bf16 v[64:79], a[28:31], v[60:63], v[64:79]
 v_mfma_f32_32x32x16_bf16 v[80:95], a[140:143], v[60:63], v[80:95]
 ds_read_b128 v[52:55], v12 offset:6656
 s_waitcnt lgkmcnt(5)
 v_mfma_f32_32x32x16_bf16 v[64:79], a[32:35], v[32:35], v[64:79]
 v_mfma_f32_32x32x16_bf16 v[80:95], a[144:147], v[32:35], v[80:95]
 ds_read_b128 v[56:59], v12 offset:7168
 s_waitcnt lgkmcnt(5)
 v_mfma_f32_32x32x16_bf16 v[64:79], a[36:39], v[36:39], v[64:79]
 v_mfma_f32_32x32x16_bf16 v[80:95], a[148:151], v[36:39], v[80:95]
 ds_read_b128 v[60:63], v12 offset:7680
 s_waitcnt lgkmcnt(5)
 v_mfma_f32_32x32x16_bf16 v[64:79], a[40:43], v[40:43], v[64:79]
 v_mfma_f32_32x32x16_bf16 v[80:95], a[152:155], v[40:43], v[80:95]
 ds_read_b128 v[32:35], v12 offset:8192
 s_waitcnt lgkmcnt(5)
 v_mfma_f32_32x32x16_bf16 v[64:79], a[44:47], v[44:47], v[64:79]
 v_mfma_f32_32x32x16_bf16 v[80:95], a[156:159], v[44:47], v[80:95]
 ds_read_b128 v[36:39], v12 offset:8704
 s_waitcnt lgkmcnt(5)
 v_mfma_f32_32x32x16_bf16 v[64:79], a[48:51], v[48:51], v[64:79]
 v_mfma_f32_32x32x16_bf16 v[80:95], a[160:163], v[48:51], v[80:95]
 ds_read_b128 v[40:43], v12 offset:9216
 s_waitcnt lgkmcnt(5)
 v_mfma_f32_32x32x16_bf16 v[64:79], a[52:55], v[52:55], v[64:79]
 v_mfma_f32_32x32x16_bf16 v[80:95], a[164:167], v[52:55], v[80:95]
 ds_read_b128 v[44:47], v12 offset:9728
 s_waitcnt lgkmcnt(5)
 v_mfma_f32_32x32x16_bf16 v[64:79], a[56:59], v[56:59], v[64:79]
 v_mfma_f32_32x32x16_bf16 v[80:95], a[168:171], v[56:59], v[80:95]
 ds_read_b128 v[48:51], v12 offset:10240
 s_waitcnt lgkmcnt(5)
 v_mfma_f32_32x32x16_bf16 v[64:79], a[60:63], v[60:63], v[64:79]
 v_mfma_f32_32x32x16_bf16 v[80:95], a[172:175], v[60:63], v[80:95]
 ds_read_b128 v[52:55], v12 offset:10752
 s_waitcnt lgkmcnt(5)
 v_mfma_f32_32x32x16_bf16 v[64:79], a[64:67], v[32:35], v[64:79]
 v_mfma_f32_32x32x16_bf16 v[80:95], a[176:179], v[32:35], v[80:95]
 ds_read_b128 v[56:59], v12 offset:11264
 s_waitcnt lgkmcnt(5)
 v_mfma_f32_32x32x16_bf16 v[64:79], a[68:71], v[36:39], v[64:79]
 v_mfma_f32_32x32x16_bf16 v[80:95], a[180:183], v[36:39], v[80:95]
 ds_read_b128 v[60:63], v12 offset:11776
 s_waitcnt lgkmcnt(5)
 v_mfma_f32_32x32x16_bf16 v[64:79], a[72:75], v[40:43], v[64:79]
 v_mfma_f32_32x32x16_bf16 v[80:95], a[184:187], v[40:43], v[80:95]
 ds_read_b128 v[32:35], v12 offset:12288
 s_waitcnt lgkmcnt(5)
 v_mfma_f32_32x32x16_bf16 v[64:79], a[76:79], v[44:47], v[64:79]
 v_mfma_f32_32x32x16_bf16 v[80:95], a[188:191], v[44:47], v[80:95]
 ds_read_b128 v[36:39], v12 offset:12800
 s_waitcnt lgkmcnt(5)
 v_mfma_f32_32x32x16_bf16 v[64:79], a[80:83], v[48:51], v[64:79]
 v_mfma_f32_32x32x16_bf16 v[80:95], a[192:195], v[48:51], v[80:95]
 ds_read_b128 v[40:43], v12 offset:13312
 s_waitcnt lgkmcnt(5)
 v_mfma_f32_32x32x16_bf16 v[64:79], a[84:87], v[52:55], v[64:79]
 v_mfma_f32_32x32x16_bf16 v[80:95], a[196:199], v[52:55], v[80:95]
 ds_read_b128 v[44:47], v12 offset:13824
 s_waitcnt lgkmcnt(5)
 v_mfma_f32_32x32x16_bf16 v[64:79], a[88:91], v[56:59], v[64:79]
 v_mfma_f32_32x32x16_bf16 v[80:95], a[200:203], v[56:59], v[80:95]
 s_waitcnt lgkmcnt(4)
 v_mfma_f32_32x32x16_bf16 v[64:79], a[92:95], v[60:63], v[64:79]
 v_mfma_f32_32x32x16_bf16 v[80:95], a[204:207], v[60:63], v[80:95]
 s_waitcnt lgkmcnt(3)
 v_mfma_f32_32x32x16_bf16 v[64:79], a[96:99], v[32:35], v[64:79]
 v_mfma_f32_32x32x16_bf16 v[80:95], a[208:211], v[32:35], v[80:95]
 s_waitcnt lgkmcnt(2)
 v_mfma_f32_32x32x16_bf16 v[64:79], a[100:103], v[36:39], v[64:79]
 v_mfma_f32_32x32x16_bf16 v[80:95], a[212:215], v[36:39], v[80:95]
 s_waitcnt lgkmcnt(1)
 v_mfma_f32_32x32x16_bf16 v[64:79], a[104:107], v[40:43], v[64:79]
 v_mfma_f32_32x32x16_bf16 v[80:95], a[216:219], v[40:43], v[80:95]
 s_waitcnt lgkmcnt(0)
 v_mfma_f32_32x32x16_bf16 v[64:79], a[108:111], v[44:47], v[64:79]
 v_mfma_f32_32x32x16_bf16 v[80:95], a[220:223], v[44:47], v[80:95]
 s_nop 7
 v_cvt_pk_bf16_f32 v128, v64, v65
 v_cvt_pk_bf16_f32 v129, v66, v67
 v_cvt_pk_bf16_f32 v130, v68, v69
 v_cvt_pk_bf16_f32 v131, v70, v71
 v_add_u32 v13, 6144, v11
 global_store_dwordx4 v13, v[128:131], s[30:31] sc1
 v_cvt_pk_bf16_f32 v132, v72, v73
 v_cvt_pk_bf16_f32 v133, v74, v75
 v_cvt_pk_bf16_f32 v134, v76, v77
 v_cvt_pk_bf16_f32 v135, v78, v79
 v_add_u32 v13, 6400, v11
 global_store_dwordx4 v13, v[132:135], s[30:31] sc1
 s_nop 3
 v_cvt_pk_bf16_f32 v136, v80, v81
 v_cvt_pk_bf16_f32 v137, v82, v83
 v_cvt_pk_bf16_f32 v138, v84, v85
 v_cvt_pk_bf16_f32 v139, v86, v87
 v_add_u32 v13, 6144, v11
 global_store_dwordx4 v13, v[136:139], s[32:33] sc1
 v_cvt_pk_bf16_f32 v140, v88, v89
 v_cvt_pk_bf16_f32 v141, v90, v91
 v_cvt_pk_bf16_f32 v142, v92, v93
 v_cvt_pk_bf16_f32 v143, v94, v95
 v_add_u32 v13, 6400, v11
 global_store_dwordx4 v13, v[140:143], s[32:33] sc1
 s_branch PVX_L
PVX_X:
 s_barrier
 s_cmp_lg_u32 s16, 0
 s_cbranch_scc1 RG_C1
 v_mov_b32 v1, 85590144
 v_mov_b32 v2, 1
 s_mov_b64 exec, 1
 global_atomic_add v3, v1, v2, s[4:5] sc0 sc1
 v_mov_b32 v1, 0x27F00
 s_waitcnt vmcnt(0)
 ds_write_b32 v1, v3
 s_mov_b64 exec, -1
 s_waitcnt lgkmcnt(0)
RG_C1:
 s_barrier
 v_mov_b32 v1, 0x27F00
 ds_read_b32 v2, v1
 s_waitcnt lgkmcnt(0)
 v_readfirstlane_b32 s17, v2
 s_cmp_lt_u32 s17, 28
 s_cbranch_scc1 K2_GAMMA
 s_mov_b32 s17, 0
PF1_L:
 s_waitcnt vmcnt(0)
 s_barrier
 s_cmp_lg_u32 s16, 0
 s_cbranch_scc1 PF1_C1
 s_mov_b64 exec, 1
 v_mov_b32 v2, 1
 s_cmp_eq_u32 s51, 0
 s_cbranch_scc1 PF1_T
 v_mov_b32 v1, s51
 v_mov_b32 v3, s52
 global_atomic_add v1, v3, s[4:5] sc1
PF1_T:
 s_lshl_b32 s20, s17, 8
 s_add_u32 s20, s20, 85593088
 v_mov_b32 v1, s20
 global_atomic_add v3, v1, v2, s[4:5] sc0 sc1
 s_cmp_lt_u32 s17, 4
 s_cselect_b32 s20, 128, 128
 s_waitcnt vmcnt(0)
 v_readfirstlane_b32 s18, v3
 s_cmp_lt_u32 s18, s20
 s_cbranch_scc1 PF1_W
 s_mov_b32 s18, -1
PF1_W:
 v_mov_b32 v1, 0x27F00
 v_mov_b32 v2, s18
 v_mov_b32 v3, s17
 ds_write_b64 v1, v[2:3]
 s_mov_b64 exec, -1
 s_waitcnt lgkmcnt(0)
PF1_C1:
 s_barrier
 v_mov_b32 v1, 0x27F00
 ds_read_b64 v[2:3], v1
 s_mov_b32 s51, 0
 s_mov_b32 s52, 1
 s_waitcnt lgkmcnt(0)
 v_readfirstlane_b32 s18, v2
 v_readfirstlane_b32 s17, v3
 s_cmp_eq_u32 s18, -1
 s_cbranch_scc1 PF1_X
 s_mov_b32 s51, 85609472
 v_and_b32 v2, 63, v0
 v_and_b32 v3, 31, v2
 v_lshrrev_b32 v4, 5, v2
 s_lshr_b32 s20, s18, 1
 s_and_b32 s21, s18, 1
 s_lshl_b32 s21, s21, 2
 s_add_u32 s21, s21, s16
 s_mul_i32 s22, s20, 896
 s_add_u32 s30, s10, s22
 s_addc_u32 s31, s11, 0
 v_mul_u32_u24 v5, 57344, v3
 v_lshl_add_u32 v5, v4, 4, v5
 s_mul_i32 s22, s21, 57344
 s_add_u32 s22, s22, 12845056
 s_add_u32 s32, s4, s22
 s_addc_u32 s33, s5, 0
 v_lshlrev_b32 v6, 4, v2
 v_add_u32 v7, 28672, v6
 global_load_dwordx4 a[0:3], v5, s[30:31] offset:0
 global_load_dwordx4 a[112:115], v6, s[32:33] offset:0
 global_load_dwordx4 v[128:131], v7, s[32:33] offset:0
 global_load_dwordx4 a[4:7], v5, s[30:31] offset:32
 global_load_dwordx4 a[116:119], v6, s[32:33] offset:1024
 global_load_dwordx4 v[132:135], v7, s[32:33] offset:1024
 global_load_dwordx4 a[8:11], v5, s[30:31] offset:64
 global_load_dwordx4 a[120:123], v6, s[32:33] offset:2048
 global_load_dwordx4 v[136:139], v7, s[32:33] offset:2048
 global_load_dwordx4 a[12:15], v5, s[30:31] offset:96
 global_load_dwordx4 a[124:127], v6, s[32:33] offset:3072
 global_load_dwordx4 v[140:143], v7, s[32:33] offset:3072
 v_add_u32 v6, 4096, v6
 v_add_u32 v7, 4096, v7
 global_load_dwordx4 a[16:19], v5, s[30:31] offset:128
 global_load_dwordx4 a[128:131], v6, s[32:33] offset:0
 global_load_dwordx4 v[144:147], v7, s[32:33] offset:0
 global_load_dwordx4 a[20:23], v5, s[30:31] offset:160
 global_load_dwordx4 a[132:135], v6, s[32:33] offset:1024
 global_load_dwordx4 v[148:151], v7, s[32:33] offset:1024
 global_load_dwordx4 a[24:27], v5, s[30:31] offset:192
 global_load_dwordx4 a[136:139], v6, s[32:33] offset:2048
 global_load_dwordx4 v[152:155], v7, s[32:33] offset:2048
 global_load_dwordx4 a[28:31], v5, s[30:31] offset:224
 global_load_dwordx4 a[140:143], v6, s[32:33] offset:3072
 global_load_dwordx4 v[156:159], v7, s[32:33] offset:3072
 v_add_u32 v6, 4096, v6
 v_add_u32 v7, 4096, v7
 global_load_dwordx4 a[32:35], v5, s[30:31] offset:256
 global_load_dwordx4 a[144:147], v6, s[32:33] offset:0
 global_load_dwordx4 v[160:163], v7, s[32:33] offset:0
 global_load_dwordx4 a[36:39], v5, s[30:31] offset:288
 global_load_dwordx4 a[148:151], v6, s[32:33] offset:1024
 global_load_dwordx4 v[164:167], v7, s[32:33] offset:1024
 global_load_dwordx4 a[40:43], v5, s[30:31] offset:320
 global_load_dwordx4 a[152:155], v6, s[32:33] offset:2048
 global_load_dwordx4 v[168:171], v7, s[32:33] offset:2048
 global_load_dwordx4 a[44:47], v5, s[30:31] offset:352
 global_load_dwordx4 a[156:159], v6, s[32:33] offset:3072
 global_load_dwordx4 v[172:175], v7, s[32:33] offset:3072
 v_add_u32 v6, 4096, v6
 v_add_u32 v7, 4096, v7
 global_load_dwordx4 a[48:51], v5, s[30:31] offset:384
 global_load_dwordx4 a[160:163], v6, s[32:33] offset:0
 global_load_dwordx4 v[176:179], v7, s[32:33] offset:0
 global_load_dwordx4 a[52:55], v5, s[30:31] offset:416
 global_load_dwordx4 a[164:167], v6, s[32:33] offset:1024
 global_load_dwordx4 v[180:183], v7, s[32:33] offset:1024
 global_load_dwordx4 a[56:59], v5, s[30:31] offset:448
 global_load_dwordx4 a[168:171], v6, s[32:33] offset:2048
 global_load_dwordx4 v[184:187], v7, s[32:33] offset:2048
 global_load_dwordx4 a[60:63], v5, s[30:31] offset:480
 global_load_dwordx4 a[172:175], v6, s[32:33] offset:3072
 global_load_dwordx4 v[188:191], v7, s[32:33] offset:3072
 v_add_u32 v6, 4096, v6
 v_add_u32 v7, 4096, v7
 global_load_dwordx4 a[64:67], v5, s[30:31] offset:512
 global_load_dwordx4 a[176:179], v6, s[32:33] offset:0
 global_load_dwordx4 v[192:195], v7, s[32:33] offset:0
 global_load_dwordx4 a[68:71], v5, s[30:31] offset:544
 global_load_dwordx4 a[180:183], v6, s[32:33] offset:1024
 global_load_dwordx4 v[196:199], v7, s[32:33] offset:1024
 global_load_dwordx4 a[72:75], v5, s[30:31] offset:576
 global_load_dwordx4 a[184:187], v6, s[32:33] offset:2048
 global_load_dwordx4 v[200:203], v7, s[32:33] offset:2048
 global_load_dwordx4 a[76:79], v5, s[30:31] offset:608
 global_load_dwordx4 a[188:191], v6, s[32:33] offset:3072
 global_load_dwordx4 v[204:207], v7, s[32:33] offset:3072
 v_add_u32 v6, 4096, v6
 v_add_u32 v7, 4096, v7
 global_load_dwordx4 a[80:83], v5, s[30:31] offset:640
 global_load_dwordx4 a[192:195], v6, s[32:33] offset:0
 global_load_dwordx4 v[208:211], v7, s[32:33] offset:0
 global_load_dwordx4 a[84:87], v5, s[30:31] offset:672
 global_load_dwordx4 a[196:199], v6, s[32:33] offset:1024
 global_load_dwordx4 v[212:215], v7, s[32:33] offset:1024
 global_load_dwordx4 a[88:91], v5, s[30:31] offset:704
 global_load_dwordx4 a[200:203], v6, s[32:33] offset:2048
 global_load_dwordx4 v[216:219], v7, s[32:33] offset:2048
 global_load_dwordx4 a[92:95], v5, s[30:31] offset:736
 global_load_dwordx4 a[204:207], v6, s[32:33] offset:3072
 global_load_dwordx4 v[220:223], v7, s[32:33] offset:3072
 v_add_u32 v6, 4096, v6
 v_add_u32 v7, 4096, v7
 global_load_dwordx4 a[96:99], v5, s[30:31] offset:768
 global_load_dwordx4 a[208:211], v6, s[32:33] offset:0
 global_load_dwordx4 v[224:227], v7, s[32:33] offset:0
 global_load_dwordx4 a[100:103], v5, s[30:31] offset:800
 global_load_dwordx4 a[212:215], v6, s[32:33] offset:1024
 global_load_dwordx4 v[228:231], v7, s[32:33] offset:1024
 global_load_dwordx4 a[104:107], v5, s[30:31] offset:832
 global_load_dwordx4 a[216:219], v6, s[32:33] offset:2048
 global_load_dwordx4 v[232:235], v7, s[32:33] offset:2048
 global_load_dwordx4 a[108:111], v5, s[30:31] offset:864
 global_load_dwordx4 a[220:223], v6, s[32:33] offset:3072
 global_load_dwordx4 v[236:239], v7, s[32:33] offset:3072
 v_lshlrev_b32 v8, 8, v4
 v_add_u32 v8, s20, v8
 v_add_u32 v16, 0, v8
 v_mul_u32_u24 v16, v16, v3
 v_and_b32 v16, 2047, v16
 v_cvt_f32_u32 v16, v16
 v_mul_f32 v16, 973078528, v16
 v_cos_f32 v20, v16
 v_sin_f32 v22, v16
 v_add_u32 v16, 64, v8
 v_mul_u32_u24 v16, v16, v3
 v_and_b32 v16, 2047, v16
 v_cvt_f32_u32 v16, v16
 v_mul_f32 v16, 973078528, v16
 v_cos_f32 v21, v16
 v_sin_f32 v23, v16
 v_cvt_pk_bf16_f32 v32, v20, v21
 v_cvt_pk_bf16_f32 v40, v22, v23
 v_xor_b32 v48, 0x80008000, v40
 v_add_u32 v16, 128, v8
 v_mul_u32_u24 v16, v16, v3
 v_and_b32 v16, 2047, v16
 v_cvt_f32_u32 v16, v16
 v_mul_f32 v16, 973078528, v16
 v_cos_f32 v20, v16
 v_sin_f32 v22, v16
 v_add_u32 v16, 192, v8
 v_mul_u32_u24 v16, v16, v3
 v_and_b32 v16, 2047, v16
 v_cvt_f32_u32 v16, v16
 v_mul_f32 v16, 973078528, v16
 v_cos_f32 v21, v16
 v_sin_f32 v23, v16
 v_cvt_pk_bf16_f32 v33, v20, v21
 v_cvt_pk_bf16_f32 v41, v22, v23
 v_xor_b32 v49, 0x80008000, v41
 v_add_u32 v16, 512, v8
 v_mul_u32_u24 v16, v16, v3
 v_and_b32 v16, 2047, v16
 v_cvt_f32_u32 v16, v16
 v_mul_f32 v16, 973078528, v16
 v_cos_f32 v20, v16
 v_sin_f32 v22, v16
 v_add_u32 v16, 576, v8
 v_mul_u32_u24 v16, v16, v3
 v_and_b32 v16, 2047, v16
 v_cvt_f32_u32 v16, v16
 v_mul_f32 v16, 973078528, v16
 v_cos_f32 v21, v16
 v_sin_f32 v23, v16
 v_cvt_pk_bf16_f32 v34, v20, v21
 v_cvt_pk_bf16_f32 v42, v22, v23
 v_xor_b32 v50, 0x80008000, v42
 v_add_u32 v16, 640, v8
 v_mul_u32_u24 v16, v16, v3
 v_and_b32 v16, 2047, v16
 v_cvt_f32_u32 v16, v16
 v_mul_f32 v16, 973078528, v16
 v_cos_f32 v20, v16
 v_sin_f32 v22, v16
 v_add_u32 v16, 704, v8
 v_mul_u32_u24 v16, v16, v3
 v_and_b32 v16, 2047, v16
 v_cvt_f32_u32 v16, v16
 v_mul_f32 v16, 973078528, v16
 v_cos_f32 v21, v16
 v_sin_f32 v23, v16
 v_cvt_pk_bf16_f32 v35, v20, v21
 v_cvt_pk_bf16_f32 v43, v22, v23
 v_xor_b32 v51, 0x80008000, v43
 v_add_u32 v16, 1024, v8
 v_mul_u32_u24 v16, v16, v3
 v_and_b32 v16, 2047, v16
 v_cvt_f32_u32 v16, v16
 v_mul_f32 v16, 973078528, v16
 v_cos_f32 v20, v16
 v_sin_f32 v22, v16
 v_add_u32 v16, 1088, v8
 v_mul_u32_u24 v16, v16, v3
 v_and_b32 v16, 2047, v16
 v_cvt_f32_u32 v16, v16
 v_mul_f32 v16, 973078528, v16
 v_cos_f32 v21, v16
 v_sin_f32 v23, v16
 v_cvt_pk_bf16_f32 v36, v20, v21
 v_cvt_pk_bf16_f32 v44, v22, v23
 v_xor_b32 v52, 0x80008000, v44
 v_add_u32 v16, 1152, v8
 v_mul_u32_u24 v16, v16, v3
 v_and_b32 v16, 2047, v16
 v_cvt_f32_u32 v16, v16
 v_mul_f32 v16, 973078528, v16
 v_cos_f32 v20, v16
 v_sin_f32 v22, v16
 v_add_u32 v16, 1216, v8
 v_mul_u32_u24 v16, v16, v3
 v_and_b32 v16, 2047, v16
 v_cvt_f32_u32 v16, v16
 v_mul_f32 v16, 973078528, v16
 v_cos_f32 v21, v16
 v_sin_f32 v23, v16
 v_cvt_pk_bf16_f32 v37, v20, v21
 v_cvt_pk_bf16_f32 v45, v22, v23
 v_xor_b32 v53, 0x80008000, v45
 v_add_u32 v16, 1536, v8
 v_mul_u32_u24 v16, v16, v3
 v_and_b32 v16, 2047, v16
 v_cvt_f32_u32 v16, v16
 v_mul_f32 v16, 973078528, v16
 v_cos_f32 v20, v16
 v_sin_f32 v22, v16
 v_add_u32 v16, 1600, v8
 v_mul_u32_u24 v16, v16, v3
 v_and_b32 v16, 2047, v16
 v_cvt_f32_u32 v16, v16
 v_mul_f32 v16, 973078528, v16
 v_cos_f32 v21, v16
 v_sin_f32 v23, v16
 v_cvt_pk_bf16_f32 v38, v20, v21
 v_cvt_pk_bf16_f32 v46, v22, v23
 v_xor_b32 v54, 0x80008000, v46
 v_add_u32 v16, 1664, v8
 v_mul_u32_u24 v16, v16, v3
 v_and_b32 v16, 2047, v16
 v_cvt_f32_u32 v16, v16
 v_mul_f32 v16, 973078528, v16
 v_cos_f32 v20, v16
 v_sin_f32 v22, v16
 v_add_u32 v16, 1728, v8
 v_mul_u32_u24 v16, v16, v3
 v_and_b32 v16, 2047, v16
 v_cvt_f32_u32 v16, v16
 v_mul_f32 v16, 973078528, v16
 v_cos_f32 v21, v16
 v_sin_f32 v23, v16
 v_cvt_pk_bf16_f32 v39, v20, v21
 v_cvt_pk_bf16_f32 v47, v22, v23
 v_xor_b32 v55, 0x80008000, v47
 s_waitcnt vmcnt(63)
 v_mfma_f32_32x32x16_bf16 v[64:79], a[0:3], a[112:115], 0
 v_mfma_f32_32x32x16_bf16 v[80:95], a[0:3], v[128:131], 0
 s_waitcnt vmcnt(63)
 v_mfma_f32_32x32x16_bf16 v[64:79], a[4:7], a[116:119], v[64:79]
 v_mfma_f32_32x32x16_bf16 v[80:95], a[4:7], v[132:135], v[80:95]
 s_waitcnt vmcnt(63)
 v_mfma_f32_32x32x16_bf16 v[64:79], a[8:11], a[120:123], v[64:79]
 v_mfma_f32_32x32x16_bf16 v[80:95], a[8:11], v[136:139], v[80:95]
 s_waitcnt vmcnt(63)
 v_mfma_f32_32x32x16_bf16 v[64:79], a[12:15], a[124:127], v[64:79]
 v_mfma_f32_32x32x16_bf16 v[80:95], a[12:15], v[140:143], v[80:95]
 s_waitcnt vmcnt(63)
 v_mfma_f32_32x32x16_bf16 v[64:79], a[16:19], a[128:131], v[64:79]
 v_mfma_f32_32x32x16_bf16 v[80:95], a[16:19], v[144:147], v[80:95]
 s_waitcnt vmcnt(63)
 v_mfma_f32_32x32x16_bf16 v[64:79], a[20:23], a[132:135], v[64:79]
 v_mfma_f32_32x32x16_bf16 v[80:95], a[20:23], v[148:151], v[80:95]
 s_waitcnt vmcnt(63)
 v_mfma_f32_32x32x16_bf16 v[64:79], a[24:27], a[136:139], v[64:79]
 v_mfma_f32_32x32x16_bf16 v[80:95], a[24:27], v[152:155], v[80:95]
 s_waitcnt vmcnt(60)
 v_mfma_f32_32x32x16_bf16 v[64:79], a[28:31], a[140:143], v[64:79]
 v_mfma_f32_32x32x16_bf16 v[80:95], a[28:31], v[156:159], v[80:95]
 s_waitcnt vmcnt(57)
 v_mfma_f32_32x32x16_bf16 v[64:79], a[32:35], a[144:147], v[64:79]
 v_mfma_f32_32x32x16_bf16 v[80:95], a[32:35], v[160:163], v[80:95]
 s_waitcnt vmcnt(54)
 v_mfma_f32_32x32x16_bf16 v[64:79], a[36:39], a[148:151], v[64:79]
 v_mfma_f32_32x32x16_bf16 v[80:95], a[36:39], v[164:167], v[80:95]
 s_waitcnt vmcnt(51)
 v_mfma_f32_32x32x16_bf16 v[64:79], a[40:43], a[152:155], v[64:79]
 v_mfma_f32_32x32x16_bf16 v[80:95], a[40:43], v[168:171], v[80:95]
 s_waitcnt vmcnt(48)
 v_mfma_f32_32x32x16_bf16 v[64:79], a[44:47], a[156:159], v[64:79]
 v_mfma_f32_32x32x16_bf16 v[80:95], a[44:47], v[172:175], v[80:95]
 s_waitcnt vmcnt(45)
 v_mfma_f32_32x32x16_bf16 v[64:79], a[48:51], a[160:163], v[64:79]
 v_mfma_f32_32x32x16_bf16 v[80:95], a[48:51], v[176:179], v[80:95]
 s_waitcnt vmcnt(42)
 v_mfma_f32_32x32x16_bf16 v[64:79], a[52:55], a[164:167], v[64:79]
 v_mfma_f32_32x32x16_bf16 v[80:95], a[52:55], v[180:183], v[80:95]
 s_waitcnt vmcnt(39)
 v_mfma_f32_32x32x16_bf16 v[64:79], a[56:59], a[168:171], v[64:79]
 v_mfma_f32_32x32x16_bf16 v[80:95], a[56:59], v[184:187], v[80:95]
 s_waitcnt vmcnt(36)
 v_mfma_f32_32x32x16_bf16 v[64:79], a[60:63], a[172:175], v[64:79]
 v_mfma_f32_32x32x16_bf16 v[80:95], a[60:63], v[188:191], v[80:95]
 s_waitcnt vmcnt(33)
 v_mfma_f32_32x32x16_bf16 v[64:79], a[64:67], a[176:179], v[64:79]
 v_mfma_f32_32x32x16_bf16 v[80:95], a[64:67], v[192:195], v[80:95]
 s_waitcnt vmcnt(30)
 v_mfma_f32_32x32x16_bf16 v[64:79], a[68:71], a[180:183], v[64:79]
 v_mfma_f32_32x32x16_bf16 v[80:95], a[68:71], v[196:199], v[80:95]
 s_waitcnt vmcnt(27)
 v_mfma_f32_32x32x16_bf16 v[64:79], a[72:75], a[184:187], v[64:79]
 v_mfma_f32_32x32x16_bf16 v[80:95], a[72:75], v[200:203], v[80:95]
 s_waitcnt vmcnt(24)
 v_mfma_f32_32x32x16_bf16 v[64:79], a[76:79], a[188:191], v[64:79]
 v_mfma_f32_32x32x16_bf16 v[80:95], a[76:79], v[204:207], v[80:95]
 s_waitcnt vmcnt(21)
 v_mfma_f32_32x32x16_bf16 v[64:79], a[80:83], a[192:195], v[64:79]
 v_mfma_f32_32x32x16_bf16 v[80:95], a[80:83], v[208:211], v[80:95]
 s_waitcnt vmcnt(18)
 v_mfma_f32_32x32x16_bf16 v[64:79], a[84:87], a[196:199], v[64:79]
 v_mfma_f32_32x32x16_bf16 v[80:95], a[84:87], v[212:215], v[80:95]
 s_waitcnt vmcnt(15)
 v_mfma_f32_32x32x16_bf16 v[64:79], a[88:91], a[200:203], v[64:79]
 v_mfma_f32_32x32x16_bf16 v[80:95], a[88:91], v[216:219], v[80:95]
 s_waitcnt vmcnt(12)
 v_mfma_f32_32x32x16_bf16 v[64:79], a[92:95], a[204:207], v[64:79]
 v_mfma_f32_32x32x16_bf16 v[80:95], a[92:95], v[220:223], v[80:95]
 s_waitcnt vmcnt(9)
 v_mfma_f32_32x32x16_bf16 v[64:79], a[96:99], a[208:211], v[64:79]
 v_mfma_f32_32x32x16_bf16 v[80:95], a[96:99], v[224:227], v[80:95]
 s_waitcnt vmcnt(6)
 v_mfma_f32_32x32x16_bf16 v[64:79], a[100:103], a[212:215], v[64:79]
 v_mfma_f32_32x32x16_bf16 v[80:95], a[100:103], v[228:231], v[80:95]
 s_waitcnt vmcnt(3)
 v_mfma_f32_32x32x16_bf16 v[64:79], a[104:107], a[216:219], v[64:79]
 v_mfma_f32_32x32x16_bf16 v[80:95], a[104:107], v[232:235], v[80:95]
 s_waitcnt vmcnt(0)
 v_mfma_f32_32x32x16_bf16 v[64:79], a[108:111], a[220:223], v[64:79]
 v_mfma_f32_32x32x16_bf16 v[80:95], a[108:111], v[236:239], v[80:95]
 s_nop 7
 v_cvt_pk_bf16_f32 v96, v64, v65
 v_cvt_pk_bf16_f32 v97, v66, v67
 v_cvt_pk_bf16_f32 v98, v68, v69
 v_cvt_pk_bf16_f32 v99, v70, v71
 v_cvt_pk_bf16_f32 v100, v72, v73
 v_cvt_pk_bf16_f32 v101, v74, v75
 v_cvt_pk_bf16_f32 v102, v76, v77
 v_cvt_pk_bf16_f32 v103, v78, v79
 v_cvt_pk_bf16_f32 v104, v80, v81
 v_cvt_pk_bf16_f32 v105, v82, v83
 v_cvt_pk_bf16_f32 v106, v84, v85
 v_cvt_pk_bf16_f32 v107, v86, v87
 v_cvt_pk_bf16_f32 v108, v88, v89
 v_cvt_pk_bf16_f32 v109, v90, v91
 v_cvt_pk_bf16_f32 v110, v92, v93
 v_cvt_pk_bf16_f32 v111, v94, v95
 v_mfma_f32_32x32x16_bf16 v[64:79], v[96:99], v[32:35], 0
 v_mfma_f32_32x32x16_bf16 v[80:95], v[104:107], v[32:35], 0
 v_mfma_f32_32x32x16_bf16 v[64:79], v[104:107], v[48:51], v[64:79]
 v_mfma_f32_32x32x16_bf16 v[80:95], v[96:99], v[40:43], v[80:95]
 v_mfma_f32_32x32x16_bf16 v[64:79], v[100:103], v[36:39], v[64:79]
 v_mfma_f32_32x32x16_bf16 v[80:95], v[108:111], v[36:39], v[80:95]
 v_mfma_f32_32x32x16_bf16 v[64:79], v[108:111], v[52:55], v[64:79]
 v_mfma_f32_32x32x16_bf16 v[80:95], v[100:103], v[44:47], v[80:95]
 s_lshl_b32 s22, s20, 10
 s_lshl_b32 s23, s21, 6
 s_add_u32 s22, s22, s23
 s_add_u32 s22, s22, 14876672
 s_add_u32 s30, s4, s22
 s_addc_u32 s31, s5, 0
 v_lshlrev_b32 v5, 16, v3
 v_lshl_add_u32 v5, v4, 4, v5
 v_cvt_pk_bf16_f32 v112, v64, v65
 v_cvt_pk_bf16_f32 v113, v66, v67
 v_cvt_pk_bf16_f32 v114, v68, v69
 v_cvt_pk_bf16_f32 v115, v70, v71
 global_store_dwordx4 v5, v[112:115], s[30:31] offset:0 sc1
 v_cvt_pk_bf16_f32 v116, v72, v73
 v_cvt_pk_bf16_f32 v117, v74, v75
 v_cvt_pk_bf16_f32 v118, v76, v77
 v_cvt_pk_bf16_f32 v119, v78, v79
 global_store_dwordx4 v5, v[116:119], s[30:31] offset:32 sc1
 v_cvt_pk_bf16_f32 v120, v80, v81
 v_cvt_pk_bf16_f32 v121, v82, v83
 v_cvt_pk_bf16_f32 v122, v84, v85
 v_cvt_pk_bf16_f32 v123, v86, v87
 global_store_dwordx4 v5, v[120:123], s[30:31] offset:512 sc1
 v_cvt_pk_bf16_f32 v124, v88, v89
 v_cvt_pk_bf16_f32 v125, v90, v91
 v_cvt_pk_bf16_f32 v126, v92, v93
 v_cvt_pk_bf16_f32 v127, v94, v95
 global_store_dwordx4 v5, v[124:127], s[30:31] offset:544 sc1
 s_branch PF1_L
PF1_X:
 s_mov_b32 s17, s50
PQX_L:
 s_waitcnt vmcnt(0)
 s_barrier
 s_cmp_lg_u32 s16, 0
 s_cbranch_scc1 PQX_C1
 s_mov_b64 exec, 1
 v_mov_b32 v2, 1
 s_cmp_eq_u32 s51, 0
 s_cbranch_scc1 PQX_T
 v_mov_b32 v1, s51
 v_mov_b32 v3, s52
 global_atomic_add v1, v3, s[4:5] sc1
PQX_T:
 s_lshl_b32 s20, s17, 8
 s_add_u32 s20, s20, 85595136
 v_mov_b32 v1, s20
 global_atomic_add v3, v1, v2, s[4:5] sc0 sc1
 s_cmp_lt_u32 s17, 4
 s_cselect_b32 s20, 40, 32
 s_waitcnt vmcnt(0)
 v_readfirstlane_b32 s18, v3
 s_cmp_lt_u32 s18, s20
 s_cbranch_scc1 PQX_W
 s_mov_b32 s18, -1
 s_mov_b64 exec, 127
 v_lshlrev_b32 v1, 8, v0
 v_add_u32 v1, 85595136, v1
 global_load_dword v3, v1, s[4:5] sc1
 v_mov_b32 v4, 32
 v_mov_b32 v5, 40
 v_cmp_gt_u32 vcc, 4, v0
 s_nop 1
 v_cndmask_b32 v4, v4, v5, vcc
 s_waitcnt vmcnt(0)
 v_cmp_lt_u32 vcc, v3, v4
 s_mov_b64 exec, 1
 s_cbranch_vccz PQX_W
 s_ff1_i32_b32 s17, vcc_lo
 s_branch PQX_T
PQX_W:
 v_mov_b32 v1, 0x27F00
 v_mov_b32 v2, s18
 v_mov_b32 v3, s17
 ds_write_b64 v1, v[2:3]
 s_mov_b64 exec, -1
 s_waitcnt lgkmcnt(0)
PQX_C1:
 s_barrier
 v_mov_b32 v1, 0x27F00
 ds_read_b64 v[2:3], v1
 s_mov_b32 s51, 0
 s_mov_b32 s52, 1
 s_waitcnt lgkmcnt(0)
 v_readfirstlane_b32 s18, v2
 v_readfirstlane_b32 s17, v3
 s_cmp_eq_u32 s18, -1
 s_cbranch_scc1 PQX_X
 v_and_b32 v2, 63, v0
 v_and_b32 v3, 31, v2
 v_lshrrev_b32 v4, 5, v2
 s_and_b32 s20, s18, 7
 s_lshr_b32 s21, s18, 3
 s_mul_i32 s21, s21, 7
 s_add_u32 s21, s21, s17
 s_lshr_b32 s22, s21, 1
 s_and_b32 s23, s21, 1
 s_mul_i32 s24, s22, 401408
 s_mul_i32 s25, s23, 200704
 s_add_u32 s24, s24, s25
 s_add_u32 s24, s24, 0
 s_lshr_b32 s25, s16, 1
 s_mul_i32 s27, s25, 100352
 s_add_u32 s27, s27, s24
 s_add_u32 s27, s27, 86016
 s_mul_i32 s25, s25, 14336
 s_add_u32 s24, s24, s25
 s_mul_i32 s26, s22, 28672
 s_mul_i32 s25, s23, 14336
 s_add_u32 s26, s26, s25
 s_add_u32 s26, s26, 55771136
 s_lshl_b32 s51, s20, 8
 s_add_u32 s51, s51, 85610496
 s_lshl_b32 s20, s20, 3
 s_lshl_b32 s25, s16, 1
 s_add_u32 s20, s20, s25
 s_mul_i32 s25, s20, 458752
 s_add_u32 s26, s26, s25
 s_add_u32 s30, s4, s26
 s_addc_u32 s31, s5, 0
 s_add_u32 s32, s30, 458752
 s_addc_u32 s33, s31, 0
 s_mul_i32 s25, s20, 28672
 s_add_u32 s25, s25, 85655552
 s_add_u32 s34, s4, s25
 s_addc_u32 s35, s5, 0
 s_and_b32 s25, s16, 1
 s_mul_i32 s25, s25, 7168
 v_lshlrev_b32 v5, 4, v2
 v_add_u32 v6, s25, v5
 v_add_u32 v7, 4096, v6
 s_lshr_b32 s28, s16, 1
 s_mul_i32 s28, s28, 14464
 s_add_u32 s28, s28, s25
 s_barrier
 s_add_u32 s36, s24, 0
 s_add_u32 s36, s4, s36
 s_addc_u32 s37, s5, 0
 s_add_u32 m0, s28, 0
 s_nop 0
 global_load_lds_dwordx4 v6, s[36:37] offset:0
 global_load_lds_dwordx4 v6, s[36:37] offset:1024
 global_load_lds_dwordx4 v6, s[36:37] offset:2048
 global_load_lds_dwordx4 v6, s[36:37] offset:3072
 s_add_u32 m0, s28, 4096
 s_nop 0
 global_load_lds_dwordx4 v7, s[36:37] offset:0
 global_load_lds_dwordx4 v7, s[36:37] offset:1024
 global_load_lds_dwordx4 v7, s[36:37] offset:2048
 v_mov_b32 v8, v5
 global_load_dwordx4 a[0:3], v8, s[34:35] offset:0
 global_load_dwordx4 a[4:7], v8, s[34:35] offset:1024
 global_load_dwordx4 a[8:11], v8, s[34:35] offset:2048
 global_load_dwordx4 a[12:15], v8, s[34:35] offset:3072
 v_add_u32 v8, 4096, v8
 global_load_dwordx4 a[16:19], v8, s[34:35] offset:0
 global_load_dwordx4 a[20:23], v8, s[34:35] offset:1024
 global_load_dwordx4 a[24:27], v8, s[34:35] offset:2048
 global_load_dwordx4 a[28:31], v8, s[34:35] offset:3072
 v_add_u32 v8, 4096, v8
 global_load_dwordx4 a[32:35], v8, s[34:35] offset:0
 global_load_dwordx4 a[36:39], v8, s[34:35] offset:1024
 global_load_dwordx4 a[40:43], v8, s[34:35] offset:2048
 global_load_dwordx4 a[44:47], v8, s[34:35] offset:3072
 v_add_u32 v8, 4096, v8
 global_load_dwordx4 a[48:51], v8, s[34:35] offset:0
 global_load_dwordx4 a[52:55], v8, s[34:35] offset:1024
 global_load_dwordx4 a[56:59], v8, s[34:35] offset:2048
 global_load_dwordx4 a[60:63], v8, s[34:35] offset:3072
 v_add_u32 v8, 4096, v8
 global_load_dwordx4 a[64:67], v8, s[34:35] offset:0
 global_load_dwordx4 a[68:71], v8, s[34:35] offset:1024
 global_load_dwordx4 a[72:75], v8, s[34:35] offset:2048
 global_load_dwordx4 a[76:79], v8, s[34:35] offset:3072
 v_add_u32 v8, 4096, v8
 global_load_dwordx4 a[80:83], v8, s[34:35] offset:0
 global_load_dwordx4 a[84:87], v8, s[34:35] offset:1024
 global_load_dwordx4 a[88:91], v8, s[34:35] offset:2048
 global_load_dwordx4 a[92:95], v8, s[34:35] offset:3072
 v_add_u32 v8, 4096, v8
 global_load_dwordx4 a[96:99], v8, s[34:35] offset:0
 global_load_dwordx4 a[100:103], v8, s[34:35] offset:1024
 global_load_dwordx4 a[104:107], v8, s[34:35] offset:2048
 global_load_dwordx4 a[108:111], v8, s[34:35] offset:3072
 v_add_u32 v8, 4096, v8
 global_load_dwordx4 a[112:115], v8, s[34:35] offset:0
 global_load_dwordx4 a[116:119], v8, s[34:35] offset:1024
 global_load_dwordx4 a[120:123], v8, s[34:35] offset:2048
 global_load_dwordx4 a[124:127], v8, s[34:35] offset:3072
 v_add_u32 v8, 4096, v8
 global_load_dwordx4 a[128:131], v8, s[34:35] offset:0
 global_load_dwordx4 a[132:135], v8, s[34:35] offset:1024
 global_load_dwordx4 a[136:139], v8, s[34:35] offset:2048
 global_load_dwordx4 a[140:143], v8, s[34:35] offset:3072
 v_add_u32 v8, 4096, v8
 global_load_dwordx4 a[144:147], v8, s[34:35] offset:0
 global_load_dwordx4 a[148:151], v8, s[34:35] offset:1024
 global_load_dwordx4 a[152:155], v8, s[34:35] offset:2048
 global_load_dwordx4 a[156:159], v8, s[34:35] offset:3072
 v_add_u32 v8, 4096, v8
 global_load_dwordx4 a[160:163], v8, s[34:35] offset:0
 s_add_u32 s36, s24, 28672
 s_add_u32 s36, s4, s36
 s_addc_u32 s37, s5, 0
 s_add_u32 m0, s28, 28800
 s_nop 0
 global_load_lds_dwordx4 v6, s[36:37] offset:0
 global_load_lds_dwordx4 v6, s[36:37] offset:1024
 global_load_lds_dwordx4 v6, s[36:37] offset:2048
 global_load_lds_dwordx4 v6, s[36:37] offset:3072
 s_add_u32 m0, s28, 32896
 s_nop 0
 global_load_lds_dwordx4 v7, s[36:37] offset:0
 global_load_lds_dwordx4 v7, s[36:37] offset:1024
 global_load_lds_dwordx4 v7, s[36:37] offset:2048
 global_load_dwordx4 a[164:167], v8, s[34:35] offset:1024
 global_load_dwordx4 a[168:171], v8, s[34:35] offset:2048
 global_load_dwordx4 a[172:175], v8, s[34:35] offset:3072
 v_add_u32 v8, 4096, v8
 global_load_dwordx4 a[176:179], v8, s[34:35] offset:0
 global_load_dwordx4 a[180:183], v8, s[34:35] offset:1024
 global_load_dwordx4 a[184:187], v8, s[34:35] offset:2048
 global_load_dwordx4 a[188:191], v8, s[34:35] offset:3072
 v_add_u32 v8, 4096, v8
 global_load_dwordx4 a[192:195], v8, s[34:35] offset:0
 global_load_dwordx4 a[196:199], v8, s[34:35] offset:1024
 global_load_dwordx4 a[200:203], v8, s[34:35] offset:2048
 global_load_dwordx4 a[204:207], v8, s[34:35] offset:3072
 v_add_u32 v8, 4096, v8
 global_load_dwordx4 a[208:211], v8, s[34:35] offset:0
 global_load_dwordx4 a[212:215], v8, s[34:35] offset:1024
 global_load_dwordx4 a[216:219], v8, s[34:35] offset:2048
 global_load_dwordx4 a[220:223], v8, s[34:35] offset:3072
 v_and_b32 v12, 1, v3
 v_bfe_u32 v13, v3, 3, 1
 v_lshl_add_u32 v12, v13, 1, v12
 v_bfe_u32 v13, v3, 1, 1
 v_bfe_u32 v14, v3, 2, 1
 v_bfe_u32 v15, v3, 4, 1
 v_lshl_add_u32 v9, v13, 2, v12
 v_lshl_add_u32 v9, v15, 3, v9
 v_lshlrev_b32 v9, 4, v9
 v_mul_u32_u24 v16, 14464, v14
 v_lshlrev_b32 v17, 8, v4
 v_add3_u32 v9, v9, v16, v17
 v_lshl_add_u32 v10, v14, 2, v12
 v_lshl_add_u32 v10, v13, 3, v10
 v_lshlrev_b32 v10, 4, v10
 v_mul_u32_u24 v16, 14464, v15
 v_add3_u32 v10, v10, v16, v17
 v_mov_b32 v11, v5
 s_waitcnt vmcnt(0)
 s_barrier
 s_add_u32 s36, s24, 57344
 s_add_u32 s36, s4, s36
 s_addc_u32 s37, s5, 0
 s_add_u32 m0, s28, 57600
 s_nop 0
 global_load_lds_dwordx4 v6, s[36:37] offset:0
 global_load_lds_dwordx4 v6, s[36:37] offset:1024
 global_load_lds_dwordx4 v6, s[36:37] offset:2048
 global_load_lds_dwordx4 v6, s[36:37] offset:3072
 s_add_u32 m0, s28, 61696
 s_nop 0
 global_load_lds_dwordx4 v7, s[36:37] offset:0
 global_load_lds_dwordx4 v7, s[36:37] offset:1024
 global_load_lds_dwordx4 v7, s[36:37] offset:2048
 v_add_u32 v12, 0, v9
 ds_read_b128 v[32:35], v12 offset:0
 ds_read_b128 v[36:39], v12 offset:512
 ds_read_b128 v[40:43], v12 offset:1024
 ds_read_b128 v[44:47], v12 offset:1536
 ds_read_b128 v[48:51], v12 offset:2048
 ds_read_b128 v[52:55], v12 offset:2560
 s_waitcnt lgkmcnt(5)
 v_mfma_f32_32x32x16_bf16 v[64:79], v[32:35], a[0:3], 0
 v_mfma_f32_32x32x16_bf16 v[80:95], v[32:35], a[112:115], 0
 ds_read_b128 v[56:59], v12 offset:3072
 s_waitcnt lgkmcnt(5)
 v_mfma_f32_32x32x16_bf16 v[64:79], v[36:39], a[4:7], v[64:79]
 v_mfma_f32_32x32x16_bf16 v[80:95], v[36:39], a[116:119], v[80:95]
 ds_read_b128 v[60:63], v12 offset:3584
 s_waitcnt lgkmcnt(5)
 v_mfma_f32_32x32x16_bf16 v[64:79], v[40:43], a[8:11], v[64:79]
 v_mfma_f32_32x32x16_bf16 v[80:95], v[40:43], a[120:123], v[80:95]
 ds_read_b128 v[32:35], v12 offset:4096
 s_waitcnt lgkmcnt(5)
 v_mfma_f32_32x32x16_bf16 v[64:79], v[44:47], a[12:15], v[64:79]
 v_mfma_f32_32x32x16_bf16 v[80:95], v[44:47], a[124:127], v[80:95]
 ds_read_b128 v[36:39], v12 offset:4608
 s_waitcnt lgkmcnt(5)
 v_mfma_f32_32x32x16_bf16 v[64:79], v[48:51], a[16:19], v[64:79]
 v_mfma_f32_32x32x16_bf16 v[80:95], v[48:51], a[128:131], v[80:95]
 ds_read_b128 v[40:43], v12 offset:5120
 s_waitcnt lgkmcnt(5)
 v_mfma_f32_32x32x16_bf16 v[64:79], v[52:55], a[20:23], v[64:79]
 v_mfma_f32_32x32x16_bf16 v[80:95], v[52:55], a[132:135], v[80:95]
 ds_read_b128 v[44:47], v12 offset:5632
 s_waitcnt lgkmcnt(5)
 v_mfma_f32_32x32x16_bf16 v[64:79], v[56:59], a[24:27], v[64:79]
 v_mfma_f32_32x32x16_bf16 v[80:95], v[56:59], a[136:139], v[80:95]
 ds_read_b128 v[48:51], v12 offset:6144
 s_waitcnt lgkmcnt(5)
 v_mfma_f32_32x32x16_bf16 v[64:79], v[60:63], a[28:31], v[64:79]
 v_mfma_f32_32x32x16_bf16 v[80:95], v[60:63], a[140:143], v[80:95]
 ds_read_b128 v[52:55], v12 offset:6656
 s_waitcnt lgkmcnt(5)
 v_mfma_f32_32x32x16_bf16 v[64:79], v[32:35], a[32:35], v[64:79]
 v_mfma_f32_32x32x16_bf16 v[80:95], v[32:35], a[144:147], v[80:95]
 ds_read_b128 v[56:59], v12 offset:7168
 s_waitcnt lgkmcnt(5)
 v_mfma_f32_32x32x16_bf16 v[64:79], v[36:39], a[36:39], v[64:79]
 v_mfma_f32_32x32x16_bf16 v[80:95], v[36:39], a[148:151], v[80:95]
 ds_read_b128 v[60:63], v12 offset:7680
 s_waitcnt lgkmcnt(5)
 v_mfma_f32_32x32x16_bf16 v[64:79], v[40:43], a[40:43], v[64:79]
 v_mfma_f32_32x32x16_bf16 v[80:95], v[40:43], a[152:155], v[80:95]
 ds_read_b128 v[32:35], v12 offset:8192
 s_waitcnt lgkmcnt(5)
 v_mfma_f32_32x32x16_bf16 v[64:79], v[44:47], a[44:47], v[64:79]
 v_mfma_f32_32x32x16_bf16 v[80:95], v[44:47], a[156:159], v[80:95]
 ds_read_b128 v[36:39], v12 offset:8704
 s_waitcnt lgkmcnt(5)
 v_mfma_f32_32x32x16_bf16 v[64:79], v[48:51], a[48:51], v[64:79]
 v_mfma_f32_32x32x16_bf16 v[80:95], v[48:51], a[160:163], v[80:95]
 ds_read_b128 v[40:43], v12 offset:9216
 s_waitcnt lgkmcnt(5)
 v_mfma_f32_32x32x16_bf16 v[64:79], v[52:55], a[52:55], v[64:79]
 v_mfma_f32_32x32x16_bf16 v[80:95], v[52:55], a[164:167], v[80:95]
 ds_read_b128 v[44:47], v12 offset:9728
 s_waitcnt lgkmcnt(5)
 v_mfma_f32_32x32x16_bf16 v[64:79], v[56:59], a[56:59], v[64:79]
 v_mfma_f32_32x32x16_bf16 v[80:95], v[56:59], a[168:171], v[80:95]
 ds_read_b128 v[48:51], v12 offset:10240
 s_waitcnt lgkmcnt(5)
 v_mfma_f32_32x32x16_bf16 v[64:79], v[60:63], a[60:63], v[64:79]
 v_mfma_f32_32x32x16_bf16 v[80:95], v[60:63], a[172:175], v[80:95]
 ds_read_b128 v[52:55], v12 offset:10752
 s_waitcnt lgkmcnt(5)
 v_mfma_f32_32x32x16_bf16 v[64:79], v[32:35], a[64:67], v[64:79]
 v_mfma_f32_32x32x16_bf16 v[80:95], v[32:35], a[176:179], v[80:95]
 ds_read_b128 v[56:59], v12 offset:11264
 s_waitcnt lgkmcnt(5)
 v_mfma_f32_32x32x16_bf16 v[64:79], v[36:39], a[68:71], v[64:79]
 v_mfma_f32_32x32x16_bf16 v[80:95], v[36:39], a[180:183], v[80:95]
 ds_read_b128 v[60:63], v12 offset:11776
 s_waitcnt lgkmcnt(5)
 v_mfma_f32_32x32x16_bf16 v[64:79], v[40:43], a[72:75], v[64:79]
 v_mfma_f32_32x32x16_bf16 v[80:95], v[40:43], a[184:187], v[80:95]
 ds_read_b128 v[32:35], v12 offset:12288
 s_waitcnt lgkmcnt(5)
 v_mfma_f32_32x32x16_bf16 v[64:79], v[44:47], a[76:79], v[64:79]
 v_mfma_f32_32x32x16_bf16 v[80:95], v[44:47], a[188:191], v[80:95]
 ds_read_b128 v[36:39], v12 offset:12800
 s_waitcnt lgkmcnt(5)
 v_mfma_f32_32x32x16_bf16 v[64:79], v[48:51], a[80:83], v[64:79]
 v_mfma_f32_32x32x16_bf16 v[80:95], v[48:51], a[192:195], v[80:95]
 ds_read_b128 v[40:43], v12 offset:13312
 s_waitcnt lgkmcnt(5)
 v_mfma_f32_32x32x16_bf16 v[64:79], v[52:55], a[84:87], v[64:79]
 v_mfma_f32_32x32x16_bf16 v[80:95], v[52:55], a[196:199], v[80:95]
 ds_read_b128 v[44:47], v12 offset:13824
 s_waitcnt lgkmcnt(5)
 v_mfma_f32_32x32x16_bf16 v[64:79], v[56:59], a[88:91], v[64:79]
 v_mfma_f32_32x32x16_bf16 v[80:95], v[56:59], a[200:203], v[80:95]
 s_waitcnt lgkmcnt(4)
 v_mfma_f32_32x32x16_bf16 v[64:79], v[60:63], a[92:95], v[64:79]
 v_mfma_f32_32x32x16_bf16 v[80:95], v[60:63], a[204:207], v[80:95]
 s_waitcnt lgkmcnt(3)
 v_mfma_f32_32x32x16_bf16 v[64:79], v[32:35], a[96:99], v[64:79]
 v_mfma_f32_32x32x16_bf16 v[80:95], v[32:35], a[208:211], v[80:95]
 s_waitcnt lgkmcnt(2)
 v_mfma_f32_32x32x16_bf16 v[64:79], v[36:39], a[100:103], v[64:79]
 v_mfma_f32_32x32x16_bf16 v[80:95], v[36:39], a[212:215], v[80:95]
 s_waitcnt lgkmcnt(1)
 v_mfma_f32_32x32x16_bf16 v[64:79], v[40:43], a[104:107], v[64:79]
 v_mfma_f32_32x32x16_bf16 v[80:95], v[40:43], a[216:219], v[80:95]
 s_waitcnt lgkmcnt(0)
 v_mfma_f32_32x32x16_bf16 v[64:79], v[44:47], a[108:111], v[64:79]
 v_mfma_f32_32x32x16_bf16 v[80:95], v[44:47], a[220:223], v[80:95]
 s_nop 7
 v_cvt_pk_bf16_f32 v128, v64, v65
 v_cvt_pk_bf16_f32 v129, v66, v67
 v_cvt_pk_bf16_f32 v130, v68, v69
 v_cvt_pk_bf16_f32 v131, v70, v71
 v_add_u32 v13, 0, v11
 global_store_dwordx4 v13, v[128:131], s[30:31] sc1
 v_cvt_pk_bf16_f32 v132, v72, v73
 v_cvt_pk_bf16_f32 v133, v74, v75
 v_cvt_pk_bf16_f32 v134, v76, v77
 v_cvt_pk_bf16_f32 v135, v78, v79
 v_add_u32 v13, 1024, v11
 global_store_dwordx4 v13, v[132:135], s[30:31] sc1
 s_nop 3
 v_cvt_pk_bf16_f32 v136, v80, v81
 v_cvt_pk_bf16_f32 v137, v82, v83
 v_cvt_pk_bf16_f32 v138, v84, v85
 v_cvt_pk_bf16_f32 v139, v86, v87
 v_add_u32 v13, 0, v11
 global_store_dwordx4 v13, v[136:139], s[32:33] sc1
 v_cvt_pk_bf16_f32 v140, v88, v89
 v_cvt_pk_bf16_f32 v141, v90, v91
 v_cvt_pk_bf16_f32 v142, v92, v93
 v_cvt_pk_bf16_f32 v143, v94, v95
 v_add_u32 v13, 1024, v11
 global_store_dwordx4 v13, v[140:143], s[32:33] sc1
 s_waitcnt vmcnt(11)
 s_barrier
 s_add_u32 s36, s24, 100352
 s_add_u32 s36, s4, s36
 s_addc_u32 s37, s5, 0
 s_add_u32 m0, s28, 0
 s_nop 0
 global_load_lds_dwordx4 v6, s[36:37] offset:0
 global_load_lds_dwordx4 v6, s[36:37] offset:1024
 global_load_lds_dwordx4 v6, s[36:37] offset:2048
 global_load_lds_dwordx4 v6, s[36:37] offset:3072
 s_add_u32 m0, s28, 4096
 s_nop 0
 global_load_lds_dwordx4 v7, s[36:37] offset:0
 global_load_lds_dwordx4 v7, s[36:37] offset:1024
 global_load_lds_dwordx4 v7, s[36:37] offset:2048
 v_add_u32 v12, 28800, v9
 ds_read_b128 v[32:35], v12 offset:0
 ds_read_b128 v[36:39], v12 offset:512
 ds_read_b128 v[40:43], v12 offset:1024
 ds_read_b128 v[44:47], v12 offset:1536
 ds_read_b128 v[48:51], v12 offset:2048
 ds_read_b128 v[52:55], v12 offset:2560
 s_waitcnt lgkmcnt(5)
 v_mfma_f32_32x32x16_bf16 v[64:79], v[32:35], a[0:3], 0
 v_mfma_f32_32x32x16_bf16 v[80:95], v[32:35], a[112:115], 0
 ds_read_b128 v[56:59], v12 offset:3072
 s_waitcnt lgkmcnt(5)
 v_mfma_f32_32x32x16_bf16 v[64:79], v[36:39], a[4:7], v[64:79]
 v_mfma_f32_32x32x16_bf16 v[80:95], v[36:39], a[116:119], v[80:95]
 ds_read_b128 v[60:63], v12 offset:3584
 s_waitcnt lgkmcnt(5)
 v_mfma_f32_32x32x16_bf16 v[64:79], v[40:43], a[8:11], v[64:79]
 v_mfma_f32_32x32x16_bf16 v[80:95], v[40:43], a[120:123], v[80:95]
 ds_read_b128 v[32:35], v12 offset:4096
 s_waitcnt lgkmcnt(5)
 v_mfma_f32_32x32x16_bf16 v[64:79], v[44:47], a[12:15], v[64:79]
 v_mfma_f32_32x32x16_bf16 v[80:95], v[44:47], a[124:127], v[80:95]
 ds_read_b128 v[36:39], v12 offset:4608
 s_waitcnt lgkmcnt(5)
 v_mfma_f32_32x32x16_bf16 v[64:79], v[48:51], a[16:19], v[64:79]
 v_mfma_f32_32x32x16_bf16 v[80:95], v[48:51], a[128:131], v[80:95]
 ds_read_b128 v[40:43], v12 offset:5120
 s_waitcnt lgkmcnt(5)
 v_mfma_f32_32x32x16_bf16 v[64:79], v[52:55], a[20:23], v[64:79]
 v_mfma_f32_32x32x16_bf16 v[80:95], v[52:55], a[132:135], v[80:95]
 ds_read_b128 v[44:47], v12 offset:5632
 s_waitcnt lgkmcnt(5)
 v_mfma_f32_32x32x16_bf16 v[64:79], v[56:59], a[24:27], v[64:79]
 v_mfma_f32_32x32x16_bf16 v[80:95], v[56:59], a[136:139], v[80:95]
 ds_read_b128 v[48:51], v12 offset:6144
 s_waitcnt lgkmcnt(5)
 v_mfma_f32_32x32x16_bf16 v[64:79], v[60:63], a[28:31], v[64:79]
 v_mfma_f32_32x32x16_bf16 v[80:95], v[60:63], a[140:143], v[80:95]
 ds_read_b128 v[52:55], v12 offset:6656
 s_waitcnt lgkmcnt(5)
 v_mfma_f32_32x32x16_bf16 v[64:79], v[32:35], a[32:35], v[64:79]
 v_mfma_f32_32x32x16_bf16 v[80:95], v[32:35], a[144:147], v[80:95]
 ds_read_b128 v[56:59], v12 offset:7168
 s_waitcnt lgkmcnt(5)
 v_mfma_f32_32x32x16_bf16 v[64:79], v[36:39], a[36:39], v[64:79]
 v_mfma_f32_32x32x16_bf16 v[80:95], v[36:39], a[148:151], v[80:95]
 ds_read_b128 v[60:63], v12 offset:7680
 s_waitcnt lgkmcnt(5)
 v_mfma_f32_32x32x16_bf16 v[64:79], v[40:43], a[40:43], v[64:79]
 v_mfma_f32_32x32x16_bf16 v[80:95], v[40:43], a[152:155], v[80:95]
 ds_read_b128 v[32:35], v12 offset:8192
 s_waitcnt lgkmcnt(5)
 v_mfma_f32_32x32x16_bf16 v[64:79], v[44:47], a[44:47], v[64:79]
 v_mfma_f32_32x32x16_bf16 v[80:95], v[44:47], a[156:159], v[80:95]
 ds_read_b128 v[36:39], v12 offset:8704
 s_waitcnt lgkmcnt(5)
 v_mfma_f32_32x32x16_bf16 v[64:79], v[48:51], a[48:51], v[64:79]
 v_mfma_f32_32x32x16_bf16 v[80:95], v[48:51], a[160:163], v[80:95]
 ds_read_b128 v[40:43], v12 offset:9216
 s_waitcnt lgkmcnt(5)
 v_mfma_f32_32x32x16_bf16 v[64:79], v[52:55], a[52:55], v[64:79]
 v_mfma_f32_32x32x16_bf16 v[80:95], v[52:55], a[164:167], v[80:95]
 ds_read_b128 v[44:47], v12 offset:9728
 s_waitcnt lgkmcnt(5)
 v_mfma_f32_32x32x16_bf16 v[64:79], v[56:59], a[56:59], v[64:79]
 v_mfma_f32_32x32x16_bf16 v[80:95], v[56:59], a[168:171], v[80:95]
 ds_read_b128 v[48:51], v12 offset:10240
 s_waitcnt lgkmcnt(5)
 v_mfma_f32_32x32x16_bf16 v[64:79], v[60:63], a[60:63], v[64:79]
 v_mfma_f32_32x32x16_bf16 v[80:95], v[60:63], a[172:175], v[80:95]
 ds_read_b128 v[52:55], v12 offset:10752
 s_waitcnt lgkmcnt(5)
 v_mfma_f32_32x32x16_bf16 v[64:79], v[32:35], a[64:67], v[64:79]
 v_mfma_f32_32x32x16_bf16 v[80:95], v[32:35], a[176:179], v[80:95]
 ds_read_b128 v[56:59], v12 offset:11264
 s_waitcnt lgkmcnt(5)
 v_mfma_f32_32x32x16_bf16 v[64:79], v[36:39], a[68:71], v[64:79]
 v_mfma_f32_32x32x16_bf16 v[80:95], v[36:39], a[180:183], v[80:95]
 ds_read_b128 v[60:63], v12 offset:11776
 s_waitcnt lgkmcnt(5)
 v_mfma_f32_32x32x16_bf16 v[64:79], v[40:43], a[72:75], v[64:79]
 v_mfma_f32_32x32x16_bf16 v[80:95], v[40:43], a[184:187], v[80:95]
 ds_read_b128 v[32:35], v12 offset:12288
 s_waitcnt lgkmcnt(5)
 v_mfma_f32_32x32x16_bf16 v[64:79], v[44:47], a[76:79], v[64:79]
 v_mfma_f32_32x32x16_bf16 v[80:95], v[44:47], a[188:191], v[80:95]
 ds_read_b128 v[36:39], v12 offset:12800
 s_waitcnt lgkmcnt(5)
 v_mfma_f32_32x32x16_bf16 v[64:79], v[48:51], a[80:83], v[64:79]
 v_mfma_f32_32x32x16_bf16 v[80:95], v[48:51], a[192:195], v[80:95]
 ds_read_b128 v[40:43], v12 offset:13312
 s_waitcnt lgkmcnt(5)
 v_mfma_f32_32x32x16_bf16 v[64:79], v[52:55], a[84:87], v[64:79]
 v_mfma_f32_32x32x16_bf16 v[80:95], v[52:55], a[196:199], v[80:95]
 ds_read_b128 v[44:47], v12 offset:13824
 s_waitcnt lgkmcnt(5)
 v_mfma_f32_32x32x16_bf16 v[64:79], v[56:59], a[88:91], v[64:79]
 v_mfma_f32_32x32x16_bf16 v[80:95], v[56:59], a[200:203], v[80:95]
 s_waitcnt lgkmcnt(4)
 v_mfma_f32_32x32x16_bf16 v[64:79], v[60:63], a[92:95], v[64:79]
 v_mfma_f32_32x32x16_bf16 v[80:95], v[60:63], a[204:207], v[80:95]
 s_waitcnt lgkmcnt(3)
 v_mfma_f32_32x32x16_bf16 v[64:79], v[32:35], a[96:99], v[64:79]
 v_mfma_f32_32x32x16_bf16 v[80:95], v[32:35], a[208:211], v[80:95]
 s_waitcnt lgkmcnt(2)
 v_mfma_f32_32x32x16_bf16 v[64:79], v[36:39], a[100:103], v[64:79]
 v_mfma_f32_32x32x16_bf16 v[80:95], v[36:39], a[212:215], v[80:95]
 s_waitcnt lgkmcnt(1)
 v_mfma_f32_32x32x16_bf16 v[64:79], v[40:43], a[104:107], v[64:79]
 v_mfma_f32_32x32x16_bf16 v[80:95], v[40:43], a[216:219], v[80:95]
 s_waitcnt lgkmcnt(0)
 v_mfma_f32_32x32x16_bf16 v[64:79], v[44:47], a[108:111], v[64:79]
 v_mfma_f32_32x32x16_bf16 v[80:95], v[44:47], a[220:223], v[80:95]
 s_nop 7
 v_cvt_pk_bf16_f32 v128, v64, v65
 v_cvt_pk_bf16_f32 v129, v66, v67
 v_cvt_pk_bf16_f32 v130, v68, v69
 v_cvt_pk_bf16_f32 v131, v70, v71
 v_add_u32 v13, 2048, v11
 global_store_dwordx4 v13, v[128:131], s[30:31] sc1
 v_cvt_pk_bf16_f32 v132, v72, v73
 v_cvt_pk_bf16_f32 v133, v74, v75
 v_cvt_pk_bf16_f32 v134, v76, v77
 v_cvt_pk_bf16_f32 v135, v78, v79
 v_add_u32 v13, 3072, v11
 global_store_dwordx4 v13, v[132:135], s[30:31] sc1
 s_nop 3
 v_cvt_pk_bf16_f32 v136, v80, v81
 v_cvt_pk_bf16_f32 v137, v82, v83
 v_cvt_pk_bf16_f32 v138, v84, v85
 v_cvt_pk_bf16_f32 v139, v86, v87
 v_add_u32 v13, 2048, v11
 global_store_dwordx4 v13, v[136:139], s[32:33] sc1
 v_cvt_pk_bf16_f32 v140, v88, v89
 v_cvt_pk_bf16_f32 v141, v90, v91
 v_cvt_pk_bf16_f32 v142, v92, v93
 v_cvt_pk_bf16_f32 v143, v94, v95
 v_add_u32 v13, 3072, v11
 global_store_dwordx4 v13, v[140:143], s[32:33] sc1
 s_waitcnt vmcnt(15)
 s_barrier
 s_add_u32 s36, s24, 129024
 s_add_u32 s36, s4, s36
 s_addc_u32 s37, s5, 0
 s_add_u32 m0, s28, 28800
 s_nop 0
 global_load_lds_dwordx4 v6, s[36:37] offset:0
 global_load_lds_dwordx4 v6, s[36:37] offset:1024
 global_load_lds_dwordx4 v6, s[36:37] offset:2048
 global_load_lds_dwordx4 v6, s[36:37] offset:3072
 s_add_u32 m0, s28, 32896
 s_nop 0
 global_load_lds_dwordx4 v7, s[36:37] offset:0
 global_load_lds_dwordx4 v7, s[36:37] offset:1024
 global_load_lds_dwordx4 v7, s[36:37] offset:2048
 v_add_u32 v12, 57600, v9
 ds_read_b128 v[32:35], v12 offset:0
 ds_read_b128 v[36:39], v12 offset:512
 ds_read_b128 v[40:43], v12 offset:1024
 ds_read_b128 v[44:47], v12 offset:1536
 ds_read_b128 v[48:51], v12 offset:2048
 ds_read_b128 v[52:55], v12 offset:2560
 s_waitcnt lgkmcnt(5)
 v_mfma_f32_32x32x16_bf16 v[64:79], v[32:35], a[0:3], 0
 v_mfma_f32_32x32x16_bf16 v[80:95], v[32:35], a[112:115], 0
 ds_read_b128 v[56:59], v12 offset:3072
 s_waitcnt lgkmcnt(5)
 v_mfma_f32_32x32x16_bf16 v[64:79], v[36:39], a[4:7], v[64:79]
 v_mfma_f32_32x32x16_bf16 v[80:95], v[36:39], a[116:119], v[80:95]
 ds_read_b128 v[60:63], v12 offset:3584
 s_waitcnt lgkmcnt(5)
 v_mfma_f32_32x32x16_bf16 v[64:79], v[40:43], a[8:11], v[64:79]
 v_mfma_f32_32x32x16_bf16 v[80:95], v[40:43], a[120:123], v[80:95]
 ds_read_b128 v[32:35], v12 offset:4096
 s_waitcnt lgkmcnt(5)
 v_mfma_f32_32x32x16_bf16 v[64:79], v[44:47], a[12:15], v[64:79]
 v_mfma_f32_32x32x16_bf16 v[80:95], v[44:47], a[124:127], v[80:95]
 ds_read_b128 v[36:39], v12 offset:4608
 s_waitcnt lgkmcnt(5)
 v_mfma_f32_32x32x16_bf16 v[64:79], v[48:51], a[16:19], v[64:79]
 v_mfma_f32_32x32x16_bf16 v[80:95], v[48:51], a[128:131], v[80:95]
 ds_read_b128 v[40:43], v12 offset:5120
 s_waitcnt lgkmcnt(5)
 v_mfma_f32_32x32x16_bf16 v[64:79], v[52:55], a[20:23], v[64:79]
 v_mfma_f32_32x32x16_bf16 v[80:95], v[52:55], a[132:135], v[80:95]
 ds_read_b128 v[44:47], v12 offset:5632
 s_waitcnt lgkmcnt(5)
 v_mfma_f32_32x32x16_bf16 v[64:79], v[56:59], a[24:27], v[64:79]
 v_mfma_f32_32x32x16_bf16 v[80:95], v[56:59], a[136:139], v[80:95]
 ds_read_b128 v[48:51], v12 offset:6144
 s_waitcnt lgkmcnt(5)
 v_mfma_f32_32x32x16_bf16 v[64:79], v[60:63], a[28:31], v[64:79]
 v_mfma_f32_32x32x16_bf16 v[80:95], v[60:63], a[140:143], v[80:95]
 ds_read_b128 v[52:55], v12 offset:6656
 s_waitcnt lgkmcnt(5)
 v_mfma_f32_32x32x16_bf16 v[64:79], v[32:35], a[32:35], v[64:79]
 v_mfma_f32_32x32x16_bf16 v[80:95], v[32:35], a[144:147], v[80:95]
 ds_read_b128 v[56:59], v12 offset:7168
 s_waitcnt lgkmcnt(5)
 v_mfma_f32_32x32x16_bf16 v[64:79], v[36:39], a[36:39], v[64:79]
 v_mfma_f32_32x32x16_bf16 v[80:95], v[36:39], a[148:151], v[80:95]
 ds_read_b128 v[60:63], v12 offset:7680
 s_waitcnt lgkmcnt(5)
 v_mfma_f32_32x32x16_bf16 v[64:79], v[40:43], a[40:43], v[64:79]
 v_mfma_f32_32x32x16_bf16 v[80:95], v[40:43], a[152:155], v[80:95]
 ds_read_b128 v[32:35], v12 offset:8192
 s_waitcnt lgkmcnt(5)
 v_mfma_f32_32x32x16_bf16 v[64:79], v[44:47], a[44:47], v[64:79]
 v_mfma_f32_32x32x16_bf16 v[80:95], v[44:47], a[156:159], v[80:95]
 ds_read_b128 v[36:39], v12 offset:8704
 s_waitcnt lgkmcnt(5)
 v_mfma_f32_32x32x16_bf16 v[64:79], v[48:51], a[48:51], v[64:79]
 v_mfma_f32_32x32x16_bf16 v[80:95], v[48:51], a[160:163], v[80:95]
 ds_read_b128 v[40:43], v12 offset:9216
 s_waitcnt lgkmcnt(5)
 v_mfma_f32_32x32x16_bf16 v[64:79], v[52:55], a[52:55], v[64:79]
 v_mfma_f32_32x32x16_bf16 v[80:95], v[52:55], a[164:167], v[80:95]
 ds_read_b128 v[44:47], v12 offset:9728
 s_waitcnt lgkmcnt(5)
 v_mfma_f32_32x32x16_bf16 v[64:79], v[56:59], a[56:59], v[64:79]
 v_mfma_f32_32x32x16_bf16 v[80:95], v[56:59], a[168:171], v[80:95]
 ds_read_b128 v[48:51], v12 offset:10240
 s_waitcnt lgkmcnt(5)
 v_mfma_f32_32x32x16_bf16 v[64:79], v[60:63], a[60:63], v[64:79]
 v_mfma_f32_32x32x16_bf16 v[80:95], v[60:63], a[172:175], v[80:95]
 ds_read_b128 v[52:55], v12 offset:10752
 s_waitcnt lgkmcnt(5)
 v_mfma_f32_32x32x16_bf16 v[64:79], v[32:35], a[64:67], v[64:79]
 v_mfma_f32_32x32x16_bf16 v[80:95], v[32:35], a[176:179], v[80:95]
 ds_read_b128 v[56:59], v12 offset:11264
 s_waitcnt lgkmcnt(5)
 v_mfma_f32_32x32x16_bf16 v[64:79], v[36:39], a[68:71], v[64:79]
 v_mfma_f32_32x32x16_bf16 v[80:95], v[36:39], a[180:183], v[80:95]
 ds_read_b128 v[60:63], v12 offset:11776
 s_waitcnt lgkmcnt(5)
 v_mfma_f32_32x32x16_bf16 v[64:79], v[40:43], a[72:75], v[64:79]
 v_mfma_f32_32x32x16_bf16 v[80:95], v[40:43], a[184:187], v[80:95]
 ds_read_b128 v[32:35], v12 offset:12288
 s_waitcnt lgkmcnt(5)
 v_mfma_f32_32x32x16_bf16 v[64:79], v[44:47], a[76:79], v[64:79]
 v_mfma_f32_32x32x16_bf16 v[80:95], v[44:47], a[188:191], v[80:95]
 ds_read_b128 v[36:39], v12 offset:12800
 s_waitcnt lgkmcnt(5)
 v_mfma_f32_32x32x16_bf16 v[64:79], v[48:51], a[80:83], v[64:79]
 v_mfma_f32_32x32x16_bf16 v[80:95], v[48:51], a[192:195], v[80:95]
 ds_read_b128 v[40:43], v12 offset:13312
 s_waitcnt lgkmcnt(5)
 v_mfma_f32_32x32x16_bf16 v[64:79], v[52:55], a[84:87], v[64:79]
 v_mfma_f32_32x32x16_bf16 v[80:95], v[52:55], a[196:199], v[80:95]
 ds_read_b128 v[44:47], v12 offset:13824
 s_waitcnt lgkmcnt(5)
 v_mfma_f32_32x32x16_bf16 v[64:79], v[56:59], a[88:91], v[64:79]
 v_mfma_f32_32x32x16_bf16 v[80:95], v[56:59], a[200:203], v[80:95]
 s_waitcnt lgkmcnt(4)
 v_mfma_f32_32x32x16_bf16 v[64:79], v[60:63], a[92:95], v[64:79]
 v_mfma_f32_32x32x16_bf16 v[80:95], v[60:63], a[204:207], v[80:95]
 s_waitcnt lgkmcnt(3)
 v_mfma_f32_32x32x16_bf16 v[64:79], v[32:35], a[96:99], v[64:79]
 v_mfma_f32_32x32x16_bf16 v[80:95], v[32:35], a[208:211], v[80:95]
 s_waitcnt lgkmcnt(2)
 v_mfma_f32_32x32x16_bf16 v[64:79], v[36:39], a[100:103], v[64:79]
 v_mfma_f32_32x32x16_bf16 v[80:95], v[36:39], a[212:215], v[80:95]
 s_waitcnt lgkmcnt(1)
 v_mfma_f32_32x32x16_bf16 v[64:79], v[40:43], a[104:107], v[64:79]
 v_mfma_f32_32x32x16_bf16 v[80:95], v[40:43], a[216:219], v[80:95]
 s_waitcnt lgkmcnt(0)
 v_mfma_f32_32x32x16_bf16 v[64:79], v[44:47], a[108:111], v[64:79]
 v_mfma_f32_32x32x16_bf16 v[80:95], v[44:47], a[220:223], v[80:95]
 s_nop 7
 v_cvt_pk_bf16_f32 v128, v64, v65
 v_cvt_pk_bf16_f32 v129, v66, v67
 v_cvt_pk_bf16_f32 v130, v68, v69
 v_cvt_pk_bf16_f32 v131, v70, v71
 v_add_u32 v13, 4096, v11
 global_store_dwordx4 v13, v[128:131], s[30:31] sc1
 v_cvt_pk_bf16_f32 v132, v72, v73
 v_cvt_pk_bf16_f32 v133, v74, v75
 v_cvt_pk_bf16_f32 v134, v76, v77
 v_cvt_pk_bf16_f32 v135, v78, v79
 v_add_u32 v13, 5120, v11
 global_store_dwordx4 v13, v[132:135], s[30:31] sc1
 s_nop 3
 v_cvt_pk_bf16_f32 v136, v80, v81
 v_cvt_pk_bf16_f32 v137, v82, v83
 v_cvt_pk_bf16_f32 v138, v84, v85
 v_cvt_pk_bf16_f32 v139, v86, v87
 v_add_u32 v13, 4096, v11
 global_store_dwordx4 v13, v[136:139], s[32:33] sc1
 v_cvt_pk_bf16_f32 v140, v88, v89
 v_cvt_pk_bf16_f32 v141, v90, v91
 v_cvt_pk_bf16_f32 v142, v92, v93
 v_cvt_pk_bf16_f32 v143, v94, v95
 v_add_u32 v13, 5120, v11
 global_store_dwordx4 v13, v[140:143], s[32:33] sc1
 s_waitcnt vmcnt(15)
 s_barrier
 s_add_u32 s36, s24, 157696
 s_add_u32 s36, s4, s36
 s_addc_u32 s37, s5, 0
 s_add_u32 m0, s28, 57600
 s_nop 0
 global_load_lds_dwordx4 v6, s[36:37] offset:0
 global_load_lds_dwordx4 v6, s[36:37] offset:1024
 global_load_lds_dwordx4 v6, s[36:37] offset:2048
 global_load_lds_dwordx4 v6, s[36:37] offset:3072
 s_add_u32 m0, s28, 61696
 s_nop 0
 global_load_lds_dwordx4 v7, s[36:37] offset:0
 global_load_lds_dwordx4 v7, s[36:37] offset:1024
 global_load_lds_dwordx4 v7, s[36:37] offset:2048
 v_add_u32 v12, 0, v9
 ds_read_b128 v[32:35], v12 offset:0
 ds_read_b128 v[36:39], v12 offset:512
 ds_read_b128 v[40:43], v12 offset:1024
 ds_read_b128 v[44:47], v12 offset:1536
 ds_read_b128 v[48:51], v12 offset:2048
 ds_read_b128 v[52:55], v12 offset:2560
 s_waitcnt lgkmcnt(5)
 v_mfma_f32_32x32x16_bf16 v[64:79], v[32:35], a[0:3], 0
 v_mfma_f32_32x32x16_bf16 v[80:95], v[32:35], a[112:115], 0
 ds_read_b128 v[56:59], v12 offset:3072
 s_waitcnt lgkmcnt(5)
 v_mfma_f32_32x32x16_bf16 v[64:79], v[36:39], a[4:7], v[64:79]
 v_mfma_f32_32x32x16_bf16 v[80:95], v[36:39], a[116:119], v[80:95]
 ds_read_b128 v[60:63], v12 offset:3584
 s_waitcnt lgkmcnt(5)
 v_mfma_f32_32x32x16_bf16 v[64:79], v[40:43], a[8:11], v[64:79]
 v_mfma_f32_32x32x16_bf16 v[80:95], v[40:43], a[120:123], v[80:95]
 ds_read_b128 v[32:35], v12 offset:4096
 s_waitcnt lgkmcnt(5)
 v_mfma_f32_32x32x16_bf16 v[64:79], v[44:47], a[12:15], v[64:79]
 v_mfma_f32_32x32x16_bf16 v[80:95], v[44:47], a[124:127], v[80:95]
 ds_read_b128 v[36:39], v12 offset:4608
 s_waitcnt lgkmcnt(5)
 v_mfma_f32_32x32x16_bf16 v[64:79], v[48:51], a[16:19], v[64:79]
 v_mfma_f32_32x32x16_bf16 v[80:95], v[48:51], a[128:131], v[80:95]
 ds_read_b128 v[40:43], v12 offset:5120
 s_waitcnt lgkmcnt(5)
 v_mfma_f32_32x32x16_bf16 v[64:79], v[52:55], a[20:23], v[64:79]
 v_mfma_f32_32x32x16_bf16 v[80:95], v[52:55], a[132:135], v[80:95]
 ds_read_b128 v[44:47], v12 offset:5632
 s_waitcnt lgkmcnt(5)
 v_mfma_f32_32x32x16_bf16 v[64:79], v[56:59], a[24:27], v[64:79]
 v_mfma_f32_32x32x16_bf16 v[80:95], v[56:59], a[136:139], v[80:95]
 ds_read_b128 v[48:51], v12 offset:6144
 s_waitcnt lgkmcnt(5)
 v_mfma_f32_32x32x16_bf16 v[64:79], v[60:63], a[28:31], v[64:79]
 v_mfma_f32_32x32x16_bf16 v[80:95], v[60:63], a[140:143], v[80:95]
 ds_read_b128 v[52:55], v12 offset:6656
 s_waitcnt lgkmcnt(5)
 v_mfma_f32_32x32x16_bf16 v[64:79], v[32:35], a[32:35], v[64:79]
 v_mfma_f32_32x32x16_bf16 v[80:95], v[32:35], a[144:147], v[80:95]
 ds_read_b128 v[56:59], v12 offset:7168
 s_waitcnt lgkmcnt(5)
 v_mfma_f32_32x32x16_bf16 v[64:79], v[36:39], a[36:39], v[64:79]
 v_mfma_f32_32x32x16_bf16 v[80:95], v[36:39], a[148:151], v[80:95]
 ds_read_b128 v[60:63], v12 offset:7680
 s_waitcnt lgkmcnt(5)
 v_mfma_f32_32x32x16_bf16 v[64:79], v[40:43], a[40:43], v[64:79]
 v_mfma_f32_32x32x16_bf16 v[80:95], v[40:43], a[152:155], v[80:95]
 ds_read_b128 v[32:35], v12 offset:8192
 s_waitcnt lgkmcnt(5)
 v_mfma_f32_32x32x16_bf16 v[64:79], v[44:47], a[44:47], v[64:79]
 v_mfma_f32_32x32x16_bf16 v[80:95], v[44:47], a[156:159], v[80:95]
 ds_read_b128 v[36:39], v12 offset:8704
 s_waitcnt lgkmcnt(5)
 v_mfma_f32_32x32x16_bf16 v[64:79], v[48:51], a[48:51], v[64:79]
 v_mfma_f32_32x32x16_bf16 v[80:95], v[48:51], a[160:163], v[80:95]
 ds_read_b128 v[40:43], v12 offset:9216
 s_waitcnt lgkmcnt(5)
 v_mfma_f32_32x32x16_bf16 v[64:79], v[52:55], a[52:55], v[64:79]
 v_mfma_f32_32x32x16_bf16 v[80:95], v[52:55], a[164:167], v[80:95]
 ds_read_b128 v[44:47], v12 offset:9728
 s_waitcnt lgkmcnt(5)
 v_mfma_f32_32x32x16_bf16 v[64:79], v[56:59], a[56:59], v[64:79]
 v_mfma_f32_32x32x16_bf16 v[80:95], v[56:59], a[168:171], v[80:95]
 ds_read_b128 v[48:51], v12 offset:10240
 s_waitcnt lgkmcnt(5)
 v_mfma_f32_32x32x16_bf16 v[64:79], v[60:63], a[60:63], v[64:79]
 v_mfma_f32_32x32x16_bf16 v[80:95], v[60:63], a[172:175], v[80:95]
 ds_read_b128 v[52:55], v12 offset:10752
 s_waitcnt lgkmcnt(5)
 v_mfma_f32_32x32x16_bf16 v[64:79], v[32:35], a[64:67], v[64:79]
 v_mfma_f32_32x32x16_bf16 v[80:95], v[32:35], a[176:179], v[80:95]
 ds_read_b128 v[56:59], v12 offset:11264
 s_waitcnt lgkmcnt(5)
 v_mfma_f32_32x32x16_bf16 v[64:79], v[36:39], a[68:71], v[64:79]
 v_mfma_f32_32x32x16_bf16 v[80:95], v[36:39], a[180:183], v[80:95]
 ds_read_b128 v[60:63], v12 offset:11776
 s_waitcnt lgkmcnt(5)
 v_mfma_f32_32x32x16_bf16 v[64:79], v[40:43], a[72:75], v[64:79]
 v_mfma_f32_32x32x16_bf16 v[80:95], v[40:43], a[184:187], v[80:95]
 ds_read_b128 v[32:35], v12 offset:12288
 s_waitcnt lgkmcnt(5)
 v_mfma_f32_32x32x16_bf16 v[64:79], v[44:47], a[76:79], v[64:79]
 v_mfma_f32_32x32x16_bf16 v[80:95], v[44:47], a[188:191], v[80:95]
 ds_read_b128 v[36:39], v12 offset:12800
 s_waitcnt lgkmcnt(5)
 v_mfma_f32_32x32x16_bf16 v[64:79], v[48:51], a[80:83], v[64:79]
 v_mfma_f32_32x32x16_bf16 v[80:95], v[48:51], a[192:195], v[80:95]
 ds_read_b128 v[40:43], v12 offset:13312
 s_waitcnt lgkmcnt(5)
 v_mfma_f32_32x32x16_bf16 v[64:79], v[52:55], a[84:87], v[64:79]
 v_mfma_f32_32x32x16_bf16 v[80:95], v[52:55], a[196:199], v[80:95]
 ds_read_b128 v[44:47], v12 offset:13824
 s_waitcnt lgkmcnt(5)
 v_mfma_f32_32x32x16_bf16 v[64:79], v[56:59], a[88:91], v[64:79]
 v_mfma_f32_32x32x16_bf16 v[80:95], v[56:59], a[200:203], v[80:95]
 s_waitcnt lgkmcnt(4)
 v_mfma_f32_32x32x16_bf16 v[64:79], v[60:63], a[92:95], v[64:79]
 v_mfma_f32_32x32x16_bf16 v[80:95], v[60:63], a[204:207], v[80:95]
 s_waitcnt lgkmcnt(3)
 v_mfma_f32_32x32x16_bf16 v[64:79], v[32:35], a[96:99], v[64:79]
 v_mfma_f32_32x32x16_bf16 v[80:95], v[32:35], a[208:211], v[80:95]
 s_waitcnt lgkmcnt(2)
 v_mfma_f32_32x32x16_bf16 v[64:79], v[36:39], a[100:103], v[64:79]
 v_mfma_f32_32x32x16_bf16 v[80:95], v[36:39], a[212:215], v[80:95]
 s_waitcnt lgkmcnt(1)
 v_mfma_f32_32x32x16_bf16 v[64:79], v[40:43], a[104:107], v[64:79]
 v_mfma_f32_32x32x16_bf16 v[80:95], v[40:43], a[216:219], v[80:95]
 s_waitcnt lgkmcnt(0)
 v_mfma_f32_32x32x16_bf16 v[64:79], v[44:47], a[108:111], v[64:79]
 v_mfma_f32_32x32x16_bf16 v[80:95], v[44:47], a[220:223], v[80:95]
 s_nop 7
 v_cvt_pk_bf16_f32 v128, v64, v65
 v_cvt_pk_bf16_f32 v129, v66, v67
 v_cvt_pk_bf16_f32 v130, v68, v69
 v_cvt_pk_bf16_f32 v131, v70, v71
 v_add_u32 v13, 7168, v11
 global_store_dwordx4 v13, v[128:131], s[30:31] sc1
 v_cvt_pk_bf16_f32 v132, v72, v73
 v_cvt_pk_bf16_f32 v133, v74, v75
 v_cvt_pk_bf16_f32 v134, v76, v77
 v_cvt_pk_bf16_f32 v135, v78, v79
 v_add_u32 v13, 8192, v11
 global_store_dwordx4 v13, v[132:135], s[30:31] sc1
 s_nop 3
 v_cvt_pk_bf16_f32 v136, v80, v81
 v_cvt_pk_bf16_f32 v137, v82, v83
 v_cvt_pk_bf16_f32 v138, v84, v85
 v_cvt_pk_bf16_f32 v139, v86, v87
 v_add_u32 v13, 7168, v11
 global_store_dwordx4 v13, v[136:139], s[32:33] sc1
 v_cvt_pk_bf16_f32 v140, v88, v89
 v_cvt_pk_bf16_f32 v141, v90, v91
 v_cvt_pk_bf16_f32 v142, v92, v93
 v_cvt_pk_bf16_f32 v143, v94, v95
 v_add_u32 v13, 8192, v11
 global_store_dwordx4 v13, v[140:143], s[32:33] sc1
 s_waitcnt vmcnt(15)
 s_barrier
 s_add_u32 s36, s27, 0
 s_add_u32 s36, s4, s36
 s_addc_u32 s37, s5, 0
 s_add_u32 m0, s28, 0
 s_nop 0
 global_load_lds_dwordx4 v6, s[36:37] offset:0
 global_load_lds_dwordx4 v6, s[36:37] offset:1024
 global_load_lds_dwordx4 v6, s[36:37] offset:2048
 global_load_lds_dwordx4 v6, s[36:37] offset:3072
 s_add_u32 m0, s28, 4096
 s_nop 0
 global_load_lds_dwordx4 v7, s[36:37] offset:0
 global_load_lds_dwordx4 v7, s[36:37] offset:1024
 global_load_lds_dwordx4 v7, s[36:37] offset:2048
 v_add_u32 v12, 28800, v9
 ds_read_b128 v[32:35], v12 offset:0
 ds_read_b128 v[36:39], v12 offset:512
 ds_read_b128 v[40:43], v12 offset:1024
 ds_read_b128 v[44:47], v12 offset:1536
 ds_read_b128 v[48:51], v12 offset:2048
 ds_read_b128 v[52:55], v12 offset:2560
 s_waitcnt lgkmcnt(5)
 v_mfma_f32_32x32x16_bf16 v[64:79], v[32:35], a[0:3], 0
 v_mfma_f32_32x32x16_bf16 v[80:95], v[32:35], a[112:115], 0
 ds_read_b128 v[56:59], v12 offset:3072
 s_waitcnt lgkmcnt(5)
 v_mfma_f32_32x32x16_bf16 v[64:79], v[36:39], a[4:7], v[64:79]
 v_mfma_f32_32x32x16_bf16 v[80:95], v[36:39], a[116:119], v[80:95]
 ds_read_b128 v[60:63], v12 offset:3584
 s_waitcnt lgkmcnt(5)
 v_mfma_f32_32x32x16_bf16 v[64:79], v[40:43], a[8:11], v[64:79]
 v_mfma_f32_32x32x16_bf16 v[80:95], v[40:43], a[120:123], v[80:95]
 ds_read_b128 v[32:35], v12 offset:4096
 s_waitcnt lgkmcnt(5)
 v_mfma_f32_32x32x16_bf16 v[64:79], v[44:47], a[12:15], v[64:79]
 v_mfma_f32_32x32x16_bf16 v[80:95], v[44:47], a[124:127], v[80:95]
 ds_read_b128 v[36:39], v12 offset:4608
 s_waitcnt lgkmcnt(5)
 v_mfma_f32_32x32x16_bf16 v[64:79], v[48:51], a[16:19], v[64:79]
 v_mfma_f32_32x32x16_bf16 v[80:95], v[48:51], a[128:131], v[80:95]
 ds_read_b128 v[40:43], v12 offset:5120
 s_waitcnt lgkmcnt(5)
 v_mfma_f32_32x32x16_bf16 v[64:79], v[52:55], a[20:23], v[64:79]
 v_mfma_f32_32x32x16_bf16 v[80:95], v[52:55], a[132:135], v[80:95]
 ds_read_b128 v[44:47], v12 offset:5632
 s_waitcnt lgkmcnt(5)
 v_mfma_f32_32x32x16_bf16 v[64:79], v[56:59], a[24:27], v[64:79]
 v_mfma_f32_32x32x16_bf16 v[80:95], v[56:59], a[136:139], v[80:95]
 ds_read_b128 v[48:51], v12 offset:6144
 s_waitcnt lgkmcnt(5)
 v_mfma_f32_32x32x16_bf16 v[64:79], v[60:63], a[28:31], v[64:79]
 v_mfma_f32_32x32x16_bf16 v[80:95], v[60:63], a[140:143], v[80:95]
 ds_read_b128 v[52:55], v12 offset:6656
 s_waitcnt lgkmcnt(5)
 v_mfma_f32_32x32x16_bf16 v[64:79], v[32:35], a[32:35], v[64:79]
 v_mfma_f32_32x32x16_bf16 v[80:95], v[32:35], a[144:147], v[80:95]
 ds_read_b128 v[56:59], v12 offset:7168
 s_waitcnt lgkmcnt(5)
 v_mfma_f32_32x32x16_bf16 v[64:79], v[36:39], a[36:39], v[64:79]
 v_mfma_f32_32x32x16_bf16 v[80:95], v[36:39], a[148:151], v[80:95]
 ds_read_b128 v[60:63], v12 offset:7680
 s_waitcnt lgkmcnt(5)
 v_mfma_f32_32x32x16_bf16 v[64:79], v[40:43], a[40:43], v[64:79]
 v_mfma_f32_32x32x16_bf16 v[80:95], v[40:43], a[152:155], v[80:95]
 ds_read_b128 v[32:35], v12 offset:8192
 s_waitcnt lgkmcnt(5)
 v_mfma_f32_32x32x16_bf16 v[64:79], v[44:47], a[44:47], v[64:79]
 v_mfma_f32_32x32x16_bf16 v[80:95], v[44:47], a[156:159], v[80:95]
 ds_read_b128 v[36:39], v12 offset:8704
 s_waitcnt lgkmcnt(5)
 v_mfma_f32_32x32x16_bf16 v[64:79], v[48:51], a[48:51], v[64:79]
 v_mfma_f32_32x32x16_bf16 v[80:95], v[48:51], a[160:163], v[80:95]
 ds_read_b128 v[40:43], v12 offset:9216
 s_waitcnt lgkmcnt(5)
 v_mfma_f32_32x32x16_bf16 v[64:79], v[52:55], a[52:55], v[64:79]
 v_mfma_f32_32x32x16_bf16 v[80:95], v[52:55], a[164:167], v[80:95]
 ds_read_b128 v[44:47], v12 offset:9728
 s_waitcnt lgkmcnt(5)
 v_mfma_f32_32x32x16_bf16 v[64:79], v[56:59], a[56:59], v[64:79]
 v_mfma_f32_32x32x16_bf16 v[80:95], v[56:59], a[168:171], v[80:95]
 ds_read_b128 v[48:51], v12 offset:10240
 s_waitcnt lgkmcnt(5)
 v_mfma_f32_32x32x16_bf16 v[64:79], v[60:63], a[60:63], v[64:79]
 v_mfma_f32_32x32x16_bf16 v[80:95], v[60:63], a[172:175], v[80:95]
 ds_read_b128 v[52:55], v12 offset:10752
 s_waitcnt lgkmcnt(5)
 v_mfma_f32_32x32x16_bf16 v[64:79], v[32:35], a[64:67], v[64:79]
 v_mfma_f32_32x32x16_bf16 v[80:95], v[32:35], a[176:179], v[80:95]
 ds_read_b128 v[56:59], v12 offset:11264
 s_waitcnt lgkmcnt(5)
 v_mfma_f32_32x32x16_bf16 v[64:79], v[36:39], a[68:71], v[64:79]
 v_mfma_f32_32x32x16_bf16 v[80:95], v[36:39], a[180:183], v[80:95]
 ds_read_b128 v[60:63], v12 offset:11776
 s_waitcnt lgkmcnt(5)
 v_mfma_f32_32x32x16_bf16 v[64:79], v[40:43], a[72:75], v[64:79]
 v_mfma_f32_32x32x16_bf16 v[80:95], v[40:43], a[184:187], v[80:95]
 ds_read_b128 v[32:35], v12 offset:12288
 s_waitcnt lgkmcnt(5)
 v_mfma_f32_32x32x16_bf16 v[64:79], v[44:47], a[76:79], v[64:79]
 v_mfma_f32_32x32x16_bf16 v[80:95], v[44:47], a[188:191], v[80:95]
 ds_read_b128 v[36:39], v12 offset:12800
 s_waitcnt lgkmcnt(5)
 v_mfma_f32_32x32x16_bf16 v[64:79], v[48:51], a[80:83], v[64:79]
 v_mfma_f32_32x32x16_bf16 v[80:95], v[48:51], a[192:195], v[80:95]
 ds_read_b128 v[40:43], v12 offset:13312
 s_waitcnt lgkmcnt(5)
 v_mfma_f32_32x32x16_bf16 v[64:79], v[52:55], a[84:87], v[64:79]
 v_mfma_f32_32x32x16_bf16 v[80:95], v[52:55], a[196:199], v[80:95]
 ds_read_b128 v[44:47], v12 offset:13824
 s_waitcnt lgkmcnt(5)
 v_mfma_f32_32x32x16_bf16 v[64:79], v[56:59], a[88:91], v[64:79]
 v_mfma_f32_32x32x16_bf16 v[80:95], v[56:59], a[200:203], v[80:95]
 s_waitcnt lgkmcnt(4)
 v_mfma_f32_32x32x16_bf16 v[64:79], v[60:63], a[92:95], v[64:79]
 v_mfma_f32_32x32x16_bf16 v[80:95], v[60:63], a[204:207], v[80:95]
 s_waitcnt lgkmcnt(3)
 v_mfma_f32_32x32x16_bf16 v[64:79], v[32:35], a[96:99], v[64:79]
 v_mfma_f32_32x32x16_bf16 v[80:95], v[32:35], a[208:211], v[80:95]
 s_waitcnt lgkmcnt(2)
 v_mfma_f32_32x32x16_bf16 v[64:79], v[36:39], a[100:103], v[64:79]
 v_mfma_f32_32x32x16_bf16 v[80:95], v[36:39], a[212:215], v[80:95]
 s_waitcnt lgkmcnt(1)
 v_mfma_f32_32x32x16_bf16 v[64:79], v[40:43], a[104:107], v[64:79]
 v_mfma_f32_32x32x16_bf16 v[80:95], v[40:43], a[216:219], v[80:95]
 s_waitcnt lgkmcnt(0)
 v_mfma_f32_32x32x16_bf16 v[64:79], v[44:47], a[108:111], v[64:79]
 v_mfma_f32_32x32x16_bf16 v[80:95], v[44:47], a[220:223], v[80:95]
 s_nop 7
 v_cvt_pk_bf16_f32 v128, v64, v65
 v_cvt_pk_bf16_f32 v129, v66, v67
 v_cvt_pk_bf16_f32 v130, v68, v69
 v_cvt_pk_bf16_f32 v131, v70, v71
 v_add_u32 v13, 9216, v11
 global_store_dwordx4 v13, v[128:131], s[30:31] sc1
 v_cvt_pk_bf16_f32 v132, v72, v73
 v_cvt_pk_bf16_f32 v133, v74, v75
 v_cvt_pk_bf16_f32 v134, v76, v77
 v_cvt_pk_bf16_f32 v135, v78, v79
 v_add_u32 v13, 10240, v11
 global_store_dwordx4 v13, v[132:135], s[30:31] sc1
 s_nop 3
 v_cvt_pk_bf16_f32 v136, v80, v81
 v_cvt_pk_bf16_f32 v137, v82, v83
 v_cvt_pk_bf16_f32 v138, v84, v85
 v_cvt_pk_bf16_f32 v139, v86, v87
 v_add_u32 v13, 9216, v11
 global_store_dwordx4 v13, v[136:139], s[32:33] sc1
 v_cvt_pk_bf16_f32 v140, v88, v89
 v_cvt_pk_bf16_f32 v141, v90, v91
 v_cvt_pk_bf16_f32 v142, v92, v93
 v_cvt_pk_bf16_f32 v143, v94, v95
 v_add_u32 v13, 10240, v11
 global_store_dwordx4 v13, v[140:143], s[32:33] sc1
 s_waitcnt vmcnt(15)
 s_barrier
 v_add_u32 v12, 57600, v9
 ds_read_b128 v[32:35], v12 offset:0
 ds_read_b128 v[36:39], v12 offset:512
 ds_read_b128 v[40:43], v12 offset:1024
 ds_read_b128 v[44:47], v12 offset:1536
 ds_read_b128 v[48:51], v12 offset:2048
 ds_read_b128 v[52:55], v12 offset:2560
 s_waitcnt lgkmcnt(5)
 v_mfma_f32_32x32x16_bf16 v[64:79], v[32:35], a[0:3], 0
 v_mfma_f32_32x32x16_bf16 v[80:95], v[32:35], a[112:115], 0
 ds_read_b128 v[56:59], v12 offset:3072
 s_waitcnt lgkmcnt(5)
 v_mfma_f32_32x32x16_bf16 v[64:79], v[36:39], a[4:7], v[64:79]
 v_mfma_f32_32x32x16_bf16 v[80:95], v[36:39], a[116:119], v[80:95]
 ds_read_b128 v[60:63], v12 offset:3584
 s_waitcnt lgkmcnt(5)
 v_mfma_f32_32x32x16_bf16 v[64:79], v[40:43], a[8:11], v[64:79]
 v_mfma_f32_32x32x16_bf16 v[80:95], v[40:43], a[120:123], v[80:95]
 ds_read_b128 v[32:35], v12 offset:4096
 s_waitcnt lgkmcnt(5)
 v_mfma_f32_32x32x16_bf16 v[64:79], v[44:47], a[12:15], v[64:79]
 v_mfma_f32_32x32x16_bf16 v[80:95], v[44:47], a[124:127], v[80:95]
 ds_read_b128 v[36:39], v12 offset:4608
 s_waitcnt lgkmcnt(5)
 v_mfma_f32_32x32x16_bf16 v[64:79], v[48:51], a[16:19], v[64:79]
 v_mfma_f32_32x32x16_bf16 v[80:95], v[48:51], a[128:131], v[80:95]
 ds_read_b128 v[40:43], v12 offset:5120
 s_waitcnt lgkmcnt(5)
 v_mfma_f32_32x32x16_bf16 v[64:79], v[52:55], a[20:23], v[64:79]
 v_mfma_f32_32x32x16_bf16 v[80:95], v[52:55], a[132:135], v[80:95]
 ds_read_b128 v[44:47], v12 offset:5632
 s_waitcnt lgkmcnt(5)
 v_mfma_f32_32x32x16_bf16 v[64:79], v[56:59], a[24:27], v[64:79]
 v_mfma_f32_32x32x16_bf16 v[80:95], v[56:59], a[136:139], v[80:95]
 ds_read_b128 v[48:51], v12 offset:6144
 s_waitcnt lgkmcnt(5)
 v_mfma_f32_32x32x16_bf16 v[64:79], v[60:63], a[28:31], v[64:79]
 v_mfma_f32_32x32x16_bf16 v[80:95], v[60:63], a[140:143], v[80:95]
 ds_read_b128 v[52:55], v12 offset:6656
 s_waitcnt lgkmcnt(5)
 v_mfma_f32_32x32x16_bf16 v[64:79], v[32:35], a[32:35], v[64:79]
 v_mfma_f32_32x32x16_bf16 v[80:95], v[32:35], a[144:147], v[80:95]
 ds_read_b128 v[56:59], v12 offset:7168
 s_waitcnt lgkmcnt(5)
 v_mfma_f32_32x32x16_bf16 v[64:79], v[36:39], a[36:39], v[64:79]
 v_mfma_f32_32x32x16_bf16 v[80:95], v[36:39], a[148:151], v[80:95]
 ds_read_b128 v[60:63], v12 offset:7680
 s_waitcnt lgkmcnt(5)
 v_mfma_f32_32x32x16_bf16 v[64:79], v[40:43], a[40:43], v[64:79]
 v_mfma_f32_32x32x16_bf16 v[80:95], v[40:43], a[152:155], v[80:95]
 ds_read_b128 v[32:35], v12 offset:8192
 s_waitcnt lgkmcnt(5)
 v_mfma_f32_32x32x16_bf16 v[64:79], v[44:47], a[44:47], v[64:79]
 v_mfma_f32_32x32x16_bf16 v[80:95], v[44:47], a[156:159], v[80:95]
 ds_read_b128 v[36:39], v12 offset:8704
 s_waitcnt lgkmcnt(5)
 v_mfma_f32_32x32x16_bf16 v[64:79], v[48:51], a[48:51], v[64:79]
 v_mfma_f32_32x32x16_bf16 v[80:95], v[48:51], a[160:163], v[80:95]
 ds_read_b128 v[40:43], v12 offset:9216
 s_waitcnt lgkmcnt(5)
 v_mfma_f32_32x32x16_bf16 v[64:79], v[52:55], a[52:55], v[64:79]
 v_mfma_f32_32x32x16_bf16 v[80:95], v[52:55], a[164:167], v[80:95]
 ds_read_b128 v[44:47], v12 offset:9728
 s_waitcnt lgkmcnt(5)
 v_mfma_f32_32x32x16_bf16 v[64:79], v[56:59], a[56:59], v[64:79]
 v_mfma_f32_32x32x16_bf16 v[80:95], v[56:59], a[168:171], v[80:95]
 ds_read_b128 v[48:51], v12 offset:10240
 s_waitcnt lgkmcnt(5)
 v_mfma_f32_32x32x16_bf16 v[64:79], v[60:63], a[60:63], v[64:79]
 v_mfma_f32_32x32x16_bf16 v[80:95], v[60:63], a[172:175], v[80:95]
 ds_read_b128 v[52:55], v12 offset:10752
 s_waitcnt lgkmcnt(5)
 v_mfma_f32_32x32x16_bf16 v[64:79], v[32:35], a[64:67], v[64:79]
 v_mfma_f32_32x32x16_bf16 v[80:95], v[32:35], a[176:179], v[80:95]
 ds_read_b128 v[56:59], v12 offset:11264
 s_waitcnt lgkmcnt(5)
 v_mfma_f32_32x32x16_bf16 v[64:79], v[36:39], a[68:71], v[64:79]
 v_mfma_f32_32x32x16_bf16 v[80:95], v[36:39], a[180:183], v[80:95]
 ds_read_b128 v[60:63], v12 offset:11776
 s_waitcnt lgkmcnt(5)
 v_mfma_f32_32x32x16_bf16 v[64:79], v[40:43], a[72:75], v[64:79]
 v_mfma_f32_32x32x16_bf16 v[80:95], v[40:43], a[184:187], v[80:95]
 ds_read_b128 v[32:35], v12 offset:12288
 s_waitcnt lgkmcnt(5)
 v_mfma_f32_32x32x16_bf16 v[64:79], v[44:47], a[76:79], v[64:79]
 v_mfma_f32_32x32x16_bf16 v[80:95], v[44:47], a[188:191], v[80:95]
 ds_read_b128 v[36:39], v12 offset:12800
 s_waitcnt lgkmcnt(5)
 v_mfma_f32_32x32x16_bf16 v[64:79], v[48:51], a[80:83], v[64:79]
 v_mfma_f32_32x32x16_bf16 v[80:95], v[48:51], a[192:195], v[80:95]
 ds_read_b128 v[40:43], v12 offset:13312
 s_waitcnt lgkmcnt(5)
 v_mfma_f32_32x32x16_bf16 v[64:79], v[52:55], a[84:87], v[64:79]
 v_mfma_f32_32x32x16_bf16 v[80:95], v[52:55], a[196:199], v[80:95]
 ds_read_b128 v[44:47], v12 offset:13824
 s_waitcnt lgkmcnt(5)
 v_mfma_f32_32x32x16_bf16 v[64:79], v[56:59], a[88:91], v[64:79]
 v_mfma_f32_32x32x16_bf16 v[80:95], v[56:59], a[200:203], v[80:95]
 s_waitcnt lgkmcnt(4)
 v_mfma_f32_32x32x16_bf16 v[64:79], v[60:63], a[92:95], v[64:79]
 v_mfma_f32_32x32x16_bf16 v[80:95], v[60:63], a[204:207], v[80:95]
 s_waitcnt lgkmcnt(3)
 v_mfma_f32_32x32x16_bf16 v[64:79], v[32:35], a[96:99], v[64:79]
 v_mfma_f32_32x32x16_bf16 v[80:95], v[32:35], a[208:211], v[80:95]
 s_waitcnt lgkmcnt(2)
 v_mfma_f32_32x32x16_bf16 v[64:79], v[36:39], a[100:103], v[64:79]
 v_mfma_f32_32x32x16_bf16 v[80:95], v[36:39], a[212:215], v[80:95]
 s_waitcnt lgkmcnt(1)
 v_mfma_f32_32x32x16_bf16 v[64:79], v[40:43], a[104:107], v[64:79]
 v_mfma_f32_32x32x16_bf16 v[80:95], v[40:43], a[216:219], v[80:95]
 s_waitcnt lgkmcnt(0)
 v_mfma_f32_32x32x16_bf16 v[64:79], v[44:47], a[108:111], v[64:79]
 v_mfma_f32_32x32x16_bf16 v[80:95], v[44:47], a[220:223], v[80:95]
 s_nop 7
 v_cvt_pk_bf16_f32 v128, v64, v65
 v_cvt_pk_bf16_f32 v129, v66, v67
 v_cvt_pk_bf16_f32 v130, v68, v69
 v_cvt_pk_bf16_f32 v131, v70, v71
 v_add_u32 v13, 11264, v11
 global_store_dwordx4 v13, v[128:131], s[30:31] sc1
 v_cvt_pk_bf16_f32 v132, v72, v73
 v_cvt_pk_bf16_f32 v133, v74, v75
 v_cvt_pk_bf16_f32 v134, v76, v77
 v_cvt_pk_bf16_f32 v135, v78, v79
 v_add_u32 v13, 12288, v11
 global_store_dwordx4 v13, v[132:135], s[30:31] sc1
 s_nop 3
 v_cvt_pk_bf16_f32 v136, v80, v81
 v_cvt_pk_bf16_f32 v137, v82, v83
 v_cvt_pk_bf16_f32 v138, v84, v85
 v_cvt_pk_bf16_f32 v139, v86, v87
 v_add_u32 v13, 11264, v11
 global_store_dwordx4 v13, v[136:139], s[32:33] sc1
 v_cvt_pk_bf16_f32 v140, v88, v89
 v_cvt_pk_bf16_f32 v141, v90, v91
 v_cvt_pk_bf16_f32 v142, v92, v93
 v_cvt_pk_bf16_f32 v143, v94, v95
 v_add_u32 v13, 12288, v11
 global_store_dwordx4 v13, v[140:143], s[32:33] sc1
 s_waitcnt vmcnt(8)
 s_barrier
 v_add_u32 v12, 0, v10
 ds_read_b128 v[32:35], v12 offset:0
 ds_read_b128 v[36:39], v12 offset:512
 ds_read_b128 v[40:43], v12 offset:1024
 ds_read_b128 v[44:47], v12 offset:1536
 ds_read_b128 v[48:51], v12 offset:2048
 ds_read_b128 v[52:55], v12 offset:2560
 s_waitcnt lgkmcnt(5)
 v_mfma_f32_32x32x16_bf16 v[64:79], v[32:35], a[0:3], 0
 v_mfma_f32_32x32x16_bf16 v[80:95], v[32:35], a[112:115], 0
 ds_read_b128 v[56:59], v12 offset:3072
 s_waitcnt lgkmcnt(5)
 v_mfma_f32_32x32x16_bf16 v[64:79], v[36:39], a[4:7], v[64:79]
 v_mfma_f32_32x32x16_bf16 v[80:95], v[36:39], a[116:119], v[80:95]
 ds_read_b128 v[60:63], v12 offset:3584
 s_waitcnt lgkmcnt(5)
 v_mfma_f32_32x32x16_bf16 v[64:79], v[40:43], a[8:11], v[64:79]
 v_mfma_f32_32x32x16_bf16 v[80:95], v[40:43], a[120:123], v[80:95]
 ds_read_b128 v[32:35], v12 offset:4096
 s_waitcnt lgkmcnt(5)
 v_mfma_f32_32x32x16_bf16 v[64:79], v[44:47], a[12:15], v[64:79]
 v_mfma_f32_32x32x16_bf16 v[80:95], v[44:47], a[124:127], v[80:95]
 ds_read_b128 v[36:39], v12 offset:4608
 s_waitcnt lgkmcnt(5)
 v_mfma_f32_32x32x16_bf16 v[64:79], v[48:51], a[16:19], v[64:79]
 v_mfma_f32_32x32x16_bf16 v[80:95], v[48:51], a[128:131], v[80:95]
 ds_read_b128 v[40:43], v12 offset:5120
 s_waitcnt lgkmcnt(5)
 v_mfma_f32_32x32x16_bf16 v[64:79], v[52:55], a[20:23], v[64:79]
 v_mfma_f32_32x32x16_bf16 v[80:95], v[52:55], a[132:135], v[80:95]
 ds_read_b128 v[44:47], v12 offset:5632
 s_waitcnt lgkmcnt(5)
 v_mfma_f32_32x32x16_bf16 v[64:79], v[56:59], a[24:27], v[64:79]
 v_mfma_f32_32x32x16_bf16 v[80:95], v[56:59], a[136:139], v[80:95]
 ds_read_b128 v[48:51], v12 offset:6144
 s_waitcnt lgkmcnt(5)
 v_mfma_f32_32x32x16_bf16 v[64:79], v[60:63], a[28:31], v[64:79]
 v_mfma_f32_32x32x16_bf16 v[80:95], v[60:63], a[140:143], v[80:95]
 ds_read_b128 v[52:55], v12 offset:6656
 s_waitcnt lgkmcnt(5)
 v_mfma_f32_32x32x16_bf16 v[64:79], v[32:35], a[32:35], v[64:79]
 v_mfma_f32_32x32x16_bf16 v[80:95], v[32:35], a[144:147], v[80:95]
 ds_read_b128 v[56:59], v12 offset:7168
 s_waitcnt lgkmcnt(5)
 v_mfma_f32_32x32x16_bf16 v[64:79], v[36:39], a[36:39], v[64:79]
 v_mfma_f32_32x32x16_bf16 v[80:95], v[36:39], a[148:151], v[80:95]
 ds_read_b128 v[60:63], v12 offset:7680
 s_waitcnt lgkmcnt(5)
 v_mfma_f32_32x32x16_bf16 v[64:79], v[40:43], a[40:43], v[64:79]
 v_mfma_f32_32x32x16_bf16 v[80:95], v[40:43], a[152:155], v[80:95]
 ds_read_b128 v[32:35], v12 offset:8192
 s_waitcnt lgkmcnt(5)
 v_mfma_f32_32x32x16_bf16 v[64:79], v[44:47], a[44:47], v[64:79]
 v_mfma_f32_32x32x16_bf16 v[80:95], v[44:47], a[156:159], v[80:95]
 ds_read_b128 v[36:39], v12 offset:8704
 s_waitcnt lgkmcnt(5)
 v_mfma_f32_32x32x16_bf16 v[64:79], v[48:51], a[48:51], v[64:79]
 v_mfma_f32_32x32x16_bf16 v[80:95], v[48:51], a[160:163], v[80:95]
 ds_read_b128 v[40:43], v12 offset:9216
 s_waitcnt lgkmcnt(5)
 v_mfma_f32_32x32x16_bf16 v[64:79], v[52:55], a[52:55], v[64:79]
 v_mfma_f32_32x32x16_bf16 v[80:95], v[52:55], a[164:167], v[80:95]
 ds_read_b128 v[44:47], v12 offset:9728
 s_waitcnt lgkmcnt(5)
 v_mfma_f32_32x32x16_bf16 v[64:79], v[56:59], a[56:59], v[64:79]
 v_mfma_f32_32x32x16_bf16 v[80:95], v[56:59], a[168:171], v[80:95]
 ds_read_b128 v[48:51], v12 offset:10240
 s_waitcnt lgkmcnt(5)
 v_mfma_f32_32x32x16_bf16 v[64:79], v[60:63], a[60:63], v[64:79]
 v_mfma_f32_32x32x16_bf16 v[80:95], v[60:63], a[172:175], v[80:95]
 ds_read_b128 v[52:55], v12 offset:10752
 s_waitcnt lgkmcnt(5)
 v_mfma_f32_32x32x16_bf16 v[64:79], v[32:35], a[64:67], v[64:79]
 v_mfma_f32_32x32x16_bf16 v[80:95], v[32:35], a[176:179], v[80:95]
 ds_read_b128 v[56:59], v12 offset:11264
 s_waitcnt lgkmcnt(5)
 v_mfma_f32_32x32x16_bf16 v[64:79], v[36:39], a[68:71], v[64:79]
 v_mfma_f32_32x32x16_bf16 v[80:95], v[36:39], a[180:183], v[80:95]
 ds_read_b128 v[60:63], v12 offset:11776
 s_waitcnt lgkmcnt(5)
 v_mfma_f32_32x32x16_bf16 v[64:79], v[40:43], a[72:75], v[64:79]
 v_mfma_f32_32x32x16_bf16 v[80:95], v[40:43], a[184:187], v[80:95]
 ds_read_b128 v[32:35], v12 offset:12288
 s_waitcnt lgkmcnt(5)
 v_mfma_f32_32x32x16_bf16 v[64:79], v[44:47], a[76:79], v[64:79]
 v_mfma_f32_32x32x16_bf16 v[80:95], v[44:47], a[188:191], v[80:95]
 ds_read_b128 v[36:39], v12 offset:12800
 s_waitcnt lgkmcnt(5)
 v_mfma_f32_32x32x16_bf16 v[64:79], v[48:51], a[80:83], v[64:79]
 v_mfma_f32_32x32x16_bf16 v[80:95], v[48:51], a[192:195], v[80:95]
 ds_read_b128 v[40:43], v12 offset:13312
 s_waitcnt lgkmcnt(5)
 v_mfma_f32_32x32x16_bf16 v[64:79], v[52:55], a[84:87], v[64:79]
 v_mfma_f32_32x32x16_bf16 v[80:95], v[52:55], a[196:199], v[80:95]
 ds_read_b128 v[44:47], v12 offset:13824
 s_waitcnt lgkmcnt(5)
 v_mfma_f32_32x32x16_bf16 v[64:79], v[56:59], a[88:91], v[64:79]
 v_mfma_f32_32x32x16_bf16 v[80:95], v[56:59], a[200:203], v[80:95]
 s_waitcnt lgkmcnt(4)
 v_mfma_f32_32x32x16_bf16 v[64:79], v[60:63], a[92:95], v[64:79]
 v_mfma_f32_32x32x16_bf16 v[80:95], v[60:63], a[204:207], v[80:95]
 s_waitcnt lgkmcnt(3)
 v_mfma_f32_32x32x16_bf16 v[64:79], v[32:35], a[96:99], v[64:79]
 v_mfma_f32_32x32x16_bf16 v[80:95], v[32:35], a[208:211], v[80:95]
 s_waitcnt lgkmcnt(2)
 v_mfma_f32_32x32x16_bf16 v[64:79], v[36:39], a[100:103], v[64:79]
 v_mfma_f32_32x32x16_bf16 v[80:95], v[36:39], a[212:215], v[80:95]
 s_waitcnt lgkmcnt(1)
 v_mfma_f32_32x32x16_bf16 v[64:79], v[40:43], a[104:107], v[64:79]
 v_mfma_f32_32x32x16_bf16 v[80:95], v[40:43], a[216:219], v[80:95]
 s_waitcnt lgkmcnt(0)
 v_mfma_f32_32x32x16_bf16 v[64:79], v[44:47], a[108:111], v[64:79]
 v_mfma_f32_32x32x16_bf16 v[80:95], v[44:47], a[220:223], v[80:95]
 s_nop 7
 v_cvt_pk_bf16_f32 v128, v64, v65
 v_cvt_pk_bf16_f32 v129, v66, v67
 v_cvt_pk_bf16_f32 v130, v68, v69
 v_cvt_pk_bf16_f32 v131, v70, v71
 v_add_u32 v13, 6144, v11
 global_store_dwordx4 v13, v[128:131], s[30:31] sc1
 v_cvt_pk_bf16_f32 v132, v72, v73
 v_cvt_pk_bf16_f32 v133, v74, v75
 v_cvt_pk_bf16_f32 v134, v76, v77
 v_cvt_pk_bf16_f32 v135, v78, v79
 v_add_u32 v13, 13312, v11
 global_store_dwordx4 v13, v[132:135], s[30:31] sc1
 s_nop 3
 v_cvt_pk_bf16_f32 v136, v80, v81
 v_cvt_pk_bf16_f32 v137, v82, v83
 v_cvt_pk_bf16_f32 v138, v84, v85
 v_cvt_pk_bf16_f32 v139, v86, v87
 v_add_u32 v13, 6144, v11
 global_store_dwordx4 v13, v[136:139], s[32:33] sc1
 v_cvt_pk_bf16_f32 v140, v88, v89
 v_cvt_pk_bf16_f32 v141, v90, v91
 v_cvt_pk_bf16_f32 v142, v92, v93
 v_cvt_pk_bf16_f32 v143, v94, v95
 v_add_u32 v13, 13312, v11
 global_store_dwordx4 v13, v[140:143], s[32:33] sc1
 s_branch PQX_L
PQX_X:
 s_mov_b32 s17, 0
PF2_L:
 s_waitcnt vmcnt(0)
 s_barrier
 s_cmp_lg_u32 s16, 0
 s_cbranch_scc1 PF2_C1
 s_mov_b64 exec, 1
 v_mov_b32 v2, 1
 s_cmp_eq_u32 s51, 0
 s_cbranch_scc1 PF2_T
 v_mov_b32 v1, s51
 v_mov_b32 v3, s52
 global_atomic_add v1, v3, s[4:5] sc1
PF2_T:
 s_lshl_b32 s20, s17, 8
 s_add_u32 s20, s20, 85597184
 v_mov_b32 v1, s20
 global_atomic_add v3, v1, v2, s[4:5] sc0 sc1
 s_cmp_lt_u32 s17, 4
 s_cselect_b32 s20, 32, 32
 s_waitcnt vmcnt(0)
 v_readfirstlane_b32 s18, v3
 s_cmp_lt_u32 s18, s20
 s_cbranch_scc1 PF2_W
 s_mov_b32 s18, -1
PF2_W:
 v_mov_b32 v1, 0x27F00
 v_mov_b32 v2, s18
 v_mov_b32 v3, s17
 ds_write_b64 v1, v[2:3]
 s_mov_b64 exec, -1
 s_waitcnt lgkmcnt(0)
PF2_C1:
 s_barrier
 v_mov_b32 v1, 0x27F00
 ds_read_b64 v[2:3], v1
 s_mov_b32 s51, 0
 s_mov_b32 s52, 1
 s_waitcnt lgkmcnt(0)
 v_readfirstlane_b32 s18, v2
 v_readfirstlane_b32 s17, v3
 s_cmp_eq_u32 s18, -1
 s_cbranch_scc1 PF2_X
 s_mov_b32 s51, 85609728
 v_and_b32 v2, 63, v0
 v_and_b32 v3, 31, v2
 v_lshrrev_b32 v4, 5, v2
 v_lshlrev_b32 v8, 2, v4
 v_add_u32 v9, 0, v3
 v_add_u32 v16, 0, v8
 v_mul_u32_u24 v16, v16, v9
 v_and_b32 v16, 63, v16
 v_cvt_f32_u32 v16, v16
 v_mul_f32 v16, 1015021568, v16
 v_cos_f32 v20, v16
 v_sin_f32 v22, v16
 v_add_u32 v16, 1, v8
 v_mul_u32_u24 v16, v16, v9
 v_and_b32 v16, 63, v16
 v_cvt_f32_u32 v16, v16
 v_mul_f32 v16, 1015021568, v16
 v_cos_f32 v21, v16
 v_sin_f32 v23, v16
 v_cvt_pk_bf16_f32 v17, v20, v21
 v_cvt_pk_bf16_f32 v18, v22, v23
 v_xor_b32 v19, 0x80008000, v18
 v_accvgpr_write_b32 a0, v17
 v_accvgpr_write_b32 a32, v18
 v_accvgpr_write_b32 a64, v19
 v_add_u32 v16, 2, v8
 v_mul_u32_u24 v16, v16, v9
 v_and_b32 v16, 63, v16
 v_cvt_f32_u32 v16, v16
 v_mul_f32 v16, 1015021568, v16
 v_cos_f32 v20, v16
 v_sin_f32 v22, v16
 v_add_u32 v16, 3, v8
 v_mul_u32_u24 v16, v16, v9
 v_and_b32 v16, 63, v16
 v_cvt_f32_u32 v16, v16
 v_mul_f32 v16, 1015021568, v16
 v_cos_f32 v21, v16
 v_sin_f32 v23, v16
 v_cvt_pk_bf16_f32 v17, v20, v21
 v_cvt_pk_bf16_f32 v18, v22, v23
 v_xor_b32 v19, 0x80008000, v18
 v_accvgpr_write_b32 a1, v17
 v_accvgpr_write_b32 a33, v18
 v_accvgpr_write_b32 a65, v19
 v_add_u32 v16, 8, v8
 v_mul_u32_u24 v16, v16, v9
 v_and_b32 v16, 63, v16
 v_cvt_f32_u32 v16, v16
 v_mul_f32 v16, 1015021568, v16
 v_cos_f32 v20, v16
 v_sin_f32 v22, v16
 v_add_u32 v16, 9, v8
 v_mul_u32_u24 v16, v16, v9
 v_and_b32 v16, 63, v16
 v_cvt_f32_u32 v16, v16
 v_mul_f32 v16, 1015021568, v16
 v_cos_f32 v21, v16
 v_sin_f32 v23, v16
 v_cvt_pk_bf16_f32 v17, v20, v21
 v_cvt_pk_bf16_f32 v18, v22, v23
 v_xor_b32 v19, 0x80008000, v18
 v_accvgpr_write_b32 a2, v17
 v_accvgpr_write_b32 a34, v18
 v_accvgpr_write_b32 a66, v19
 v_add_u32 v16, 10, v8
 v_mul_u32_u24 v16, v16, v9
 v_and_b32 v16, 63, v16
 v_cvt_f32_u32 v16, v16
 v_mul_f32 v16, 1015021568, v16
 v_cos_f32 v20, v16
 v_sin_f32 v22, v16
 v_add_u32 v16, 11, v8
 v_mul_u32_u24 v16, v16, v9
 v_and_b32 v16, 63, v16
 v_cvt_f32_u32 v16, v16
 v_mul_f32 v16, 1015021568, v16
 v_cos_f32 v21, v16
 v_sin_f32 v23, v16
 v_cvt_pk_bf16_f32 v17, v20, v21
 v_cvt_pk_bf16_f32 v18, v22, v23
 v_xor_b32 v19, 0x80008000, v18
 v_accvgpr_write_b32 a3, v17
 v_accvgpr_write_b32 a35, v18
 v_accvgpr_write_b32 a67, v19
 v_add_u32 v16, 16, v8
 v_mul_u32_u24 v16, v16, v9
 v_and_b32 v16, 63, v16
 v_cvt_f32_u32 v16, v16
 v_mul_f32 v16, 1015021568, v16
 v_cos_f32 v20, v16
 v_sin_f32 v22, v16
 v_add_u32 v16, 17, v8
 v_mul_u32_u24 v16, v16, v9
 v_and_b32 v16, 63, v16
 v_cvt_f32_u32 v16, v16
 v_mul_f32 v16, 1015021568, v16
 v_cos_f32 v21, v16
 v_sin_f32 v23, v16
 v_cvt_pk_bf16_f32 v17, v20, v21
 v_cvt_pk_bf16_f32 v18, v22, v23
 v_xor_b32 v19, 0x80008000, v18
 v_accvgpr_write_b32 a4, v17
 v_accvgpr_write_b32 a36, v18
 v_accvgpr_write_b32 a68, v19
 v_add_u32 v16, 18, v8
 v_mul_u32_u24 v16, v16, v9
 v_and_b32 v16, 63, v16
 v_cvt_f32_u32 v16, v16
 v_mul_f32 v16, 1015021568, v16
 v_cos_f32 v20, v16
 v_sin_f32 v22, v16
 v_add_u32 v16, 19, v8
 v_mul_u32_u24 v16, v16, v9
 v_and_b32 v16, 63, v16
 v_cvt_f32_u32 v16, v16
 v_mul_f32 v16, 1015021568, v16
 v_cos_f32 v21, v16
 v_sin_f32 v23, v16
 v_cvt_pk_bf16_f32 v17, v20, v21
 v_cvt_pk_bf16_f32 v18, v22, v23
 v_xor_b32 v19, 0x80008000, v18
 v_accvgpr_write_b32 a5, v17
 v_accvgpr_write_b32 a37, v18
 v_accvgpr_write_b32 a69, v19
 v_add_u32 v16, 24, v8
 v_mul_u32_u24 v16, v16, v9
 v_and_b32 v16, 63, v16
 v_cvt_f32_u32 v16, v16
 v_mul_f32 v16, 1015021568, v16
 v_cos_f32 v20, v16
 v_sin_f32 v22, v16
 v_add_u32 v16, 25, v8
 v_mul_u32_u24 v16, v16, v9
 v_and_b32 v16, 63, v16
 v_cvt_f32_u32 v16, v16
 v_mul_f32 v16, 1015021568, v16
 v_cos_f32 v21, v16
 v_sin_f32 v23, v16
 v_cvt_pk_bf16_f32 v17, v20, v21
 v_cvt_pk_bf16_f32 v18, v22, v23
 v_xor_b32 v19, 0x80008000, v18
 v_accvgpr_write_b32 a6, v17
 v_accvgpr_write_b32 a38, v18
 v_accvgpr_write_b32 a70, v19
 v_add_u32 v16, 26, v8
 v_mul_u32_u24 v16, v16, v9
 v_and_b32 v16, 63, v16
 v_cvt_f32_u32 v16, v16
 v_mul_f32 v16, 1015021568, v16
 v_cos_f32 v20, v16
 v_sin_f32 v22, v16
 v_add_u32 v16, 27, v8
 v_mul_u32_u24 v16, v16, v9
 v_and_b32 v16, 63, v16
 v_cvt_f32_u32 v16, v16
 v_mul_f32 v16, 1015021568, v16
 v_cos_f32 v21, v16
 v_sin_f32 v23, v16
 v_cvt_pk_bf16_f32 v17, v20, v21
 v_cvt_pk_bf16_f32 v18, v22, v23
 v_xor_b32 v19, 0x80008000, v18
 v_accvgpr_write_b32 a7, v17
 v_accvgpr_write_b32 a39, v18
 v_accvgpr_write_b32 a71, v19
 v_add_u32 v16, 32, v8
 v_mul_u32_u24 v16, v16, v9
 v_and_b32 v16, 63, v16
 v_cvt_f32_u32 v16, v16
 v_mul_f32 v16, 1015021568, v16
 v_cos_f32 v20, v16
 v_sin_f32 v22, v16
 v_add_u32 v16, 33, v8
 v_mul_u32_u24 v16, v16, v9
 v_and_b32 v16, 63, v16
 v_cvt_f32_u32 v16, v16
 v_mul_f32 v16, 1015021568, v16
 v_cos_f32 v21, v16
 v_sin_f32 v23, v16
 v_cvt_pk_bf16_f32 v17, v20, v21
 v_cvt_pk_bf16_f32 v18, v22, v23
 v_xor_b32 v19, 0x80008000, v18
 v_accvgpr_write_b32 a8, v17
 v_accvgpr_write_b32 a40, v18
 v_accvgpr_write_b32 a72, v19
 v_add_u32 v16, 34, v8
 v_mul_u32_u24 v16, v16, v9
 v_and_b32 v16, 63, v16
 v_cvt_f32_u32 v16, v16
 v_mul_f32 v16, 1015021568, v16
 v_cos_f32 v20, v16
 v_sin_f32 v22, v16
 v_add_u32 v16, 35, v8
 v_mul_u32_u24 v16, v16, v9
 v_and_b32 v16, 63, v16
 v_cvt_f32_u32 v16, v16
 v_mul_f32 v16, 1015021568, v16
 v_cos_f32 v21, v16
 v_sin_f32 v23, v16
 v_cvt_pk_bf16_f32 v17, v20, v21
 v_cvt_pk_bf16_f32 v18, v22, v23
 v_xor_b32 v19, 0x80008000, v18
 v_accvgpr_write_b32 a9, v17
 v_accvgpr_write_b32 a41, v18
 v_accvgpr_write_b32 a73, v19
 v_add_u32 v16, 40, v8
 v_mul_u32_u24 v16, v16, v9
 v_and_b32 v16, 63, v16
 v_cvt_f32_u32 v16, v16
 v_mul_f32 v16, 1015021568, v16
 v_cos_f32 v20, v16
 v_sin_f32 v22, v16
 v_add_u32 v16, 41, v8
 v_mul_u32_u24 v16, v16, v9
 v_and_b32 v16, 63, v16
 v_cvt_f32_u32 v16, v16
 v_mul_f32 v16, 1015021568, v16
 v_cos_f32 v21, v16
 v_sin_f32 v23, v16
 v_cvt_pk_bf16_f32 v17, v20, v21
 v_cvt_pk_bf16_f32 v18, v22, v23
 v_xor_b32 v19, 0x80008000, v18
 v_accvgpr_write_b32 a10, v17
 v_accvgpr_write_b32 a42, v18
 v_accvgpr_write_b32 a74, v19
 v_add_u32 v16, 42, v8
 v_mul_u32_u24 v16, v16, v9
 v_and_b32 v16, 63, v16
 v_cvt_f32_u32 v16, v16
 v_mul_f32 v16, 1015021568, v16
 v_cos_f32 v20, v16
 v_sin_f32 v22, v16
 v_add_u32 v16, 43, v8
 v_mul_u32_u24 v16, v16, v9
 v_and_b32 v16, 63, v16
 v_cvt_f32_u32 v16, v16
 v_mul_f32 v16, 1015021568, v16
 v_cos_f32 v21, v16
 v_sin_f32 v23, v16
 v_cvt_pk_bf16_f32 v17, v20, v21
 v_cvt_pk_bf16_f32 v18, v22, v23
 v_xor_b32 v19, 0x80008000, v18
 v_accvgpr_write_b32 a11, v17
 v_accvgpr_write_b32 a43, v18
 v_accvgpr_write_b32 a75, v19
 v_add_u32 v16, 48, v8
 v_mul_u32_u24 v16, v16, v9
 v_and_b32 v16, 63, v16
 v_cvt_f32_u32 v16, v16
 v_mul_f32 v16, 1015021568, v16
 v_cos_f32 v20, v16
 v_sin_f32 v22, v16
 v_add_u32 v16, 49, v8
 v_mul_u32_u24 v16, v16, v9
 v_and_b32 v16, 63, v16
 v_cvt_f32_u32 v16, v16
 v_mul_f32 v16, 1015021568, v16
 v_cos_f32 v21, v16
 v_sin_f32 v23, v16
 v_cvt_pk_bf16_f32 v17, v20, v21
 v_cvt_pk_bf16_f32 v18, v22, v23
 v_xor_b32 v19, 0x80008000, v18
 v_accvgpr_write_b32 a12, v17
 v_accvgpr_write_b32 a44, v18
 v_accvgpr_write_b32 a76, v19
 v_add_u32 v16, 50, v8
 v_mul_u32_u24 v16, v16, v9
 v_and_b32 v16, 63, v16
 v_cvt_f32_u32 v16, v16
 v_mul_f32 v16, 1015021568, v16
 v_cos_f32 v20, v16
 v_sin_f32 v22, v16
 v_add_u32 v16, 51, v8
 v_mul_u32_u24 v16, v16, v9
 v_and_b32 v16, 63, v16
 v_cvt_f32_u32 v16, v16
 v_mul_f32 v16, 1015021568, v16
 v_cos_f32 v21, v16
 v_sin_f32 v23, v16
 v_cvt_pk_bf16_f32 v17, v20, v21
 v_cvt_pk_bf16_f32 v18, v22, v23
 v_xor_b32 v19, 0x80008000, v18
 v_accvgpr_write_b32 a13, v17
 v_accvgpr_write_b32 a45, v18
 v_accvgpr_write_b32 a77, v19
 v_add_u32 v16, 56, v8
 v_mul_u32_u24 v16, v16, v9
 v_and_b32 v16, 63, v16
 v_cvt_f32_u32 v16, v16
 v_mul_f32 v16, 1015021568, v16
 v_cos_f32 v20, v16
 v_sin_f32 v22, v16
 v_add_u32 v16, 57, v8
 v_mul_u32_u24 v16, v16, v9
 v_and_b32 v16, 63, v16
 v_cvt_f32_u32 v16, v16
 v_mul_f32 v16, 1015021568, v16
 v_cos_f32 v21, v16
 v_sin_f32 v23, v16
 v_cvt_pk_bf16_f32 v17, v20, v21
 v_cvt_pk_bf16_f32 v18, v22, v23
 v_xor_b32 v19, 0x80008000, v18
 v_accvgpr_write_b32 a14, v17
 v_accvgpr_write_b32 a46, v18
 v_accvgpr_write_b32 a78, v19
 v_add_u32 v16, 58, v8
 v_mul_u32_u24 v16, v16, v9
 v_and_b32 v16, 63, v16
 v_cvt_f32_u32 v16, v16
 v_mul_f32 v16, 1015021568, v16
 v_cos_f32 v20, v16
 v_sin_f32 v22, v16
 v_add_u32 v16, 59, v8
 v_mul_u32_u24 v16, v16, v9
 v_and_b32 v16, 63, v16
 v_cvt_f32_u32 v16, v16
 v_mul_f32 v16, 1015021568, v16
 v_cos_f32 v21, v16
 v_sin_f32 v23, v16
 v_cvt_pk_bf16_f32 v17, v20, v21
 v_cvt_pk_bf16_f32 v18, v22, v23
 v_xor_b32 v19, 0x80008000, v18
 v_accvgpr_write_b32 a15, v17
 v_accvgpr_write_b32 a47, v18
 v_accvgpr_write_b32 a79, v19
 v_add_u32 v9, 32, v3
 v_add_u32 v16, 0, v8
 v_mul_u32_u24 v16, v16, v9
 v_and_b32 v16, 63, v16
 v_cvt_f32_u32 v16, v16
 v_mul_f32 v16, 1015021568, v16
 v_cos_f32 v20, v16
 v_sin_f32 v22, v16
 v_add_u32 v16, 1, v8
 v_mul_u32_u24 v16, v16, v9
 v_and_b32 v16, 63, v16
 v_cvt_f32_u32 v16, v16
 v_mul_f32 v16, 1015021568, v16
 v_cos_f32 v21, v16
 v_sin_f32 v23, v16
 v_cvt_pk_bf16_f32 v17, v20, v21
 v_cvt_pk_bf16_f32 v18, v22, v23
 v_xor_b32 v19, 0x80008000, v18
 v_accvgpr_write_b32 a16, v17
 v_accvgpr_write_b32 a48, v18
 v_accvgpr_write_b32 a80, v19
 v_add_u32 v16, 2, v8
 v_mul_u32_u24 v16, v16, v9
 v_and_b32 v16, 63, v16
 v_cvt_f32_u32 v16, v16
 v_mul_f32 v16, 1015021568, v16
 v_cos_f32 v20, v16
 v_sin_f32 v22, v16
 v_add_u32 v16, 3, v8
 v_mul_u32_u24 v16, v16, v9
 v_and_b32 v16, 63, v16
 v_cvt_f32_u32 v16, v16
 v_mul_f32 v16, 1015021568, v16
 v_cos_f32 v21, v16
 v_sin_f32 v23, v16
 v_cvt_pk_bf16_f32 v17, v20, v21
 v_cvt_pk_bf16_f32 v18, v22, v23
 v_xor_b32 v19, 0x80008000, v18
 v_accvgpr_write_b32 a17, v17
 v_accvgpr_write_b32 a49, v18
 v_accvgpr_write_b32 a81, v19
 v_add_u32 v16, 8, v8
 v_mul_u32_u24 v16, v16, v9
 v_and_b32 v16, 63, v16
 v_cvt_f32_u32 v16, v16
 v_mul_f32 v16, 1015021568, v16
 v_cos_f32 v20, v16
 v_sin_f32 v22, v16
 v_add_u32 v16, 9, v8
 v_mul_u32_u24 v16, v16, v9
 v_and_b32 v16, 63, v16
 v_cvt_f32_u32 v16, v16
 v_mul_f32 v16, 1015021568, v16
 v_cos_f32 v21, v16
 v_sin_f32 v23, v16
 v_cvt_pk_bf16_f32 v17, v20, v21
 v_cvt_pk_bf16_f32 v18, v22, v23
 v_xor_b32 v19, 0x80008000, v18
 v_accvgpr_write_b32 a18, v17
 v_accvgpr_write_b32 a50, v18
 v_accvgpr_write_b32 a82, v19
 v_add_u32 v16, 10, v8
 v_mul_u32_u24 v16, v16, v9
 v_and_b32 v16, 63, v16
 v_cvt_f32_u32 v16, v16
 v_mul_f32 v16, 1015021568, v16
 v_cos_f32 v20, v16
 v_sin_f32 v22, v16
 v_add_u32 v16, 11, v8
 v_mul_u32_u24 v16, v16, v9
 v_and_b32 v16, 63, v16
 v_cvt_f32_u32 v16, v16
 v_mul_f32 v16, 1015021568, v16
 v_cos_f32 v21, v16
 v_sin_f32 v23, v16
 v_cvt_pk_bf16_f32 v17, v20, v21
 v_cvt_pk_bf16_f32 v18, v22, v23
 v_xor_b32 v19, 0x80008000, v18
 v_accvgpr_write_b32 a19, v17
 v_accvgpr_write_b32 a51, v18
 v_accvgpr_write_b32 a83, v19
 v_add_u32 v16, 16, v8
 v_mul_u32_u24 v16, v16, v9
 v_and_b32 v16, 63, v16
 v_cvt_f32_u32 v16, v16
 v_mul_f32 v16, 1015021568, v16
 v_cos_f32 v20, v16
 v_sin_f32 v22, v16
 v_add_u32 v16, 17, v8
 v_mul_u32_u24 v16, v16, v9
 v_and_b32 v16, 63, v16
 v_cvt_f32_u32 v16, v16
 v_mul_f32 v16, 1015021568, v16
 v_cos_f32 v21, v16
 v_sin_f32 v23, v16
 v_cvt_pk_bf16_f32 v17, v20, v21
 v_cvt_pk_bf16_f32 v18, v22, v23
 v_xor_b32 v19, 0x80008000, v18
 v_accvgpr_write_b32 a20, v17
 v_accvgpr_write_b32 a52, v18
 v_accvgpr_write_b32 a84, v19
 v_add_u32 v16, 18, v8
 v_mul_u32_u24 v16, v16, v9
 v_and_b32 v16, 63, v16
 v_cvt_f32_u32 v16, v16
 v_mul_f32 v16, 1015021568, v16
 v_cos_f32 v20, v16
 v_sin_f32 v22, v16
 v_add_u32 v16, 19, v8
 v_mul_u32_u24 v16, v16, v9
 v_and_b32 v16, 63, v16
 v_cvt_f32_u32 v16, v16
 v_mul_f32 v16, 1015021568, v16
 v_cos_f32 v21, v16
 v_sin_f32 v23, v16
 v_cvt_pk_bf16_f32 v17, v20, v21
 v_cvt_pk_bf16_f32 v18, v22, v23
 v_xor_b32 v19, 0x80008000, v18
 v_accvgpr_write_b32 a21, v17
 v_accvgpr_write_b32 a53, v18
 v_accvgpr_write_b32 a85, v19
 v_add_u32 v16, 24, v8
 v_mul_u32_u24 v16, v16, v9
 v_and_b32 v16, 63, v16
 v_cvt_f32_u32 v16, v16
 v_mul_f32 v16, 1015021568, v16
 v_cos_f32 v20, v16
 v_sin_f32 v22, v16
 v_add_u32 v16, 25, v8
 v_mul_u32_u24 v16, v16, v9
 v_and_b32 v16, 63, v16
 v_cvt_f32_u32 v16, v16
 v_mul_f32 v16, 1015021568, v16
 v_cos_f32 v21, v16
 v_sin_f32 v23, v16
 v_cvt_pk_bf16_f32 v17, v20, v21
 v_cvt_pk_bf16_f32 v18, v22, v23
 v_xor_b32 v19, 0x80008000, v18
 v_accvgpr_write_b32 a22, v17
 v_accvgpr_write_b32 a54, v18
 v_accvgpr_write_b32 a86, v19
 v_add_u32 v16, 26, v8
 v_mul_u32_u24 v16, v16, v9
 v_and_b32 v16, 63, v16
 v_cvt_f32_u32 v16, v16
 v_mul_f32 v16, 1015021568, v16
 v_cos_f32 v20, v16
 v_sin_f32 v22, v16
 v_add_u32 v16, 27, v8
 v_mul_u32_u24 v16, v16, v9
 v_and_b32 v16, 63, v16
 v_cvt_f32_u32 v16, v16
 v_mul_f32 v16, 1015021568, v16
 v_cos_f32 v21, v16
 v_sin_f32 v23, v16
 v_cvt_pk_bf16_f32 v17, v20, v21
 v_cvt_pk_bf16_f32 v18, v22, v23
 v_xor_b32 v19, 0x80008000, v18
 v_accvgpr_write_b32 a23, v17
 v_accvgpr_write_b32 a55, v18
 v_accvgpr_write_b32 a87, v19
 v_add_u32 v16, 32, v8
 v_mul_u32_u24 v16, v16, v9
 v_and_b32 v16, 63, v16
 v_cvt_f32_u32 v16, v16
 v_mul_f32 v16, 1015021568, v16
 v_cos_f32 v20, v16
 v_sin_f32 v22, v16
 v_add_u32 v16, 33, v8
 v_mul_u32_u24 v16, v16, v9
 v_and_b32 v16, 63, v16
 v_cvt_f32_u32 v16, v16
 v_mul_f32 v16, 1015021568, v16
 v_cos_f32 v21, v16
 v_sin_f32 v23, v16
 v_cvt_pk_bf16_f32 v17, v20, v21
 v_cvt_pk_bf16_f32 v18, v22, v23
 v_xor_b32 v19, 0x80008000, v18
 v_accvgpr_write_b32 a24, v17
 v_accvgpr_write_b32 a56, v18
 v_accvgpr_write_b32 a88, v19
 v_add_u32 v16, 34, v8
 v_mul_u32_u24 v16, v16, v9
 v_and_b32 v16, 63, v16
 v_cvt_f32_u32 v16, v16
 v_mul_f32 v16, 1015021568, v16
 v_cos_f32 v20, v16
 v_sin_f32 v22, v16
 v_add_u32 v16, 35, v8
 v_mul_u32_u24 v16, v16, v9
 v_and_b32 v16, 63, v16
 v_cvt_f32_u32 v16, v16
 v_mul_f32 v16, 1015021568, v16
 v_cos_f32 v21, v16
 v_sin_f32 v23, v16
 v_cvt_pk_bf16_f32 v17, v20, v21
 v_cvt_pk_bf16_f32 v18, v22, v23
 v_xor_b32 v19, 0x80008000, v18
 v_accvgpr_write_b32 a25, v17
 v_accvgpr_write_b32 a57, v18
 v_accvgpr_write_b32 a89, v19
 v_add_u32 v16, 40, v8
 v_mul_u32_u24 v16, v16, v9
 v_and_b32 v16, 63, v16
 v_cvt_f32_u32 v16, v16
 v_mul_f32 v16, 1015021568, v16
 v_cos_f32 v20, v16
 v_sin_f32 v22, v16
 v_add_u32 v16, 41, v8
 v_mul_u32_u24 v16, v16, v9
 v_and_b32 v16, 63, v16
 v_cvt_f32_u32 v16, v16
 v_mul_f32 v16, 1015021568, v16
 v_cos_f32 v21, v16
 v_sin_f32 v23, v16
 v_cvt_pk_bf16_f32 v17, v20, v21
 v_cvt_pk_bf16_f32 v18, v22, v23
 v_xor_b32 v19, 0x80008000, v18
 v_accvgpr_write_b32 a26, v17
 v_accvgpr_write_b32 a58, v18
 v_accvgpr_write_b32 a90, v19
 v_add_u32 v16, 42, v8
 v_mul_u32_u24 v16, v16, v9
 v_and_b32 v16, 63, v16
 v_cvt_f32_u32 v16, v16
 v_mul_f32 v16, 1015021568, v16
 v_cos_f32 v20, v16
 v_sin_f32 v22, v16
 v_add_u32 v16, 43, v8
 v_mul_u32_u24 v16, v16, v9
 v_and_b32 v16, 63, v16
 v_cvt_f32_u32 v16, v16
 v_mul_f32 v16, 1015021568, v16
 v_cos_f32 v21, v16
 v_sin_f32 v23, v16
 v_cvt_pk_bf16_f32 v17, v20, v21
 v_cvt_pk_bf16_f32 v18, v22, v23
 v_xor_b32 v19, 0x80008000, v18
 v_accvgpr_write_b32 a27, v17
 v_accvgpr_write_b32 a59, v18
 v_accvgpr_write_b32 a91, v19
 v_add_u32 v16, 48, v8
 v_mul_u32_u24 v16, v16, v9
 v_and_b32 v16, 63, v16
 v_cvt_f32_u32 v16, v16
 v_mul_f32 v16, 1015021568, v16
 v_cos_f32 v20, v16
 v_sin_f32 v22, v16
 v_add_u32 v16, 49, v8
 v_mul_u32_u24 v16, v16, v9
 v_and_b32 v16, 63, v16
 v_cvt_f32_u32 v16, v16
 v_mul_f32 v16, 1015021568, v16
 v_cos_f32 v21, v16
 v_sin_f32 v23, v16
 v_cvt_pk_bf16_f32 v17, v20, v21
 v_cvt_pk_bf16_f32 v18, v22, v23
 v_xor_b32 v19, 0x80008000, v18
 v_accvgpr_write_b32 a28, v17
 v_accvgpr_write_b32 a60, v18
 v_accvgpr_write_b32 a92, v19
 v_add_u32 v16, 50, v8
 v_mul_u32_u24 v16, v16, v9
 v_and_b32 v16, 63, v16
 v_cvt_f32_u32 v16, v16
 v_mul_f32 v16, 1015021568, v16
 v_cos_f32 v20, v16
 v_sin_f32 v22, v16
 v_add_u32 v16, 51, v8
 v_mul_u32_u24 v16, v16, v9
 v_and_b32 v16, 63, v16
 v_cvt_f32_u32 v16, v16
 v_mul_f32 v16, 1015021568, v16
 v_cos_f32 v21, v16
 v_sin_f32 v23, v16
 v_cvt_pk_bf16_f32 v17, v20, v21
 v_cvt_pk_bf16_f32 v18, v22, v23
 v_xor_b32 v19, 0x80008000, v18
 v_accvgpr_write_b32 a29, v17
 v_accvgpr_write_b32 a61, v18
 v_accvgpr_write_b32 a93, v19
 v_add_u32 v16, 56, v8
 v_mul_u32_u24 v16, v16, v9
 v_and_b32 v16, 63, v16
 v_cvt_f32_u32 v16, v16
 v_mul_f32 v16, 1015021568, v16
 v_cos_f32 v20, v16
 v_sin_f32 v22, v16
 v_add_u32 v16, 57, v8
 v_mul_u32_u24 v16, v16, v9
 v_and_b32 v16, 63, v16
 v_cvt_f32_u32 v16, v16
 v_mul_f32 v16, 1015021568, v16
 v_cos_f32 v21, v16
 v_sin_f32 v23, v16
 v_cvt_pk_bf16_f32 v17, v20, v21
 v_cvt_pk_bf16_f32 v18, v22, v23
 v_xor_b32 v19, 0x80008000, v18
 v_accvgpr_write_b32 a30, v17
 v_accvgpr_write_b32 a62, v18
 v_accvgpr_write_b32 a94, v19
 v_add_u32 v16, 58, v8
 v_mul_u32_u24 v16, v16, v9
 v_and_b32 v16, 63, v16
 v_cvt_f32_u32 v16, v16
 v_mul_f32 v16, 1015021568, v16
 v_cos_f32 v20, v16
 v_sin_f32 v22, v16
 v_add_u32 v16, 59, v8
 v_mul_u32_u24 v16, v16, v9
 v_and_b32 v16, 63, v16
 v_cvt_f32_u32 v16, v16
 v_mul_f32 v16, 1015021568, v16
 v_cos_f32 v21, v16
 v_sin_f32 v23, v16
 v_cvt_pk_bf16_f32 v17, v20, v21
 v_cvt_pk_bf16_f32 v18, v22, v23
 v_xor_b32 v19, 0x80008000, v18
 v_accvgpr_write_b32 a31, v17
 v_accvgpr_write_b32 a63, v18
 v_accvgpr_write_b32 a95, v19
 s_mov_b32 s24, 85609472
 v_mov_b32 v10, s24
 s_mov_b32 s41, 0
W1_1:
 global_load_dword v12, v10, s[4:5] sc1
 s_add_u32 s41, s41, 1
 s_cmp_gt_u32 s41, 2000000
 s_cbranch_scc1 K2_EXIT
 s_waitcnt vmcnt(0)
 v_readfirstlane_b32 s42, v12
 s_cmp_ge_u32 s42, 128
 s_cbranch_scc1 W1_1_D
 s_sleep 8
 s_branch W1_1
W1_1_D:
 s_lshl_b32 s20, s18, 16
 s_add_u32 s20, s20, 14876672
 s_add_u32 s30, s4, s20
 s_addc_u32 s31, s5, 0
 s_lshl_b32 s21, s16, 7
 v_lshlrev_b32 v5, 2, v3
 v_add_u32 v5, s21, v5
 v_lshl_add_u32 v6, v4, 12, v5
 s_mov_b32 s22, 0x05040100
 s_mov_b32 s23, 0x07060302
 global_load_dword v32, v6, s[30:31] offset:0
 global_load_dword v33, v6, s[30:31] offset:1024
 global_load_dword v34, v6, s[30:31] offset:2048
 global_load_dword v35, v6, s[30:31] offset:3072
 global_load_dword v40, v6, s[30:31] offset:512
 global_load_dword v41, v6, s[30:31] offset:1536
 global_load_dword v42, v6, s[30:31] offset:2560
 global_load_dword v43, v6, s[30:31] offset:3584
 v_add_u32 v6, 8192, v6
 global_load_dword v36, v6, s[30:31] offset:0
 global_load_dword v37, v6, s[30:31] offset:1024
 global_load_dword v38, v6, s[30:31] offset:2048
 global_load_dword v39, v6, s[30:31] offset:3072
 global_load_dword v44, v6, s[30:31] offset:512
 global_load_dword v45, v6, s[30:31] offset:1536
 global_load_dword v46, v6, s[30:31] offset:2560
 global_load_dword v47, v6, s[30:31] offset:3584
 v_add_u32 v6, 8192, v6
 global_load_dword v48, v6, s[30:31] offset:0
 global_load_dword v49, v6, s[30:31] offset:1024
 global_load_dword v50, v6, s[30:31] offset:2048
 global_load_dword v51, v6, s[30:31] offset:3072
 global_load_dword v56, v6, s[30:31] offset:512
 global_load_dword v57, v6, s[30:31] offset:1536
 global_load_dword v58, v6, s[30:31] offset:2560
 global_load_dword v59, v6, s[30:31] offset:3584
 v_add_u32 v6, 8192, v6
 global_load_dword v52, v6, s[30:31] offset:0
 global_load_dword v53, v6, s[30:31] offset:1024
 global_load_dword v54, v6, s[30:31] offset:2048
 global_load_dword v55, v6, s[30:31] offset:3072
 global_load_dword v60, v6, s[30:31] offset:512
 global_load_dword v61, v6, s[30:31] offset:1536
 global_load_dword v62, v6, s[30:31] offset:2560
 global_load_dword v63, v6, s[30:31] offset:3584
 v_add_u32 v6, 8192, v6
 global_load_dword v64, v6, s[30:31] offset:0
 global_load_dword v65, v6, s[30:31] offset:1024
 global_load_dword v66, v6, s[30:31] offset:2048
 global_load_dword v67, v6, s[30:31] offset:3072
 global_load_dword v72, v6, s[30:31] offset:512
 global_load_dword v73, v6, s[30:31] offset:1536
 global_load_dword v74, v6, s[30:31] offset:2560
 global_load_dword v75, v6, s[30:31] offset:3584
 v_add_u32 v6, 8192, v6
 global_load_dword v68, v6, s[30:31] offset:0
 global_load_dword v69, v6, s[30:31] offset:1024
 global_load_dword v70, v6, s[30:31] offset:2048
 global_load_dword v71, v6, s[30:31] offset:3072
 global_load_dword v76, v6, s[30:31] offset:512
 global_load_dword v77, v6, s[30:31] offset:1536
 global_load_dword v78, v6, s[30:31] offset:2560
 global_load_dword v79, v6, s[30:31] offset:3584
 v_add_u32 v6, 8192, v6
 global_load_dword v80, v6, s[30:31] offset:0
 global_load_dword v81, v6, s[30:31] offset:1024
 global_load_dword v82, v6, s[30:31] offset:2048
 global_load_dword v83, v6, s[30:31] offset:3072
 global_load_dword v88, v6, s[30:31] offset:512
 global_load_dword v89, v6, s[30:31] offset:1536
 global_load_dword v90, v6, s[30:31] offset:2560
 global_load_dword v91, v6, s[30:31] offset:3584
 v_add_u32 v6, 8192, v6
 global_load_dword v84, v6, s[30:31] offset:0
 global_load_dword v85, v6, s[30:31] offset:1024
 global_load_dword v86, v6, s[30:31] offset:2048
 global_load_dword v87, v6, s[30:31] offset:3072
 global_load_dword v92, v6, s[30:31] offset:512
 global_load_dword v93, v6, s[30:31] offset:1536
 global_load_dword v94, v6, s[30:31] offset:2560
 global_load_dword v95, v6, s[30:31] offset:3584
 s_add_u32 s36, s12, 0
 s_addc_u32 s37, s13, 0
 s_mov_b32 s38, 921600
 s_mov_b32 s39, 0x00020000
 s_add_u32 s40, s14, 0
 s_addc_u32 s41, s15, 0
 s_mov_b32 s42, 921600
 s_mov_b32 s43, 0x00020000
 s_add_u32 s44, s4, 16973824
 s_addc_u32 s45, s5, 0
 s_mov_b32 s46, 2097152
 s_mov_b32 s47, 0x00020000
 s_waitcnt vmcnt(0)
 v_perm_b32 v96, v33, v32, s22
 v_perm_b32 v112, v33, v32, s23
 v_perm_b32 v97, v35, v34, s22
 v_perm_b32 v113, v35, v34, s23
 v_perm_b32 v98, v37, v36, s22
 v_perm_b32 v114, v37, v36, s23
 v_perm_b32 v99, v39, v38, s22
 v_perm_b32 v115, v39, v38, s23
 v_perm_b32 v128, v41, v40, s22
 v_perm_b32 v144, v41, v40, s23
 v_perm_b32 v129, v43, v42, s22
 v_perm_b32 v145, v43, v42, s23
 v_perm_b32 v130, v45, v44, s22
 v_perm_b32 v146, v45, v44, s23
 v_perm_b32 v131, v47, v46, s22
 v_perm_b32 v147, v47, v46, s23
 v_perm_b32 v100, v49, v48, s22
 v_perm_b32 v116, v49, v48, s23
 v_perm_b32 v101, v51, v50, s22
 v_perm_b32 v117, v51, v50, s23
 v_perm_b32 v102, v53, v52, s22
 v_perm_b32 v118, v53, v52, s23
 v_perm_b32 v103, v55, v54, s22
 v_perm_b32 v119, v55, v54, s23
 v_perm_b32 v132, v57, v56, s22
 v_perm_b32 v148, v57, v56, s23
 v_perm_b32 v133, v59, v58, s22
 v_perm_b32 v149, v59, v58, s23
 v_perm_b32 v134, v61, v60, s22
 v_perm_b32 v150, v61, v60, s23
 v_perm_b32 v135, v63, v62, s22
 v_perm_b32 v151, v63, v62, s23
 v_perm_b32 v104, v65, v64, s22
 v_perm_b32 v120, v65, v64, s23
 v_perm_b32 v105, v67, v66, s22
 v_perm_b32 v121, v67, v66, s23
 v_perm_b32 v106, v69, v68, s22
 v_perm_b32 v122, v69, v68, s23
 v_perm_b32 v107, v71, v70, s22
 v_perm_b32 v123, v71, v70, s23
 v_perm_b32 v136, v73, v72, s22
 v_perm_b32 v152, v73, v72, s23
 v_perm_b32 v137, v75, v74, s22
 v_perm_b32 v153, v75, v74, s23
 v_perm_b32 v138, v77, v76, s22
 v_perm_b32 v154, v77, v76, s23
 v_perm_b32 v139, v79, v78, s22
 v_perm_b32 v155, v79, v78, s23
 v_perm_b32 v108, v81, v80, s22
 v_perm_b32 v124, v81, v80, s23
 v_perm_b32 v109, v83, v82, s22
 v_perm_b32 v125, v83, v82, s23
 v_perm_b32 v110, v85, v84, s22
 v_perm_b32 v126, v85, v84, s23
 v_perm_b32 v111, v87, v86, s22
 v_perm_b32 v127, v87, v86, s23
 v_perm_b32 v140, v89, v88, s22
 v_perm_b32 v156, v89, v88, s23
 v_perm_b32 v141, v91, v90, s22
 v_perm_b32 v157, v91, v90, s23
 v_perm_b32 v142, v93, v92, s22
 v_perm_b32 v158, v93, v92, s23
 v_perm_b32 v143, v95, v94, s22
 v_perm_b32 v159, v95, v94, s23
 v_lshrrev_b32 v7, 1, v5
 v_add_u32 v7, 0, v7
 v_cmp_lt_u32 vcc, 224, v7
 v_lshlrev_b32 v7, 1, v7
 v_mul_u32_u24 v9, 57600, v4
 s_mul_i32 s20, s18, 450
 v_add3_u32 v7, v7, v9, s20
 v_mov_b32 v9, 0x40000000
 v_cndmask_b32 v7, v7, v9, vcc
 v_mov_b32 v32, 0
 v_mov_b32 v33, 0
 v_mov_b32 v34, 0
 v_mov_b32 v35, 0
 v_mov_b32 v36, 0
 v_mov_b32 v37, 0
 v_mov_b32 v38, 0
 v_mov_b32 v39, 0
 v_mov_b32 v40, 0
 v_mov_b32 v41, 0
 v_mov_b32 v42, 0
 v_mov_b32 v43, 0
 v_mov_b32 v44, 0
 v_mov_b32 v45, 0
 v_mov_b32 v46, 0
 v_mov_b32 v47, 0
 v_mov_b32 v48, 0
 v_mov_b32 v49, 0
 v_mov_b32 v50, 0
 v_mov_b32 v51, 0
 v_mov_b32 v52, 0
 v_mov_b32 v53, 0
 v_mov_b32 v54, 0
 v_mov_b32 v55, 0
 v_mov_b32 v56, 0
 v_mov_b32 v57, 0
 v_mov_b32 v58, 0
 v_mov_b32 v59, 0
 v_mov_b32 v60, 0
 v_mov_b32 v61, 0
 v_mov_b32 v62, 0
 v_mov_b32 v63, 0
 v_mov_b32 v64, 0
 v_mov_b32 v65, 0
 v_mov_b32 v66, 0
 v_mov_b32 v67, 0
 v_mov_b32 v68, 0
 v_mov_b32 v69, 0
 v_mov_b32 v70, 0
 v_mov_b32 v71, 0
 v_mov_b32 v72, 0
 v_mov_b32 v73, 0
 v_mov_b32 v74, 0
 v_mov_b32 v75, 0
 v_mov_b32 v76, 0
 v_mov_b32 v77, 0
 v_mov_b32 v78, 0
 v_mov_b32 v79, 0
 v_mov_b32 v80, 0
 v_mov_b32 v81, 0
 v_mov_b32 v82, 0
 v_mov_b32 v83, 0
 v_mov_b32 v84, 0
 v_mov_b32 v85, 0
 v_mov_b32 v86, 0
 v_mov_b32 v87, 0
 v_mov_b32 v88, 0
 v_mov_b32 v89, 0
 v_mov_b32 v90, 0
 v_mov_b32 v91, 0
 v_mov_b32 v92, 0
 v_mov_b32 v93, 0
 v_mov_b32 v94, 0
 v_mov_b32 v95, 0
 s_mov_b32 s20, 0
 buffer_load_short_d16_hi v32, v7, s[36:39], s20 offen
 buffer_load_short_d16_hi v64, v7, s[40:43], s20 offen
 s_mov_b32 s20, 14400
 buffer_load_short_d16_hi v33, v7, s[36:39], s20 offen
 buffer_load_short_d16_hi v65, v7, s[40:43], s20 offen
 s_mov_b32 s20, 28800
 buffer_load_short_d16_hi v34, v7, s[36:39], s20 offen
 buffer_load_short_d16_hi v66, v7, s[40:43], s20 offen
 s_mov_b32 s20, 43200
 buffer_load_short_d16_hi v35, v7, s[36:39], s20 offen
 buffer_load_short_d16_hi v67, v7, s[40:43], s20 offen
 s_mov_b32 s20, 115200
 buffer_load_short_d16_hi v36, v7, s[36:39], s20 offen
 buffer_load_short_d16_hi v68, v7, s[40:43], s20 offen
 s_mov_b32 s20, 129600
 buffer_load_short_d16_hi v37, v7, s[36:39], s20 offen
 buffer_load_short_d16_hi v69, v7, s[40:43], s20 offen
 s_mov_b32 s20, 144000
 buffer_load_short_d16_hi v38, v7, s[36:39], s20 offen
 buffer_load_short_d16_hi v70, v7, s[40:43], s20 offen
 s_mov_b32 s20, 158400
 buffer_load_short_d16_hi v39, v7, s[36:39], s20 offen
 buffer_load_short_d16_hi v71, v7, s[40:43], s20 offen
 s_mov_b32 s20, 230400
 buffer_load_short_d16_hi v40, v7, s[36:39], s20 offen
 buffer_load_short_d16_hi v72, v7, s[40:43], s20 offen
 s_mov_b32 s20, 244800
 buffer_load_short_d16_hi v41, v7, s[36:39], s20 offen
 buffer_load_short_d16_hi v73, v7, s[40:43], s20 offen
 s_mov_b32 s20, 259200
 buffer_load_short_d16_hi v42, v7, s[36:39], s20 offen
 buffer_load_short_d16_hi v74, v7, s[40:43], s20 offen
 s_mov_b32 s20, 273600
 buffer_load_short_d16_hi v43, v7, s[36:39], s20 offen
 buffer_load_short_d16_hi v75, v7, s[40:43], s20 offen
 s_mov_b32 s20, 345600
 buffer_load_short_d16_hi v44, v7, s[36:39], s20 offen
 buffer_load_short_d16_hi v76, v7, s[40:43], s20 offen
 s_mov_b32 s20, 360000
 buffer_load_short_d16_hi v45, v7, s[36:39], s20 offen
 buffer_load_short_d16_hi v77, v7, s[40:43], s20 offen
 s_mov_b32 s20, 374400
 buffer_load_short_d16_hi v46, v7, s[36:39], s20 offen
 buffer_load_short_d16_hi v78, v7, s[40:43], s20 offen
 s_mov_b32 s20, 388800
 buffer_load_short_d16_hi v47, v7, s[36:39], s20 offen
 buffer_load_short_d16_hi v79, v7, s[40:43], s20 offen
 s_mov_b32 s20, 460800
 buffer_load_short_d16_hi v48, v7, s[36:39], s20 offen
 buffer_load_short_d16_hi v80, v7, s[40:43], s20 offen
 s_mov_b32 s20, 475200
 buffer_load_short_d16_hi v49, v7, s[36:39], s20 offen
 buffer_load_short_d16_hi v81, v7, s[40:43], s20 offen
 s_mov_b32 s20, 489600
 buffer_load_short_d16_hi v50, v7, s[36:39], s20 offen
 buffer_load_short_d16_hi v82, v7, s[40:43], s20 offen
 s_mov_b32 s20, 504000
 buffer_load_short_d16_hi v51, v7, s[36:39], s20 offen
 buffer_load_short_d16_hi v83, v7, s[40:43], s20 offen
 s_mov_b32 s20, 576000
 buffer_load_short_d16_hi v52, v7, s[36:39], s20 offen
 buffer_load_short_d16_hi v84, v7, s[40:43], s20 offen
 s_mov_b32 s20, 590400
 buffer_load_short_d16_hi v53, v7, s[36:39], s20 offen
 buffer_load_short_d16_hi v85, v7, s[40:43], s20 offen
 s_mov_b32 s20, 604800
 buffer_load_short_d16_hi v54, v7, s[36:39], s20 offen
 buffer_load_short_d16_hi v86, v7, s[40:43], s20 offen
 s_mov_b32 s20, 619200
 buffer_load_short_d16_hi v55, v7, s[36:39], s20 offen
 buffer_load_short_d16_hi v87, v7, s[40:43], s20 offen
 s_mov_b32 s20, 691200
 buffer_load_short_d16_hi v56, v7, s[36:39], s20 offen
 buffer_load_short_d16_hi v88, v7, s[40:43], s20 offen
 s_mov_b32 s20, 705600
 buffer_load_short_d16_hi v57, v7, s[36:39], s20 offen
 buffer_load_short_d16_hi v89, v7, s[40:43], s20 offen
 s_mov_b32 s20, 720000
 buffer_load_short_d16_hi v58, v7, s[36:39], s20 offen
 buffer_load_short_d16_hi v90, v7, s[40:43], s20 offen
 s_mov_b32 s20, 734400
 buffer_load_short_d16_hi v59, v7, s[36:39], s20 offen
 buffer_load_short_d16_hi v91, v7, s[40:43], s20 offen
 s_mov_b32 s20, 806400
 buffer_load_short_d16_hi v60, v7, s[36:39], s20 offen
 buffer_load_short_d16_hi v92, v7, s[40:43], s20 offen
 s_mov_b32 s20, 820800
 buffer_load_short_d16_hi v61, v7, s[36:39], s20 offen
 buffer_load_short_d16_hi v93, v7, s[40:43], s20 offen
 s_mov_b32 s20, 835200
 buffer_load_short_d16_hi v62, v7, s[36:39], s20 offen
 buffer_load_short_d16_hi v94, v7, s[40:43], s20 offen
 s_mov_b32 s20, 849600
 buffer_load_short_d16_hi v63, v7, s[36:39], s20 offen
 buffer_load_short_d16_hi v95, v7, s[40:43], s20 offen
 v_mfma_f32_32x32x16_bf16 v[160:175], a[0:3], v[96:99], 0
 v_mfma_f32_32x32x16_bf16 v[176:191], a[0:3], v[128:131], 0
 v_mfma_f32_32x32x16_bf16 v[192:207], a[16:19], v[96:99], 0
 v_mfma_f32_32x32x16_bf16 v[208:223], a[16:19], v[128:131], 0
 v_mfma_f32_32x32x16_bf16 v[160:175], a[64:67], v[128:131], v[160:175]
 v_mfma_f32_32x32x16_bf16 v[176:191], a[32:35], v[96:99], v[176:191]
 v_mfma_f32_32x32x16_bf16 v[192:207], a[80:83], v[128:131], v[192:207]
 v_mfma_f32_32x32x16_bf16 v[208:223], a[48:51], v[96:99], v[208:223]
 v_mfma_f32_32x32x16_bf16 v[160:175], a[4:7], v[100:103], v[160:175]
 v_mfma_f32_32x32x16_bf16 v[176:191], a[4:7], v[132:135], v[176:191]
 v_mfma_f32_32x32x16_bf16 v[192:207], a[20:23], v[100:103], v[192:207]
 v_mfma_f32_32x32x16_bf16 v[208:223], a[20:23], v[132:135], v[208:223]
 v_mfma_f32_32x32x16_bf16 v[160:175], a[68:71], v[132:135], v[160:175]
 v_mfma_f32_32x32x16_bf16 v[176:191], a[36:39], v[100:103], v[176:191]
 v_mfma_f32_32x32x16_bf16 v[192:207], a[84:87], v[132:135], v[192:207]
 v_mfma_f32_32x32x16_bf16 v[208:223], a[52:55], v[100:103], v[208:223]
 v_mfma_f32_32x32x16_bf16 v[160:175], a[8:11], v[104:107], v[160:175]
 v_mfma_f32_32x32x16_bf16 v[176:191], a[8:11], v[136:139], v[176:191]
 v_mfma_f32_32x32x16_bf16 v[192:207], a[24:27], v[104:107], v[192:207]
 v_mfma_f32_32x32x16_bf16 v[208:223], a[24:27], v[136:139], v[208:223]
 v_mfma_f32_32x32x16_bf16 v[160:175], a[72:75], v[136:139], v[160:175]
 v_mfma_f32_32x32x16_bf16 v[176:191], a[40:43], v[104:107], v[176:191]
 v_mfma_f32_32x32x16_bf16 v[192:207], a[88:91], v[136:139], v[192:207]
 v_mfma_f32_32x32x16_bf16 v[208:223], a[56:59], v[104:107], v[208:223]
 v_mfma_f32_32x32x16_bf16 v[160:175], a[12:15], v[108:111], v[160:175]
 v_mfma_f32_32x32x16_bf16 v[176:191], a[12:15], v[140:143], v[176:191]
 v_mfma_f32_32x32x16_bf16 v[192:207], a[28:31], v[108:111], v[192:207]
 v_mfma_f32_32x32x16_bf16 v[208:223], a[28:31], v[140:143], v[208:223]
 v_mfma_f32_32x32x16_bf16 v[160:175], a[76:79], v[140:143], v[160:175]
 v_mfma_f32_32x32x16_bf16 v[176:191], a[44:47], v[108:111], v[176:191]
 v_mfma_f32_32x32x16_bf16 v[192:207], a[92:95], v[140:143], v[192:207]
 v_mfma_f32_32x32x16_bf16 v[208:223], a[60:63], v[108:111], v[208:223]
 s_waitcnt vmcnt(0)
 v_mul_f32 v16, v160, v32
 v_mul_f32 v18, v160, v64
 s_nop 0
 v_fma_f32 v16, v176, v64, v16
 v_fma_f32 v18, -v176, v32, v18
 v_mul_f32 v17, v161, v33
 v_mul_f32 v19, v161, v65
 v_fma_f32 v17, v177, v65, v17
 v_fma_f32 v19, -v177, v33, v19
 v_cvt_pk_bf16_f32 v224, v16, v17
 v_cvt_pk_bf16_f32 v240, v18, v19
 v_mul_f32 v16, v162, v34
 v_mul_f32 v18, v162, v66
 v_fma_f32 v16, v178, v66, v16
 v_fma_f32 v18, -v178, v34, v18
 v_mul_f32 v17, v163, v35
 v_mul_f32 v19, v163, v67
 v_fma_f32 v17, v179, v67, v17
 v_fma_f32 v19, -v179, v35, v19
 v_cvt_pk_bf16_f32 v225, v16, v17
 v_cvt_pk_bf16_f32 v241, v18, v19
 v_mul_f32 v16, v164, v36
 v_mul_f32 v18, v164, v68
 v_fma_f32 v16, v180, v68, v16
 v_fma_f32 v18, -v180, v36, v18
 v_mul_f32 v17, v165, v37
 v_mul_f32 v19, v165, v69
 v_fma_f32 v17, v181, v69, v17
 v_fma_f32 v19, -v181, v37, v19
 v_cvt_pk_bf16_f32 v226, v16, v17
 v_cvt_pk_bf16_f32 v242, v18, v19
 v_mul_f32 v16, v166, v38
 v_mul_f32 v18, v166, v70
 v_fma_f32 v16, v182, v70, v16
 v_fma_f32 v18, -v182, v38, v18
 v_mul_f32 v17, v167, v39
 v_mul_f32 v19, v167, v71
 v_fma_f32 v17, v183, v71, v17
 v_fma_f32 v19, -v183, v39, v19
 v_cvt_pk_bf16_f32 v227, v16, v17
 v_cvt_pk_bf16_f32 v243, v18, v19
 v_mul_f32 v16, v168, v40
 v_mul_f32 v18, v168, v72
 v_fma_f32 v16, v184, v72, v16
 v_fma_f32 v18, -v184, v40, v18
 v_mul_f32 v17, v169, v41
 v_mul_f32 v19, v169, v73
 v_fma_f32 v17, v185, v73, v17
 v_fma_f32 v19, -v185, v41, v19
 v_cvt_pk_bf16_f32 v228, v16, v17
 v_cvt_pk_bf16_f32 v244, v18, v19
 v_mul_f32 v16, v170, v42
 v_mul_f32 v18, v170, v74
 v_fma_f32 v16, v186, v74, v16
 v_fma_f32 v18, -v186, v42, v18
 v_mul_f32 v17, v171, v43
 v_mul_f32 v19, v171, v75
 v_fma_f32 v17, v187, v75, v17
 v_fma_f32 v19, -v187, v43, v19
 v_cvt_pk_bf16_f32 v229, v16, v17
 v_cvt_pk_bf16_f32 v245, v18, v19
 v_mul_f32 v16, v172, v44
 v_mul_f32 v18, v172, v76
 v_fma_f32 v16, v188, v76, v16
 v_fma_f32 v18, -v188, v44, v18
 v_mul_f32 v17, v173, v45
 v_mul_f32 v19, v173, v77
 v_fma_f32 v17, v189, v77, v17
 v_fma_f32 v19, -v189, v45, v19
 v_cvt_pk_bf16_f32 v230, v16, v17
 v_cvt_pk_bf16_f32 v246, v18, v19
 v_mul_f32 v16, v174, v46
 v_mul_f32 v18, v174, v78
 v_fma_f32 v16, v190, v78, v16
 v_fma_f32 v18, -v190, v46, v18
 v_mul_f32 v17, v175, v47
 v_mul_f32 v19, v175, v79
 v_fma_f32 v17, v191, v79, v17
 v_fma_f32 v19, -v191, v47, v19
 v_cvt_pk_bf16_f32 v231, v16, v17
 v_cvt_pk_bf16_f32 v247, v18, v19
 v_mul_f32 v16, v192, v48
 v_mul_f32 v18, v192, v80
 v_fma_f32 v16, v208, v80, v16
 v_fma_f32 v18, -v208, v48, v18
 v_mul_f32 v17, v193, v49
 v_mul_f32 v19, v193, v81
 v_fma_f32 v17, v209, v81, v17
 v_fma_f32 v19, -v209, v49, v19
 v_cvt_pk_bf16_f32 v232, v16, v17
 v_cvt_pk_bf16_f32 v248, v18, v19
 v_mul_f32 v16, v194, v50
 v_mul_f32 v18, v194, v82
 v_fma_f32 v16, v210, v82, v16
 v_fma_f32 v18, -v210, v50, v18
 v_mul_f32 v17, v195, v51
 v_mul_f32 v19, v195, v83
 v_fma_f32 v17, v211, v83, v17
 v_fma_f32 v19, -v211, v51, v19
 v_cvt_pk_bf16_f32 v233, v16, v17
 v_cvt_pk_bf16_f32 v249, v18, v19
 v_mul_f32 v16, v196, v52
 v_mul_f32 v18, v196, v84
 v_fma_f32 v16, v212, v84, v16
 v_fma_f32 v18, -v212, v52, v18
 v_mul_f32 v17, v197, v53
 v_mul_f32 v19, v197, v85
 v_fma_f32 v17, v213, v85, v17
 v_fma_f32 v19, -v213, v53, v19
 v_cvt_pk_bf16_f32 v234, v16, v17
 v_cvt_pk_bf16_f32 v250, v18, v19
 v_mul_f32 v16, v198, v54
 v_mul_f32 v18, v198, v86
 v_fma_f32 v16, v214, v86, v16
 v_fma_f32 v18, -v214, v54, v18
 v_mul_f32 v17, v199, v55
 v_mul_f32 v19, v199, v87
 v_fma_f32 v17, v215, v87, v17
 v_fma_f32 v19, -v215, v55, v19
 v_cvt_pk_bf16_f32 v235, v16, v17
 v_cvt_pk_bf16_f32 v251, v18, v19
 v_mul_f32 v16, v200, v56
 v_mul_f32 v18, v200, v88
 v_fma_f32 v16, v216, v88, v16
 v_fma_f32 v18, -v216, v56, v18
 v_mul_f32 v17, v201, v57
 v_mul_f32 v19, v201, v89
 v_fma_f32 v17, v217, v89, v17
 v_fma_f32 v19, -v217, v57, v19
 v_cvt_pk_bf16_f32 v236, v16, v17
 v_cvt_pk_bf16_f32 v252, v18, v19
 v_mul_f32 v16, v202, v58
 v_mul_f32 v18, v202, v90
 v_fma_f32 v16, v218, v90, v16
 v_fma_f32 v18, -v218, v58, v18
 v_mul_f32 v17, v203, v59
 v_mul_f32 v19, v203, v91
 v_fma_f32 v17, v219, v91, v17
 v_fma_f32 v19, -v219, v59, v19
 v_cvt_pk_bf16_f32 v237, v16, v17
 v_cvt_pk_bf16_f32 v253, v18, v19
 v_mul_f32 v16, v204, v60
 v_mul_f32 v18, v204, v92
 v_fma_f32 v16, v220, v92, v16
 v_fma_f32 v18, -v220, v60, v18
 v_mul_f32 v17, v205, v61
 v_mul_f32 v19, v205, v93
 v_fma_f32 v17, v221, v93, v17
 v_fma_f32 v19, -v221, v61, v19
 v_cvt_pk_bf16_f32 v238, v16, v17
 v_cvt_pk_bf16_f32 v254, v18, v19
 v_mul_f32 v16, v206, v62
 v_mul_f32 v18, v206, v94
 v_fma_f32 v16, v222, v94, v16
 v_fma_f32 v18, -v222, v62, v18
 v_mul_f32 v17, v207, v63
 v_mul_f32 v19, v207, v95
 v_fma_f32 v17, v223, v95, v17
 v_fma_f32 v19, -v223, v63, v19
 v_cvt_pk_bf16_f32 v239, v16, v17
 v_cvt_pk_bf16_f32 v255, v18, v19
 v_mfma_f32_32x32x16_bf16 a[96:111], a[0:3], v[224:227], 0
 v_mfma_f32_32x32x16_bf16 a[112:127], a[0:3], v[240:243], 0
 v_mfma_f32_32x32x16_bf16 a[128:143], a[16:19], v[224:227], 0
 v_mfma_f32_32x32x16_bf16 a[144:159], a[16:19], v[240:243], 0
 v_mfma_f32_32x32x16_bf16 a[96:111], a[64:67], v[240:243], a[96:111]
 v_mfma_f32_32x32x16_bf16 a[112:127], a[32:35], v[224:227], a[112:127]
 v_mfma_f32_32x32x16_bf16 a[128:143], a[80:83], v[240:243], a[128:143]
 v_mfma_f32_32x32x16_bf16 a[144:159], a[48:51], v[224:227], a[144:159]
 v_mfma_f32_32x32x16_bf16 a[96:111], a[4:7], v[228:231], a[96:111]
 v_mfma_f32_32x32x16_bf16 a[112:127], a[4:7], v[244:247], a[112:127]
 v_mfma_f32_32x32x16_bf16 a[128:143], a[20:23], v[228:231], a[128:143]
 v_mfma_f32_32x32x16_bf16 a[144:159], a[20:23], v[244:247], a[144:159]
 v_mfma_f32_32x32x16_bf16 a[96:111], a[68:71], v[244:247], a[96:111]
 v_mfma_f32_32x32x16_bf16 a[112:127], a[36:39], v[228:231], a[112:127]
 v_mfma_f32_32x32x16_bf16 a[128:143], a[84:87], v[244:247], a[128:143]
 v_mfma_f32_32x32x16_bf16 a[144:159], a[52:55], v[228:231], a[144:159]
 v_mfma_f32_32x32x16_bf16 a[96:111], a[8:11], v[232:235], a[96:111]
 v_mfma_f32_32x32x16_bf16 a[112:127], a[8:11], v[248:251], a[112:127]
 v_mfma_f32_32x32x16_bf16 a[128:143], a[24:27], v[232:235], a[128:143]
 v_mfma_f32_32x32x16_bf16 a[144:159], a[24:27], v[248:251], a[144:159]
 v_mfma_f32_32x32x16_bf16 a[96:111], a[72:75], v[248:251], a[96:111]
 v_mfma_f32_32x32x16_bf16 a[112:127], a[40:43], v[232:235], a[112:127]
 v_mfma_f32_32x32x16_bf16 a[128:143], a[88:91], v[248:251], a[128:143]
 v_mfma_f32_32x32x16_bf16 a[144:159], a[56:59], v[232:235], a[144:159]
 v_mfma_f32_32x32x16_bf16 a[96:111], a[12:15], v[236:239], a[96:111]
 v_mfma_f32_32x32x16_bf16 a[112:127], a[12:15], v[252:255], a[112:127]
 v_mfma_f32_32x32x16_bf16 a[128:143], a[28:31], v[236:239], a[128:143]
 v_mfma_f32_32x32x16_bf16 a[144:159], a[28:31], v[252:255], a[144:159]
 v_mfma_f32_32x32x16_bf16 a[96:111], a[76:79], v[252:255], a[96:111]
 v_mfma_f32_32x32x16_bf16 a[112:127], a[44:47], v[236:239], a[112:127]
 v_mfma_f32_32x32x16_bf16 a[128:143], a[92:95], v[252:255], a[128:143]
 v_mfma_f32_32x32x16_bf16 a[144:159], a[60:63], v[236:239], a[144:159]
 v_lshrrev_b32 v7, 1, v5
 v_add_u32 v7, 1, v7
 v_cmp_lt_u32 vcc, 224, v7
 v_lshlrev_b32 v7, 1, v7
 v_mul_u32_u24 v9, 57600, v4
 s_mul_i32 s20, s18, 450
 v_add3_u32 v7, v7, v9, s20
 v_mov_b32 v9, 0x40000000
 v_cndmask_b32 v7, v7, v9, vcc
 v_mov_b32 v32, 0
 v_mov_b32 v33, 0
 v_mov_b32 v34, 0
 v_mov_b32 v35, 0
 v_mov_b32 v36, 0
 v_mov_b32 v37, 0
 v_mov_b32 v38, 0
 v_mov_b32 v39, 0
 v_mov_b32 v40, 0
 v_mov_b32 v41, 0
 v_mov_b32 v42, 0
 v_mov_b32 v43, 0
 v_mov_b32 v44, 0
 v_mov_b32 v45, 0
 v_mov_b32 v46, 0
 v_mov_b32 v47, 0
 v_mov_b32 v48, 0
 v_mov_b32 v49, 0
 v_mov_b32 v50, 0
 v_mov_b32 v51, 0
 v_mov_b32 v52, 0
 v_mov_b32 v53, 0
 v_mov_b32 v54, 0
 v_mov_b32 v55, 0
 v_mov_b32 v56, 0
 v_mov_b32 v57, 0
 v_mov_b32 v58, 0
 v_mov_b32 v59, 0
 v_mov_b32 v60, 0
 v_mov_b32 v61, 0
 v_mov_b32 v62, 0
 v_mov_b32 v63, 0
 v_mov_b32 v64, 0
 v_mov_b32 v65, 0
 v_mov_b32 v66, 0
 v_mov_b32 v67, 0
 v_mov_b32 v68, 0
 v_mov_b32 v69, 0
 v_mov_b32 v70, 0
 v_mov_b32 v71, 0
 v_mov_b32 v72, 0
 v_mov_b32 v73, 0
 v_mov_b32 v74, 0
 v_mov_b32 v75, 0
 v_mov_b32 v76, 0
 v_mov_b32 v77, 0
 v_mov_b32 v78, 0
 v_mov_b32 v79, 0
 v_mov_b32 v80, 0
 v_mov_b32 v81, 0
 v_mov_b32 v82, 0
 v_mov_b32 v83, 0
 v_mov_b32 v84, 0
 v_mov_b32 v85, 0
 v_mov_b32 v86, 0
 v_mov_b32 v87, 0
 v_mov_b32 v88, 0
 v_mov_b32 v89, 0
 v_mov_b32 v90, 0
 v_mov_b32 v91, 0
 v_mov_b32 v92, 0
 v_mov_b32 v93, 0
 v_mov_b32 v94, 0
 v_mov_b32 v95, 0
 s_mov_b32 s20, 0
 buffer_load_short_d16_hi v32, v7, s[36:39], s20 offen
 buffer_load_short_d16_hi v64, v7, s[40:43], s20 offen
 s_mov_b32 s20, 14400
 buffer_load_short_d16_hi v33, v7, s[36:39], s20 offen
 buffer_load_short_d16_hi v65, v7, s[40:43], s20 offen
 s_mov_b32 s20, 28800
 buffer_load_short_d16_hi v34, v7, s[36:39], s20 offen
 buffer_load_short_d16_hi v66, v7, s[40:43], s20 offen
 s_mov_b32 s20, 43200
 buffer_load_short_d16_hi v35, v7, s[36:39], s20 offen
 buffer_load_short_d16_hi v67, v7, s[40:43], s20 offen
 s_mov_b32 s20, 115200
 buffer_load_short_d16_hi v36, v7, s[36:39], s20 offen
 buffer_load_short_d16_hi v68, v7, s[40:43], s20 offen
 s_mov_b32 s20, 129600
 buffer_load_short_d16_hi v37, v7, s[36:39], s20 offen
 buffer_load_short_d16_hi v69, v7, s[40:43], s20 offen
 s_mov_b32 s20, 144000
 buffer_load_short_d16_hi v38, v7, s[36:39], s20 offen
 buffer_load_short_d16_hi v70, v7, s[40:43], s20 offen
 s_mov_b32 s20, 158400
 buffer_load_short_d16_hi v39, v7, s[36:39], s20 offen
 buffer_load_short_d16_hi v71, v7, s[40:43], s20 offen
 s_mov_b32 s20, 230400
 buffer_load_short_d16_hi v40, v7, s[36:39], s20 offen
 buffer_load_short_d16_hi v72, v7, s[40:43], s20 offen
 s_mov_b32 s20, 244800
 buffer_load_short_d16_hi v41, v7, s[36:39], s20 offen
 buffer_load_short_d16_hi v73, v7, s[40:43], s20 offen
 s_mov_b32 s20, 259200
 buffer_load_short_d16_hi v42, v7, s[36:39], s20 offen
 buffer_load_short_d16_hi v74, v7, s[40:43], s20 offen
 s_mov_b32 s20, 273600
 buffer_load_short_d16_hi v43, v7, s[36:39], s20 offen
 buffer_load_short_d16_hi v75, v7, s[40:43], s20 offen
 s_mov_b32 s20, 345600
 buffer_load_short_d16_hi v44, v7, s[36:39], s20 offen
 buffer_load_short_d16_hi v76, v7, s[40:43], s20 offen
 s_mov_b32 s20, 360000
 buffer_load_short_d16_hi v45, v7, s[36:39], s20 offen
 buffer_load_short_d16_hi v77, v7, s[40:43], s20 offen
 s_mov_b32 s20, 374400
 buffer_load_short_d16_hi v46, v7, s[36:39], s20 offen
 buffer_load_short_d16_hi v78, v7, s[40:43], s20 offen
 s_mov_b32 s20, 388800
 buffer_load_short_d16_hi v47, v7, s[36:39], s20 offen
 buffer_load_short_d16_hi v79, v7, s[40:43], s20 offen
 s_mov_b32 s20, 460800
 buffer_load_short_d16_hi v48, v7, s[36:39], s20 offen
 buffer_load_short_d16_hi v80, v7, s[40:43], s20 offen
 s_mov_b32 s20, 475200
 buffer_load_short_d16_hi v49, v7, s[36:39], s20 offen
 buffer_load_short_d16_hi v81, v7, s[40:43], s20 offen
 s_mov_b32 s20, 489600
 buffer_load_short_d16_hi v50, v7, s[36:39], s20 offen
 buffer_load_short_d16_hi v82, v7, s[40:43], s20 offen
 s_mov_b32 s20, 504000
 buffer_load_short_d16_hi v51, v7, s[36:39], s20 offen
 buffer_load_short_d16_hi v83, v7, s[40:43], s20 offen
 s_mov_b32 s20, 576000
 buffer_load_short_d16_hi v52, v7, s[36:39], s20 offen
 buffer_load_short_d16_hi v84, v7, s[40:43], s20 offen
 s_mov_b32 s20, 590400
 buffer_load_short_d16_hi v53, v7, s[36:39], s20 offen
 buffer_load_short_d16_hi v85, v7, s[40:43], s20 offen
 s_mov_b32 s20, 604800
 buffer_load_short_d16_hi v54, v7, s[36:39], s20 offen
 buffer_load_short_d16_hi v86, v7, s[40:43], s20 offen
 s_mov_b32 s20, 619200
 buffer_load_short_d16_hi v55, v7, s[36:39], s20 offen
 buffer_load_short_d16_hi v87, v7, s[40:43], s20 offen
 s_mov_b32 s20, 691200
 buffer_load_short_d16_hi v56, v7, s[36:39], s20 offen
 buffer_load_short_d16_hi v88, v7, s[40:43], s20 offen
 s_mov_b32 s20, 705600
 buffer_load_short_d16_hi v57, v7, s[36:39], s20 offen
 buffer_load_short_d16_hi v89, v7, s[40:43], s20 offen
 s_mov_b32 s20, 720000
 buffer_load_short_d16_hi v58, v7, s[36:39], s20 offen
 buffer_load_short_d16_hi v90, v7, s[40:43], s20 offen
 s_mov_b32 s20, 734400
 buffer_load_short_d16_hi v59, v7, s[36:39], s20 offen
 buffer_load_short_d16_hi v91, v7, s[40:43], s20 offen
 s_mov_b32 s20, 806400
 buffer_load_short_d16_hi v60, v7, s[36:39], s20 offen
 buffer_load_short_d16_hi v92, v7, s[40:43], s20 offen
 s_mov_b32 s20, 820800
 buffer_load_short_d16_hi v61, v7, s[36:39], s20 offen
 buffer_load_short_d16_hi v93, v7, s[40:43], s20 offen
 s_mov_b32 s20, 835200
 buffer_load_short_d16_hi v62, v7, s[36:39], s20 offen
 buffer_load_short_d16_hi v94, v7, s[40:43], s20 offen
 s_mov_b32 s20, 849600
 buffer_load_short_d16_hi v63, v7, s[36:39], s20 offen
 buffer_load_short_d16_hi v95, v7, s[40:43], s20 offen
 v_mfma_f32_32x32x16_bf16 v[160:175], a[0:3], v[112:115], 0
 v_mfma_f32_32x32x16_bf16 v[176:191], a[0:3], v[144:147], 0
 v_mfma_f32_32x32x16_bf16 v[192:207], a[16:19], v[112:115], 0
 v_mfma_f32_32x32x16_bf16 v[208:223], a[16:19], v[144:147], 0
 v_mfma_f32_32x32x16_bf16 v[160:175], a[64:67], v[144:147], v[160:175]
 v_mfma_f32_32x32x16_bf16 v[176:191], a[32:35], v[112:115], v[176:191]
 v_mfma_f32_32x32x16_bf16 v[192:207], a[80:83], v[144:147], v[192:207]
 v_mfma_f32_32x32x16_bf16 v[208:223], a[48:51], v[112:115], v[208:223]
 v_mfma_f32_32x32x16_bf16 v[160:175], a[4:7], v[116:119], v[160:175]
 v_mfma_f32_32x32x16_bf16 v[176:191], a[4:7], v[148:151], v[176:191]
 v_mfma_f32_32x32x16_bf16 v[192:207], a[20:23], v[116:119], v[192:207]
 v_mfma_f32_32x32x16_bf16 v[208:223], a[20:23], v[148:151], v[208:223]
 v_mfma_f32_32x32x16_bf16 v[160:175], a[68:71], v[148:151], v[160:175]
 v_mfma_f32_32x32x16_bf16 v[176:191], a[36:39], v[116:119], v[176:191]
 v_mfma_f32_32x32x16_bf16 v[192:207], a[84:87], v[148:151], v[192:207]
 v_mfma_f32_32x32x16_bf16 v[208:223], a[52:55], v[116:119], v[208:223]
 v_mfma_f32_32x32x16_bf16 v[160:175], a[8:11], v[120:123], v[160:175]
 v_mfma_f32_32x32x16_bf16 v[176:191], a[8:11], v[152:155], v[176:191]
 v_mfma_f32_32x32x16_bf16 v[192:207], a[24:27], v[120:123], v[192:207]
 v_mfma_f32_32x32x16_bf16 v[208:223], a[24:27], v[152:155], v[208:223]
 v_mfma_f32_32x32x16_bf16 v[160:175], a[72:75], v[152:155], v[160:175]
 v_mfma_f32_32x32x16_bf16 v[176:191], a[40:43], v[120:123], v[176:191]
 v_mfma_f32_32x32x16_bf16 v[192:207], a[88:91], v[152:155], v[192:207]
 v_mfma_f32_32x32x16_bf16 v[208:223], a[56:59], v[120:123], v[208:223]
 v_mfma_f32_32x32x16_bf16 v[160:175], a[12:15], v[124:127], v[160:175]
 v_mfma_f32_32x32x16_bf16 v[176:191], a[12:15], v[156:159], v[176:191]
 v_mfma_f32_32x32x16_bf16 v[192:207], a[28:31], v[124:127], v[192:207]
 v_mfma_f32_32x32x16_bf16 v[208:223], a[28:31], v[156:159], v[208:223]
 v_mfma_f32_32x32x16_bf16 v[160:175], a[76:79], v[156:159], v[160:175]
 v_mfma_f32_32x32x16_bf16 v[176:191], a[44:47], v[124:127], v[176:191]
 v_mfma_f32_32x32x16_bf16 v[192:207], a[92:95], v[156:159], v[192:207]
 v_mfma_f32_32x32x16_bf16 v[208:223], a[60:63], v[124:127], v[208:223]
 s_waitcnt vmcnt(0)
 v_mul_f32 v16, v160, v32
 v_mul_f32 v18, v160, v64
 s_nop 0
 v_fma_f32 v16, v176, v64, v16
 v_fma_f32 v18, -v176, v32, v18
 v_mul_f32 v17, v161, v33
 v_mul_f32 v19, v161, v65
 v_fma_f32 v17, v177, v65, v17
 v_fma_f32 v19, -v177, v33, v19
 v_cvt_pk_bf16_f32 v224, v16, v17
 v_cvt_pk_bf16_f32 v240, v18, v19
 v_mul_f32 v16, v162, v34
 v_mul_f32 v18, v162, v66
 v_fma_f32 v16, v178, v66, v16
 v_fma_f32 v18, -v178, v34, v18
 v_mul_f32 v17, v163, v35
 v_mul_f32 v19, v163, v67
 v_fma_f32 v17, v179, v67, v17
 v_fma_f32 v19, -v179, v35, v19
 v_cvt_pk_bf16_f32 v225, v16, v17
 v_cvt_pk_bf16_f32 v241, v18, v19
 v_mul_f32 v16, v164, v36
 v_mul_f32 v18, v164, v68
 v_fma_f32 v16, v180, v68, v16
 v_fma_f32 v18, -v180, v36, v18
 v_mul_f32 v17, v165, v37
 v_mul_f32 v19, v165, v69
 v_fma_f32 v17, v181, v69, v17
 v_fma_f32 v19, -v181, v37, v19
 v_cvt_pk_bf16_f32 v226, v16, v17
 v_cvt_pk_bf16_f32 v242, v18, v19
 v_mul_f32 v16, v166, v38
 v_mul_f32 v18, v166, v70
 v_fma_f32 v16, v182, v70, v16
 v_fma_f32 v18, -v182, v38, v18
 v_mul_f32 v17, v167, v39
 v_mul_f32 v19, v167, v71
 v_fma_f32 v17, v183, v71, v17
 v_fma_f32 v19, -v183, v39, v19
 v_cvt_pk_bf16_f32 v227, v16, v17
 v_cvt_pk_bf16_f32 v243, v18, v19
 v_mul_f32 v16, v168, v40
 v_mul_f32 v18, v168, v72
 v_fma_f32 v16, v184, v72, v16
 v_fma_f32 v18, -v184, v40, v18
 v_mul_f32 v17, v169, v41
 v_mul_f32 v19, v169, v73
 v_fma_f32 v17, v185, v73, v17
 v_fma_f32 v19, -v185, v41, v19
 v_cvt_pk_bf16_f32 v228, v16, v17
 v_cvt_pk_bf16_f32 v244, v18, v19
 v_mul_f32 v16, v170, v42
 v_mul_f32 v18, v170, v74
 v_fma_f32 v16, v186, v74, v16
 v_fma_f32 v18, -v186, v42, v18
 v_mul_f32 v17, v171, v43
 v_mul_f32 v19, v171, v75
 v_fma_f32 v17, v187, v75, v17
 v_fma_f32 v19, -v187, v43, v19
 v_cvt_pk_bf16_f32 v229, v16, v17
 v_cvt_pk_bf16_f32 v245, v18, v19
 v_mul_f32 v16, v172, v44
 v_mul_f32 v18, v172, v76
 v_fma_f32 v16, v188, v76, v16
 v_fma_f32 v18, -v188, v44, v18
 v_mul_f32 v17, v173, v45
 v_mul_f32 v19, v173, v77
 v_fma_f32 v17, v189, v77, v17
 v_fma_f32 v19, -v189, v45, v19
 v_cvt_pk_bf16_f32 v230, v16, v17
 v_cvt_pk_bf16_f32 v246, v18, v19
 v_mul_f32 v16, v174, v46
 v_mul_f32 v18, v174, v78
 v_fma_f32 v16, v190, v78, v16
 v_fma_f32 v18, -v190, v46, v18
 v_mul_f32 v17, v175, v47
 v_mul_f32 v19, v175, v79
 v_fma_f32 v17, v191, v79, v17
 v_fma_f32 v19, -v191, v47, v19
 v_cvt_pk_bf16_f32 v231, v16, v17
 v_cvt_pk_bf16_f32 v247, v18, v19
 v_mul_f32 v16, v192, v48
 v_mul_f32 v18, v192, v80
 v_fma_f32 v16, v208, v80, v16
 v_fma_f32 v18, -v208, v48, v18
 v_mul_f32 v17, v193, v49
 v_mul_f32 v19, v193, v81
 v_fma_f32 v17, v209, v81, v17
 v_fma_f32 v19, -v209, v49, v19
 v_cvt_pk_bf16_f32 v232, v16, v17
 v_cvt_pk_bf16_f32 v248, v18, v19
 v_mul_f32 v16, v194, v50
 v_mul_f32 v18, v194, v82
 v_fma_f32 v16, v210, v82, v16
 v_fma_f32 v18, -v210, v50, v18
 v_mul_f32 v17, v195, v51
 v_mul_f32 v19, v195, v83
 v_fma_f32 v17, v211, v83, v17
 v_fma_f32 v19, -v211, v51, v19
 v_cvt_pk_bf16_f32 v233, v16, v17
 v_cvt_pk_bf16_f32 v249, v18, v19
 v_mul_f32 v16, v196, v52
 v_mul_f32 v18, v196, v84
 v_fma_f32 v16, v212, v84, v16
 v_fma_f32 v18, -v212, v52, v18
 v_mul_f32 v17, v197, v53
 v_mul_f32 v19, v197, v85
 v_fma_f32 v17, v213, v85, v17
 v_fma_f32 v19, -v213, v53, v19
 v_cvt_pk_bf16_f32 v234, v16, v17
 v_cvt_pk_bf16_f32 v250, v18, v19
 v_mul_f32 v16, v198, v54
 v_mul_f32 v18, v198, v86
 v_fma_f32 v16, v214, v86, v16
 v_fma_f32 v18, -v214, v54, v18
 v_mul_f32 v17, v199, v55
 v_mul_f32 v19, v199, v87
 v_fma_f32 v17, v215, v87, v17
 v_fma_f32 v19, -v215, v55, v19
 v_cvt_pk_bf16_f32 v235, v16, v17
 v_cvt_pk_bf16_f32 v251, v18, v19
 v_mul_f32 v16, v200, v56
 v_mul_f32 v18, v200, v88
 v_fma_f32 v16, v216, v88, v16
 v_fma_f32 v18, -v216, v56, v18
 v_mul_f32 v17, v201, v57
 v_mul_f32 v19, v201, v89
 v_fma_f32 v17, v217, v89, v17
 v_fma_f32 v19, -v217, v57, v19
 v_cvt_pk_bf16_f32 v236, v16, v17
 v_cvt_pk_bf16_f32 v252, v18, v19
 v_mul_f32 v16, v202, v58
 v_mul_f32 v18, v202, v90
 v_fma_f32 v16, v218, v90, v16
 v_fma_f32 v18, -v218, v58, v18
 v_mul_f32 v17, v203, v59
 v_mul_f32 v19, v203, v91
 v_fma_f32 v17, v219, v91, v17
 v_fma_f32 v19, -v219, v59, v19
 v_cvt_pk_bf16_f32 v237, v16, v17
 v_cvt_pk_bf16_f32 v253, v18, v19
 v_mul_f32 v16, v204, v60
 v_mul_f32 v18, v204, v92
 v_fma_f32 v16, v220, v92, v16
 v_fma_f32 v18, -v220, v60, v18
 v_mul_f32 v17, v205, v61
 v_mul_f32 v19, v205, v93
 v_fma_f32 v17, v221, v93, v17
 v_fma_f32 v19, -v221, v61, v19
 v_cvt_pk_bf16_f32 v238, v16, v17
 v_cvt_pk_bf16_f32 v254, v18, v19
 v_mul_f32 v16, v206, v62
 v_mul_f32 v18, v206, v94
 v_fma_f32 v16, v222, v94, v16
 v_fma_f32 v18, -v222, v62, v18
 v_mul_f32 v17, v207, v63
 v_mul_f32 v19, v207, v95
 v_fma_f32 v17, v223, v95, v17
 v_fma_f32 v19, -v223, v63, v19
 v_cvt_pk_bf16_f32 v239, v16, v17
 v_cvt_pk_bf16_f32 v255, v18, v19
 v_mfma_f32_32x32x16_bf16 a[160:175], a[0:3], v[224:227], 0
 v_mfma_f32_32x32x16_bf16 a[176:191], a[0:3], v[240:243], 0
 v_mfma_f32_32x32x16_bf16 a[192:207], a[16:19], v[224:227], 0
 v_mfma_f32_32x32x16_bf16 a[208:223], a[16:19], v[240:243], 0
 v_mfma_f32_32x32x16_bf16 a[160:175], a[64:67], v[240:243], a[160:175]
 v_mfma_f32_32x32x16_bf16 a[176:191], a[32:35], v[224:227], a[176:191]
 v_mfma_f32_32x32x16_bf16 a[192:207], a[80:83], v[240:243], a[192:207]
 v_mfma_f32_32x32x16_bf16 a[208:223], a[48:51], v[224:227], a[208:223]
 v_mfma_f32_32x32x16_bf16 a[160:175], a[4:7], v[228:231], a[160:175]
 v_mfma_f32_32x32x16_bf16 a[176:191], a[4:7], v[244:247], a[176:191]
 v_mfma_f32_32x32x16_bf16 a[192:207], a[20:23], v[228:231], a[192:207]
 v_mfma_f32_32x32x16_bf16 a[208:223], a[20:23], v[244:247], a[208:223]
 v_mfma_f32_32x32x16_bf16 a[160:175], a[68:71], v[244:247], a[160:175]
 v_mfma_f32_32x32x16_bf16 a[176:191], a[36:39], v[228:231], a[176:191]
 v_mfma_f32_32x32x16_bf16 a[192:207], a[84:87], v[244:247], a[192:207]
 v_mfma_f32_32x32x16_bf16 a[208:223], a[52:55], v[228:231], a[208:223]
 v_mfma_f32_32x32x16_bf16 a[160:175], a[8:11], v[232:235], a[160:175]
 v_mfma_f32_32x32x16_bf16 a[176:191], a[8:11], v[248:251], a[176:191]
 v_mfma_f32_32x32x16_bf16 a[192:207], a[24:27], v[232:235], a[192:207]
 v_mfma_f32_32x32x16_bf16 a[208:223], a[24:27], v[248:251], a[208:223]
 v_mfma_f32_32x32x16_bf16 a[160:175], a[72:75], v[248:251], a[160:175]
 v_mfma_f32_32x32x16_bf16 a[176:191], a[40:43], v[232:235], a[176:191]
 v_mfma_f32_32x32x16_bf16 a[192:207], a[88:91], v[248:251], a[192:207]
 v_mfma_f32_32x32x16_bf16 a[208:223], a[56:59], v[232:235], a[208:223]
 v_mfma_f32_32x32x16_bf16 a[160:175], a[12:15], v[236:239], a[160:175]
 v_mfma_f32_32x32x16_bf16 a[176:191], a[12:15], v[252:255], a[176:191]
 v_mfma_f32_32x32x16_bf16 a[192:207], a[28:31], v[236:239], a[192:207]
 v_mfma_f32_32x32x16_bf16 a[208:223], a[28:31], v[252:255], a[208:223]
 v_mfma_f32_32x32x16_bf16 a[160:175], a[76:79], v[252:255], a[160:175]
 v_mfma_f32_32x32x16_bf16 a[176:191], a[44:47], v[236:239], a[176:191]
 v_mfma_f32_32x32x16_bf16 a[192:207], a[92:95], v[252:255], a[192:207]
 v_mfma_f32_32x32x16_bf16 a[208:223], a[60:63], v[236:239], a[208:223]
 v_lshl_add_u32 v6, v4, 17, v5
 s_lshl_b32 s20, s18, 10
 v_add_u32 v6, s20, v6
 s_mov_b32 s20, 0
 v_accvgpr_read_b32 v32, a96
 v_accvgpr_read_b32 v33, a160
 v_cvt_pk_bf16_f32 v34, v32, v33
 buffer_store_dword v34, v6, s[44:47], s20 offen offset:0 sc1
 v_accvgpr_read_b32 v36, a112
 v_accvgpr_read_b32 v37, a176
 v_cvt_pk_bf16_f32 v38, v36, v37
 buffer_store_dword v38, v6, s[44:47], s20 offen offset:512 sc1
 s_mov_b32 s20, 32768
 v_accvgpr_read_b32 v40, a97
 v_accvgpr_read_b32 v41, a161
 v_cvt_pk_bf16_f32 v42, v40, v41
 buffer_store_dword v42, v6, s[44:47], s20 offen offset:0 sc1
 v_accvgpr_read_b32 v44, a113
 v_accvgpr_read_b32 v45, a177
 v_cvt_pk_bf16_f32 v46, v44, v45
 buffer_store_dword v46, v6, s[44:47], s20 offen offset:512 sc1
 s_mov_b32 s20, 65536
 v_accvgpr_read_b32 v48, a98
 v_accvgpr_read_b32 v49, a162
 v_cvt_pk_bf16_f32 v50, v48, v49
 buffer_store_dword v50, v6, s[44:47], s20 offen offset:0 sc1
 v_accvgpr_read_b32 v52, a114
 v_accvgpr_read_b32 v53, a178
 v_cvt_pk_bf16_f32 v54, v52, v53
 buffer_store_dword v54, v6, s[44:47], s20 offen offset:512 sc1
 s_mov_b32 s20, 98304
 v_accvgpr_read_b32 v56, a99
 v_accvgpr_read_b32 v57, a163
 v_cvt_pk_bf16_f32 v58, v56, v57
 buffer_store_dword v58, v6, s[44:47], s20 offen offset:0 sc1
 v_accvgpr_read_b32 v60, a115
 v_accvgpr_read_b32 v61, a179
 v_cvt_pk_bf16_f32 v62, v60, v61
 buffer_store_dword v62, v6, s[44:47], s20 offen offset:512 sc1
 s_mov_b32 s20, 262144
 v_accvgpr_read_b32 v64, a100
 v_accvgpr_read_b32 v65, a164
 v_cvt_pk_bf16_f32 v66, v64, v65
 buffer_store_dword v66, v6, s[44:47], s20 offen offset:0 sc1
 v_accvgpr_read_b32 v68, a116
 v_accvgpr_read_b32 v69, a180
 v_cvt_pk_bf16_f32 v70, v68, v69
 buffer_store_dword v70, v6, s[44:47], s20 offen offset:512 sc1
 s_mov_b32 s20, 294912
 v_accvgpr_read_b32 v72, a101
 v_accvgpr_read_b32 v73, a165
 v_cvt_pk_bf16_f32 v74, v72, v73
 buffer_store_dword v74, v6, s[44:47], s20 offen offset:0 sc1
 v_accvgpr_read_b32 v76, a117
 v_accvgpr_read_b32 v77, a181
 v_cvt_pk_bf16_f32 v78, v76, v77
 buffer_store_dword v78, v6, s[44:47], s20 offen offset:512 sc1
 s_mov_b32 s20, 327680
 v_accvgpr_read_b32 v80, a102
 v_accvgpr_read_b32 v81, a166
 v_cvt_pk_bf16_f32 v82, v80, v81
 buffer_store_dword v82, v6, s[44:47], s20 offen offset:0 sc1
 v_accvgpr_read_b32 v84, a118
 v_accvgpr_read_b32 v85, a182
 v_cvt_pk_bf16_f32 v86, v84, v85
 buffer_store_dword v86, v6, s[44:47], s20 offen offset:512 sc1
 s_mov_b32 s20, 360448
 v_accvgpr_read_b32 v88, a103
 v_accvgpr_read_b32 v89, a167
 v_cvt_pk_bf16_f32 v90, v88, v89
 buffer_store_dword v90, v6, s[44:47], s20 offen offset:0 sc1
 v_accvgpr_read_b32 v92, a119
 v_accvgpr_read_b32 v93, a183
 v_cvt_pk_bf16_f32 v94, v92, v93
 buffer_store_dword v94, v6, s[44:47], s20 offen offset:512 sc1
 s_mov_b32 s20, 524288
 v_accvgpr_read_b32 v32, a104
 v_accvgpr_read_b32 v33, a168
 v_cvt_pk_bf16_f32 v34, v32, v33
 buffer_store_dword v34, v6, s[44:47], s20 offen offset:0 sc1
 v_accvgpr_read_b32 v36, a120
 v_accvgpr_read_b32 v37, a184
 v_cvt_pk_bf16_f32 v38, v36, v37
 buffer_store_dword v38, v6, s[44:47], s20 offen offset:512 sc1
 s_mov_b32 s20, 557056
 v_accvgpr_read_b32 v40, a105
 v_accvgpr_read_b32 v41, a169
 v_cvt_pk_bf16_f32 v42, v40, v41
 buffer_store_dword v42, v6, s[44:47], s20 offen offset:0 sc1
 v_accvgpr_read_b32 v44, a121
 v_accvgpr_read_b32 v45, a185
 v_cvt_pk_bf16_f32 v46, v44, v45
 buffer_store_dword v46, v6, s[44:47], s20 offen offset:512 sc1
 s_mov_b32 s20, 589824
 v_accvgpr_read_b32 v48, a106
 v_accvgpr_read_b32 v49, a170
 v_cvt_pk_bf16_f32 v50, v48, v49
 buffer_store_dword v50, v6, s[44:47], s20 offen offset:0 sc1
 v_accvgpr_read_b32 v52, a122
 v_accvgpr_read_b32 v53, a186
 v_cvt_pk_bf16_f32 v54, v52, v53
 buffer_store_dword v54, v6, s[44:47], s20 offen offset:512 sc1
 s_mov_b32 s20, 622592
 v_accvgpr_read_b32 v56, a107
 v_accvgpr_read_b32 v57, a171
 v_cvt_pk_bf16_f32 v58, v56, v57
 buffer_store_dword v58, v6, s[44:47], s20 offen offset:0 sc1
 v_accvgpr_read_b32 v60, a123
 v_accvgpr_read_b32 v61, a187
 v_cvt_pk_bf16_f32 v62, v60, v61
 buffer_store_dword v62, v6, s[44:47], s20 offen offset:512 sc1
 s_mov_b32 s20, 786432
 v_accvgpr_read_b32 v64, a108
 v_accvgpr_read_b32 v65, a172
 v_cvt_pk_bf16_f32 v66, v64, v65
 buffer_store_dword v66, v6, s[44:47], s20 offen offset:0 sc1
 v_accvgpr_read_b32 v68, a124
 v_accvgpr_read_b32 v69, a188
 v_cvt_pk_bf16_f32 v70, v68, v69
 buffer_store_dword v70, v6, s[44:47], s20 offen offset:512 sc1
 s_mov_b32 s20, 819200
 v_accvgpr_read_b32 v72, a109
 v_accvgpr_read_b32 v73, a173
 v_cvt_pk_bf16_f32 v74, v72, v73
 buffer_store_dword v74, v6, s[44:47], s20 offen offset:0 sc1
 v_accvgpr_read_b32 v76, a125
 v_accvgpr_read_b32 v77, a189
 v_cvt_pk_bf16_f32 v78, v76, v77
 buffer_store_dword v78, v6, s[44:47], s20 offen offset:512 sc1
 s_mov_b32 s20, 851968
 v_accvgpr_read_b32 v80, a110
 v_accvgpr_read_b32 v81, a174
 v_cvt_pk_bf16_f32 v82, v80, v81
 buffer_store_dword v82, v6, s[44:47], s20 offen offset:0 sc1
 v_accvgpr_read_b32 v84, a126
 v_accvgpr_read_b32 v85, a190
 v_cvt_pk_bf16_f32 v86, v84, v85
 buffer_store_dword v86, v6, s[44:47], s20 offen offset:512 sc1
 s_mov_b32 s20, 884736
 v_accvgpr_read_b32 v88, a111
 v_accvgpr_read_b32 v89, a175
 v_cvt_pk_bf16_f32 v90, v88, v89
 buffer_store_dword v90, v6, s[44:47], s20 offen offset:0 sc1
 v_accvgpr_read_b32 v92, a127
 v_accvgpr_read_b32 v93, a191
 v_cvt_pk_bf16_f32 v94, v92, v93
 buffer_store_dword v94, v6, s[44:47], s20 offen offset:512 sc1
 s_mov_b32 s20, 1048576
 v_accvgpr_read_b32 v32, a128
 v_accvgpr_read_b32 v33, a192
 v_cvt_pk_bf16_f32 v34, v32, v33
 buffer_store_dword v34, v6, s[44:47], s20 offen offset:0 sc1
 v_accvgpr_read_b32 v36, a144
 v_accvgpr_read_b32 v37, a208
 v_cvt_pk_bf16_f32 v38, v36, v37
 buffer_store_dword v38, v6, s[44:47], s20 offen offset:512 sc1
 s_mov_b32 s20, 1081344
 v_accvgpr_read_b32 v40, a129
 v_accvgpr_read_b32 v41, a193
 v_cvt_pk_bf16_f32 v42, v40, v41
 buffer_store_dword v42, v6, s[44:47], s20 offen offset:0 sc1
 v_accvgpr_read_b32 v44, a145
 v_accvgpr_read_b32 v45, a209
 v_cvt_pk_bf16_f32 v46, v44, v45
 buffer_store_dword v46, v6, s[44:47], s20 offen offset:512 sc1
 s_mov_b32 s20, 1114112
 v_accvgpr_read_b32 v48, a130
 v_accvgpr_read_b32 v49, a194
 v_cvt_pk_bf16_f32 v50, v48, v49
 buffer_store_dword v50, v6, s[44:47], s20 offen offset:0 sc1
 v_accvgpr_read_b32 v52, a146
 v_accvgpr_read_b32 v53, a210
 v_cvt_pk_bf16_f32 v54, v52, v53
 buffer_store_dword v54, v6, s[44:47], s20 offen offset:512 sc1
 s_mov_b32 s20, 1146880
 v_accvgpr_read_b32 v56, a131
 v_accvgpr_read_b32 v57, a195
 v_cvt_pk_bf16_f32 v58, v56, v57
 buffer_store_dword v58, v6, s[44:47], s20 offen offset:0 sc1
 v_accvgpr_read_b32 v60, a147
 v_accvgpr_read_b32 v61, a211
 v_cvt_pk_bf16_f32 v62, v60, v61
 buffer_store_dword v62, v6, s[44:47], s20 offen offset:512 sc1
 s_mov_b32 s20, 1310720
 v_accvgpr_read_b32 v64, a132
 v_accvgpr_read_b32 v65, a196
 v_cvt_pk_bf16_f32 v66, v64, v65
 buffer_store_dword v66, v6, s[44:47], s20 offen offset:0 sc1
 v_accvgpr_read_b32 v68, a148
 v_accvgpr_read_b32 v69, a212
 v_cvt_pk_bf16_f32 v70, v68, v69
 buffer_store_dword v70, v6, s[44:47], s20 offen offset:512 sc1
 s_mov_b32 s20, 1343488
 v_accvgpr_read_b32 v72, a133
 v_accvgpr_read_b32 v73, a197
 v_cvt_pk_bf16_f32 v74, v72, v73
 buffer_store_dword v74, v6, s[44:47], s20 offen offset:0 sc1
 v_accvgpr_read_b32 v76, a149
 v_accvgpr_read_b32 v77, a213
 v_cvt_pk_bf16_f32 v78, v76, v77
 buffer_store_dword v78, v6, s[44:47], s20 offen offset:512 sc1
 s_mov_b32 s20, 1376256
 v_accvgpr_read_b32 v80, a134
 v_accvgpr_read_b32 v81, a198
 v_cvt_pk_bf16_f32 v82, v80, v81
 buffer_store_dword v82, v6, s[44:47], s20 offen offset:0 sc1
 v_accvgpr_read_b32 v84, a150
 v_accvgpr_read_b32 v85, a214
 v_cvt_pk_bf16_f32 v86, v84, v85
 buffer_store_dword v86, v6, s[44:47], s20 offen offset:512 sc1
 s_mov_b32 s20, 1409024
 v_accvgpr_read_b32 v88, a135
 v_accvgpr_read_b32 v89, a199
 v_cvt_pk_bf16_f32 v90, v88, v89
 buffer_store_dword v90, v6, s[44:47], s20 offen offset:0 sc1
 v_accvgpr_read_b32 v92, a151
 v_accvgpr_read_b32 v93, a215
 v_cvt_pk_bf16_f32 v94, v92, v93
 buffer_store_dword v94, v6, s[44:47], s20 offen offset:512 sc1
 s_mov_b32 s20, 1572864
 v_accvgpr_read_b32 v32, a136
 v_accvgpr_read_b32 v33, a200
 v_cvt_pk_bf16_f32 v34, v32, v33
 buffer_store_dword v34, v6, s[44:47], s20 offen offset:0 sc1
 v_accvgpr_read_b32 v36, a152
 v_accvgpr_read_b32 v37, a216
 v_cvt_pk_bf16_f32 v38, v36, v37
 buffer_store_dword v38, v6, s[44:47], s20 offen offset:512 sc1
 s_mov_b32 s20, 1605632
 v_accvgpr_read_b32 v40, a137
 v_accvgpr_read_b32 v41, a201
 v_cvt_pk_bf16_f32 v42, v40, v41
 buffer_store_dword v42, v6, s[44:47], s20 offen offset:0 sc1
 v_accvgpr_read_b32 v44, a153
 v_accvgpr_read_b32 v45, a217
 v_cvt_pk_bf16_f32 v46, v44, v45
 buffer_store_dword v46, v6, s[44:47], s20 offen offset:512 sc1
 s_mov_b32 s20, 1638400
 v_accvgpr_read_b32 v48, a138
 v_accvgpr_read_b32 v49, a202
 v_cvt_pk_bf16_f32 v50, v48, v49
 buffer_store_dword v50, v6, s[44:47], s20 offen offset:0 sc1
 v_accvgpr_read_b32 v52, a154
 v_accvgpr_read_b32 v53, a218
 v_cvt_pk_bf16_f32 v54, v52, v53
 buffer_store_dword v54, v6, s[44:47], s20 offen offset:512 sc1
 s_mov_b32 s20, 1671168
 v_accvgpr_read_b32 v56, a139
 v_accvgpr_read_b32 v57, a203
 v_cvt_pk_bf16_f32 v58, v56, v57
 buffer_store_dword v58, v6, s[44:47], s20 offen offset:0 sc1
 v_accvgpr_read_b32 v60, a155
 v_accvgpr_read_b32 v61, a219
 v_cvt_pk_bf16_f32 v62, v60, v61
 buffer_store_dword v62, v6, s[44:47], s20 offen offset:512 sc1
 s_mov_b32 s20, 1835008
 v_accvgpr_read_b32 v64, a140
 v_accvgpr_read_b32 v65, a204
 v_cvt_pk_bf16_f32 v66, v64, v65
 buffer_store_dword v66, v6, s[44:47], s20 offen offset:0 sc1
 v_accvgpr_read_b32 v68, a156
 v_accvgpr_read_b32 v69, a220
 v_cvt_pk_bf16_f32 v70, v68, v69
 buffer_store_dword v70, v6, s[44:47], s20 offen offset:512 sc1
 s_mov_b32 s20, 1867776
 v_accvgpr_read_b32 v72, a141
 v_accvgpr_read_b32 v73, a205
 v_cvt_pk_bf16_f32 v74, v72, v73
 buffer_store_dword v74, v6, s[44:47], s20 offen offset:0 sc1
 v_accvgpr_read_b32 v76, a157
 v_accvgpr_read_b32 v77, a221
 v_cvt_pk_bf16_f32 v78, v76, v77
 buffer_store_dword v78, v6, s[44:47], s20 offen offset:512 sc1
 s_mov_b32 s20, 1900544
 v_accvgpr_read_b32 v80, a142
 v_accvgpr_read_b32 v81, a206
 v_cvt_pk_bf16_f32 v82, v80, v81
 buffer_store_dword v82, v6, s[44:47], s20 offen offset:0 sc1
 v_accvgpr_read_b32 v84, a158
 v_accvgpr_read_b32 v85, a222
 v_cvt_pk_bf16_f32 v86, v84, v85
 buffer_store_dword v86, v6, s[44:47], s20 offen offset:512 sc1
 s_mov_b32 s20, 1933312
 v_accvgpr_read_b32 v88, a143
 v_accvgpr_read_b32 v89, a207
 v_cvt_pk_bf16_f32 v90, v88, v89
 buffer_store_dword v90, v6, s[44:47], s20 offen offset:0 sc1
 v_accvgpr_read_b32 v92, a159
 v_accvgpr_read_b32 v93, a223
 v_cvt_pk_bf16_f32 v94, v92, v93
 buffer_store_dword v94, v6, s[44:47], s20 offen offset:512 sc1
 s_branch PF2_L
PF2_X:
 s_mov_b32 s17, 0
PF3_L:
 s_waitcnt vmcnt(0)
 s_barrier
 s_cmp_lg_u32 s16, 0
 s_cbranch_scc1 PF3_C1
 s_mov_b64 exec, 1
 v_mov_b32 v2, 1
 s_cmp_eq_u32 s51, 0
 s_cbranch_scc1 PF3_T
 v_mov_b32 v1, s51
 v_mov_b32 v3, s52
 global_atomic_add v1, v3, s[4:5] sc1
PF3_T:
 s_lshl_b32 s20, s17, 8
 s_add_u32 s20, s20, 85599232
 v_mov_b32 v1, s20
 global_atomic_add v3, v1, v2, s[4:5] sc0 sc1
 s_cmp_lt_u32 s17, 4
 s_cselect_b32 s20, 128, 128
 s_waitcnt vmcnt(0)
 v_readfirstlane_b32 s18, v3
 s_cmp_lt_u32 s18, s20
 s_cbranch_scc1 PF3_W
 s_mov_b32 s18, -1
PF3_W:
 v_mov_b32 v1, 0x27F00
 v_mov_b32 v2, s18
 v_mov_b32 v3, s17
 ds_write_b64 v1, v[2:3]
 s_mov_b64 exec, -1
 s_waitcnt lgkmcnt(0)
PF3_C1:
 s_barrier
 v_mov_b32 v1, 0x27F00
 ds_read_b64 v[2:3], v1
 s_mov_b32 s51, 0
 s_mov_b32 s52, 1
 s_waitcnt lgkmcnt(0)
 v_readfirstlane_b32 s18, v2
 v_readfirstlane_b32 s17, v3
 s_cmp_eq_u32 s18, -1
 s_cbranch_scc1 PF3_X
 v_and_b32 v2, 63, v0
 v_and_b32 v3, 31, v2
 v_lshrrev_b32 v4, 5, v2
 s_lshr_b32 s20, s18, 1
 s_and_b32 s21, s18, 1
 s_mul_i32 s21, s21, 7
 s_lshl_b32 s22, s16, 1
 s_add_u32 s21, s21, s22
 s_lshl_b32 s22, s21, 15
 s_add_u32 s22, s22, 13303808
 s_add_u32 s32, s4, s22
 s_addc_u32 s33, s5, 0
 v_lshlrev_b32 v6, 4, v2
 v_mov_b32 v7, v6
 global_load_dwordx4 v[128:131], v7, s[32:33] offset:0
 global_load_dwordx4 v[132:135], v7, s[32:33] offset:1024
 global_load_dwordx4 v[136:139], v7, s[32:33] offset:2048
 global_load_dwordx4 v[140:143], v7, s[32:33] offset:3072
 v_add_u32 v7, 4096, v7
 global_load_dwordx4 v[144:147], v7, s[32:33] offset:0
 global_load_dwordx4 v[148:151], v7, s[32:33] offset:1024
 global_load_dwordx4 v[152:155], v7, s[32:33] offset:2048
 global_load_dwordx4 v[156:159], v7, s[32:33] offset:3072
 v_add_u32 v7, 4096, v7
 global_load_dwordx4 v[160:163], v7, s[32:33] offset:0
 global_load_dwordx4 v[164:167], v7, s[32:33] offset:1024
 global_load_dwordx4 v[168:171], v7, s[32:33] offset:2048
 global_load_dwordx4 v[172:175], v7, s[32:33] offset:3072
 v_add_u32 v7, 4096, v7
 global_load_dwordx4 v[176:179], v7, s[32:33] offset:0
 global_load_dwordx4 v[180:183], v7, s[32:33] offset:1024
 global_load_dwordx4 v[184:187], v7, s[32:33] offset:2048
 global_load_dwordx4 v[188:191], v7, s[32:33] offset:3072
 v_add_u32 v7, 4096, v7
 global_load_dwordx4 v[192:195], v7, s[32:33] offset:0
 global_load_dwordx4 v[196:199], v7, s[32:33] offset:1024
 global_load_dwordx4 v[200:203], v7, s[32:33] offset:2048
 global_load_dwordx4 v[204:207], v7, s[32:33] offset:3072
 v_add_u32 v7, 4096, v7
 global_load_dwordx4 v[208:211], v7, s[32:33] offset:0
 global_load_dwordx4 v[212:215], v7, s[32:33] offset:1024
 global_load_dwordx4 v[216:219], v7, s[32:33] offset:2048
 global_load_dwordx4 v[220:223], v7, s[32:33] offset:3072
 v_add_u32 v7, 4096, v7
 global_load_dwordx4 v[224:227], v7, s[32:33] offset:0
 global_load_dwordx4 v[228:231], v7, s[32:33] offset:1024
 global_load_dwordx4 v[232:235], v7, s[32:33] offset:2048
 global_load_dwordx4 v[236:239], v7, s[32:33] offset:3072
 v_add_u32 v7, 4096, v7
 global_load_dwordx4 v[240:243], v7, s[32:33] offset:0
 global_load_dwordx4 v[244:247], v7, s[32:33] offset:1024
 global_load_dwordx4 v[248:251], v7, s[32:33] offset:2048
 global_load_dwordx4 v[252:255], v7, s[32:33] offset:3072
 s_cmp_eq_u32 s16, 3
 s_cbranch_scc1 F3_2
 v_add_u32 v7, 4096, v7
 global_load_dwordx4 a[128:131], v7, s[32:33] offset:0
 global_load_dwordx4 a[132:135], v7, s[32:33] offset:1024
 global_load_dwordx4 a[136:139], v7, s[32:33] offset:2048
 global_load_dwordx4 a[140:143], v7, s[32:33] offset:3072
 v_add_u32 v7, 4096, v7
 global_load_dwordx4 a[144:147], v7, s[32:33] offset:0
 global_load_dwordx4 a[148:151], v7, s[32:33] offset:1024
 global_load_dwordx4 a[152:155], v7, s[32:33] offset:2048
 global_load_dwordx4 a[156:159], v7, s[32:33] offset:3072
 v_add_u32 v7, 4096, v7
 global_load_dwordx4 a[160:163], v7, s[32:33] offset:0
 global_load_dwordx4 a[164:167], v7, s[32:33] offset:1024
 global_load_dwordx4 a[168:171], v7, s[32:33] offset:2048
 global_load_dwordx4 a[172:175], v7, s[32:33] offset:3072
 v_add_u32 v7, 4096, v7
 global_load_dwordx4 a[176:179], v7, s[32:33] offset:0
 global_load_dwordx4 a[180:183], v7, s[32:33] offset:1024
 global_load_dwordx4 a[184:187], v7, s[32:33] offset:2048
 global_load_dwordx4 a[188:191], v7, s[32:33] offset:3072
 v_add_u32 v7, 4096, v7
 global_load_dwordx4 a[192:195], v7, s[32:33] offset:0
 global_load_dwordx4 a[196:199], v7, s[32:33] offset:1024
 global_load_dwordx4 a[200:203], v7, s[32:33] offset:2048
 global_load_dwordx4 a[204:207], v7, s[32:33] offset:3072
 v_add_u32 v7, 4096, v7
 global_load_dwordx4 a[208:211], v7, s[32:33] offset:0
 global_load_dwordx4 a[212:215], v7, s[32:33] offset:1024
 global_load_dwordx4 a[216:219], v7, s[32:33] offset:2048
 global_load_dwordx4 a[220:223], v7, s[32:33] offset:3072
 v_add_u32 v7, 4096, v7
 global_load_dwordx4 a[224:227], v7, s[32:33] offset:0
 global_load_dwordx4 a[228:231], v7, s[32:33] offset:1024
 global_load_dwordx4 a[232:235], v7, s[32:33] offset:2048
 global_load_dwordx4 a[236:239], v7, s[32:33] offset:3072
 v_add_u32 v7, 4096, v7
 global_load_dwordx4 a[240:243], v7, s[32:33] offset:0
 global_load_dwordx4 a[244:247], v7, s[32:33] offset:1024
 global_load_dwordx4 a[248:251], v7, s[32:33] offset:2048
 global_load_dwordx4 a[252:255], v7, s[32:33] offset:3072
F3_2:
 v_lshlrev_b32 v8, 6, v3
 v_add_u32 v8, s20, v8
 v_lshlrev_b32 v9, 3, v4
 v_add_u32 v16, 0, v9
 v_mul_u32_u24 v16, v16, v8
 v_and_b32 v16, 2047, v16
 v_cvt_f32_u32 v16, v16
 v_mul_f32 v16, 973078528, v16
 v_cos_f32 v20, v16
 v_sin_f32 v22, v16
 v_add_u32 v16, 1, v9
 v_mul_u32_u24 v16, v16, v8
 v_and_b32 v16, 2047, v16
 v_cvt_f32_u32 v16, v16
 v_mul_f32 v16, 973078528, v16
 v_cos_f32 v21, v16
 v_sin_f32 v23, v16
 v_cvt_pk_bf16_f32 v24, v20, v21
 v_cvt_pk_bf16_f32 v32, v22, v23
 v_xor_b32 v40, 0x80008000, v32
 v_add_u32 v16, 2, v9
 v_mul_u32_u24 v16, v16, v8
 v_and_b32 v16, 2047, v16
 v_cvt_f32_u32 v16, v16
 v_mul_f32 v16, 973078528, v16
 v_cos_f32 v20, v16
 v_sin_f32 v22, v16
 v_add_u32 v16, 3, v9
 v_mul_u32_u24 v16, v16, v8
 v_and_b32 v16, 2047, v16
 v_cvt_f32_u32 v16, v16
 v_mul_f32 v16, 973078528, v16
 v_cos_f32 v21, v16
 v_sin_f32 v23, v16
 v_cvt_pk_bf16_f32 v25, v20, v21
 v_cvt_pk_bf16_f32 v33, v22, v23
 v_xor_b32 v41, 0x80008000, v33
 v_add_u32 v16, 4, v9
 v_mul_u32_u24 v16, v16, v8
 v_and_b32 v16, 2047, v16
 v_cvt_f32_u32 v16, v16
 v_mul_f32 v16, 973078528, v16
 v_cos_f32 v20, v16
 v_sin_f32 v22, v16
 v_add_u32 v16, 5, v9
 v_mul_u32_u24 v16, v16, v8
 v_and_b32 v16, 2047, v16
 v_cvt_f32_u32 v16, v16
 v_mul_f32 v16, 973078528, v16
 v_cos_f32 v21, v16
 v_sin_f32 v23, v16
 v_cvt_pk_bf16_f32 v26, v20, v21
 v_cvt_pk_bf16_f32 v34, v22, v23
 v_xor_b32 v42, 0x80008000, v34
 v_add_u32 v16, 6, v9
 v_mul_u32_u24 v16, v16, v8
 v_and_b32 v16, 2047, v16
 v_cvt_f32_u32 v16, v16
 v_mul_f32 v16, 973078528, v16
 v_cos_f32 v20, v16
 v_sin_f32 v22, v16
 v_add_u32 v16, 7, v9
 v_mul_u32_u24 v16, v16, v8
 v_and_b32 v16, 2047, v16
 v_cvt_f32_u32 v16, v16
 v_mul_f32 v16, 973078528, v16
 v_cos_f32 v21, v16
 v_sin_f32 v23, v16
 v_cvt_pk_bf16_f32 v27, v20, v21
 v_cvt_pk_bf16_f32 v35, v22, v23
 v_xor_b32 v43, 0x80008000, v35
 v_add_u32 v16, 16, v9
 v_mul_u32_u24 v16, v16, v8
 v_and_b32 v16, 2047, v16
 v_cvt_f32_u32 v16, v16
 v_mul_f32 v16, 973078528, v16
 v_cos_f32 v20, v16
 v_sin_f32 v22, v16
 v_add_u32 v16, 17, v9
 v_mul_u32_u24 v16, v16, v8
 v_and_b32 v16, 2047, v16
 v_cvt_f32_u32 v16, v16
 v_mul_f32 v16, 973078528, v16
 v_cos_f32 v21, v16
 v_sin_f32 v23, v16
 v_cvt_pk_bf16_f32 v28, v20, v21
 v_cvt_pk_bf16_f32 v36, v22, v23
 v_xor_b32 v44, 0x80008000, v36
 v_add_u32 v16, 18, v9
 v_mul_u32_u24 v16, v16, v8
 v_and_b32 v16, 2047, v16
 v_cvt_f32_u32 v16, v16
 v_mul_f32 v16, 973078528, v16
 v_cos_f32 v20, v16
 v_sin_f32 v22, v16
 v_add_u32 v16, 19, v9
 v_mul_u32_u24 v16, v16, v8
 v_and_b32 v16, 2047, v16
 v_cvt_f32_u32 v16, v16
 v_mul_f32 v16, 973078528, v16
 v_cos_f32 v21, v16
 v_sin_f32 v23, v16
 v_cvt_pk_bf16_f32 v29, v20, v21
 v_cvt_pk_bf16_f32 v37, v22, v23
 v_xor_b32 v45, 0x80008000, v37
 v_add_u32 v16, 20, v9
 v_mul_u32_u24 v16, v16, v8
 v_and_b32 v16, 2047, v16
 v_cvt_f32_u32 v16, v16
 v_mul_f32 v16, 973078528, v16
 v_cos_f32 v20, v16
 v_sin_f32 v22, v16
 v_add_u32 v16, 21, v9
 v_mul_u32_u24 v16, v16, v8
 v_and_b32 v16, 2047, v16
 v_cvt_f32_u32 v16, v16
 v_mul_f32 v16, 973078528, v16
 v_cos_f32 v21, v16
 v_sin_f32 v23, v16
 v_cvt_pk_bf16_f32 v30, v20, v21
 v_cvt_pk_bf16_f32 v38, v22, v23
 v_xor_b32 v46, 0x80008000, v38
 v_add_u32 v16, 22, v9
 v_mul_u32_u24 v16, v16, v8
 v_and_b32 v16, 2047, v16
 v_cvt_f32_u32 v16, v16
 v_mul_f32 v16, 973078528, v16
 v_cos_f32 v20, v16
 v_sin_f32 v22, v16
 v_add_u32 v16, 23, v9
 v_mul_u32_u24 v16, v16, v8
 v_and_b32 v16, 2047, v16
 v_cvt_f32_u32 v16, v16
 v_mul_f32 v16, 973078528, v16
 v_cos_f32 v21, v16
 v_sin_f32 v23, v16
 v_cvt_pk_bf16_f32 v31, v20, v21
 v_cvt_pk_bf16_f32 v39, v22, v23
 v_xor_b32 v47, 0x80008000, v39
 s_mov_b32 s24, 85609728
 v_mov_b32 v10, s24
 s_mov_b32 s41, 0
W2_3:
 global_load_dword v12, v10, s[4:5] sc1
 s_add_u32 s41, s41, 1
 s_cmp_gt_u32 s41, 2000000
 s_cbranch_scc1 K2_EXIT
 s_waitcnt vmcnt(0)
 v_readfirstlane_b32 s42, v12
 s_cmp_ge_u32 s42, 32
 s_cbranch_scc1 W2_3_D
 s_sleep 8
 s_branch W2_3
W2_3_D:
 s_lshl_b32 s22, s20, 15
 s_add_u32 s22, s22, 16973824
 s_add_u32 s30, s4, s22
 s_addc_u32 s31, s5, 0
 s_lshl_b32 s22, s16, 7
 v_lshlrev_b32 v5, 2, v3
 v_add_u32 v5, s22, v5
 v_lshl_add_u32 v5, v4, 13, v5
 s_mov_b32 s22, 0x05040100
 s_mov_b32 s23, 0x07060302
 global_load_dword v48, v5, s[30:31] offset:0
 global_load_dword v49, v5, s[30:31] offset:1024
 global_load_dword v50, v5, s[30:31] offset:2048
 global_load_dword v51, v5, s[30:31] offset:3072
 global_load_dword v56, v5, s[30:31] offset:512
 global_load_dword v57, v5, s[30:31] offset:1536
 global_load_dword v58, v5, s[30:31] offset:2560
 global_load_dword v59, v5, s[30:31] offset:3584
 v_add_u32 v5, 4096, v5
 global_load_dword v52, v5, s[30:31] offset:0
 global_load_dword v53, v5, s[30:31] offset:1024
 global_load_dword v54, v5, s[30:31] offset:2048
 global_load_dword v55, v5, s[30:31] offset:3072
 global_load_dword v60, v5, s[30:31] offset:512
 global_load_dword v61, v5, s[30:31] offset:1536
 global_load_dword v62, v5, s[30:31] offset:2560
 global_load_dword v63, v5, s[30:31] offset:3584
 v_add_u32 v5, 12288, v5
 global_load_dword v64, v5, s[30:31] offset:0
 global_load_dword v65, v5, s[30:31] offset:1024
 global_load_dword v66, v5, s[30:31] offset:2048
 global_load_dword v67, v5, s[30:31] offset:3072
 global_load_dword v72, v5, s[30:31] offset:512
 global_load_dword v73, v5, s[30:31] offset:1536
 global_load_dword v74, v5, s[30:31] offset:2560
 global_load_dword v75, v5, s[30:31] offset:3584
 v_add_u32 v5, 4096, v5
 global_load_dword v68, v5, s[30:31] offset:0
 global_load_dword v69, v5, s[30:31] offset:1024
 global_load_dword v70, v5, s[30:31] offset:2048
 global_load_dword v71, v5, s[30:31] offset:3072
 global_load_dword v76, v5, s[30:31] offset:512
 global_load_dword v77, v5, s[30:31] offset:1536
 global_load_dword v78, v5, s[30:31] offset:2560
 global_load_dword v79, v5, s[30:31] offset:3584
 s_waitcnt vmcnt(0)
 v_perm_b32 v80, v49, v48, s22
 v_perm_b32 v88, v49, v48, s23
 v_perm_b32 v81, v51, v50, s22
 v_perm_b32 v89, v51, v50, s23
 v_perm_b32 v82, v53, v52, s22
 v_perm_b32 v90, v53, v52, s23
 v_perm_b32 v83, v55, v54, s22
 v_perm_b32 v91, v55, v54, s23
 v_perm_b32 v96, v57, v56, s22
 v_perm_b32 v104, v57, v56, s23
 v_perm_b32 v97, v59, v58, s22
 v_perm_b32 v105, v59, v58, s23
 v_perm_b32 v98, v61, v60, s22
 v_perm_b32 v106, v61, v60, s23
 v_perm_b32 v99, v63, v62, s22
 v_perm_b32 v107, v63, v62, s23
 v_perm_b32 v84, v65, v64, s22
 v_perm_b32 v92, v65, v64, s23
 v_perm_b32 v85, v67, v66, s22
 v_perm_b32 v93, v67, v66, s23
 v_perm_b32 v86, v69, v68, s22
 v_perm_b32 v94, v69, v68, s23
 v_perm_b32 v87, v71, v70, s22
 v_perm_b32 v95, v71, v70, s23
 v_perm_b32 v100, v73, v72, s22
 v_perm_b32 v108, v73, v72, s23
 v_perm_b32 v101, v75, v74, s22
 v_perm_b32 v109, v75, v74, s23
 v_perm_b32 v102, v77, v76, s22
 v_perm_b32 v110, v77, v76, s23
 v_perm_b32 v103, v79, v78, s22
 v_perm_b32 v111, v79, v78, s23
 v_mfma_f32_32x32x16_bf16 a[0:15], v[80:83], v[24:27], 0
 v_mfma_f32_32x32x16_bf16 a[16:31], v[96:99], v[24:27], 0
 v_mfma_f32_32x32x16_bf16 a[32:47], v[88:91], v[24:27], 0
 v_mfma_f32_32x32x16_bf16 a[48:63], v[104:107], v[24:27], 0
 v_mfma_f32_32x32x16_bf16 a[0:15], v[96:99], v[40:43], a[0:15]
 v_mfma_f32_32x32x16_bf16 a[16:31], v[80:83], v[32:35], a[16:31]
 v_mfma_f32_32x32x16_bf16 a[32:47], v[104:107], v[40:43], a[32:47]
 v_mfma_f32_32x32x16_bf16 a[48:63], v[88:91], v[32:35], a[48:63]
 v_mfma_f32_32x32x16_bf16 a[0:15], v[84:87], v[28:31], a[0:15]
 v_mfma_f32_32x32x16_bf16 a[16:31], v[100:103], v[28:31], a[16:31]
 v_mfma_f32_32x32x16_bf16 a[32:47], v[92:95], v[28:31], a[32:47]
 v_mfma_f32_32x32x16_bf16 a[48:63], v[108:111], v[28:31], a[48:63]
 v_mfma_f32_32x32x16_bf16 a[0:15], v[100:103], v[44:47], a[0:15]
 v_mfma_f32_32x32x16_bf16 a[16:31], v[84:87], v[36:39], a[16:31]
 v_mfma_f32_32x32x16_bf16 a[32:47], v[108:111], v[44:47], a[32:47]
 v_mfma_f32_32x32x16_bf16 a[48:63], v[92:95], v[36:39], a[48:63]
 s_lshl_b32 s22, s16, 13
 v_add_u32 v7, s22, v6
 v_accvgpr_read_b32 v48, a0
 v_accvgpr_read_b32 v49, a1
 v_accvgpr_read_b32 v50, a2
 v_accvgpr_read_b32 v51, a3
 v_accvgpr_read_b32 v52, a4
 v_accvgpr_read_b32 v53, a5
 v_accvgpr_read_b32 v54, a6
 v_accvgpr_read_b32 v55, a7
 v_cvt_pk_bf16_f32 v56, v48, v49
 v_cvt_pk_bf16_f32 v57, v50, v51
 v_cvt_pk_bf16_f32 v58, v52, v53
 v_cvt_pk_bf16_f32 v59, v54, v55
 ds_write_b128 v7, v[56:59] offset:0
 v_accvgpr_read_b32 v60, a8
 v_accvgpr_read_b32 v61, a9
 v_accvgpr_read_b32 v62, a10
 v_accvgpr_read_b32 v63, a11
 v_accvgpr_read_b32 v64, a12
 v_accvgpr_read_b32 v65, a13
 v_accvgpr_read_b32 v66, a14
 v_accvgpr_read_b32 v67, a15
 v_cvt_pk_bf16_f32 v68, v60, v61
 v_cvt_pk_bf16_f32 v69, v62, v63
 v_cvt_pk_bf16_f32 v70, v64, v65
 v_cvt_pk_bf16_f32 v71, v66, v67
 ds_write_b128 v7, v[68:71] offset:1024
 v_accvgpr_read_b32 v48, a16
 v_accvgpr_read_b32 v49, a17
 v_accvgpr_read_b32 v50, a18
 v_accvgpr_read_b32 v51, a19
 v_accvgpr_read_b32 v52, a20
 v_accvgpr_read_b32 v53, a21
 v_accvgpr_read_b32 v54, a22
 v_accvgpr_read_b32 v55, a23
 v_cvt_pk_bf16_f32 v56, v48, v49
 v_cvt_pk_bf16_f32 v57, v50, v51
 v_cvt_pk_bf16_f32 v58, v52, v53
 v_cvt_pk_bf16_f32 v59, v54, v55
 ds_write_b128 v7, v[56:59] offset:2048
 v_accvgpr_read_b32 v60, a24
 v_accvgpr_read_b32 v61, a25
 v_accvgpr_read_b32 v62, a26
 v_accvgpr_read_b32 v63, a27
 v_accvgpr_read_b32 v64, a28
 v_accvgpr_read_b32 v65, a29
 v_accvgpr_read_b32 v66, a30
 v_accvgpr_read_b32 v67, a31
 v_cvt_pk_bf16_f32 v68, v60, v61
 v_cvt_pk_bf16_f32 v69, v62, v63
 v_cvt_pk_bf16_f32 v70, v64, v65
 v_cvt_pk_bf16_f32 v71, v66, v67
 ds_write_b128 v7, v[68:71] offset:3072
 v_accvgpr_read_b32 v48, a32
 v_accvgpr_read_b32 v49, a33
 v_accvgpr_read_b32 v50, a34
 v_accvgpr_read_b32 v51, a35
 v_accvgpr_read_b32 v52, a36
 v_accvgpr_read_b32 v53, a37
 v_accvgpr_read_b32 v54, a38
 v_accvgpr_read_b32 v55, a39
 v_cvt_pk_bf16_f32 v56, v48, v49
 v_cvt_pk_bf16_f32 v57, v50, v51
 v_cvt_pk_bf16_f32 v58, v52, v53
 v_cvt_pk_bf16_f32 v59, v54, v55
 ds_write_b128 v7, v[56:59] offset:4096
 v_accvgpr_read_b32 v60, a40
 v_accvgpr_read_b32 v61, a41
 v_accvgpr_read_b32 v62, a42
 v_accvgpr_read_b32 v63, a43
 v_accvgpr_read_b32 v64, a44
 v_accvgpr_read_b32 v65, a45
 v_accvgpr_read_b32 v66, a46
 v_accvgpr_read_b32 v67, a47
 v_cvt_pk_bf16_f32 v68, v60, v61
 v_cvt_pk_bf16_f32 v69, v62, v63
 v_cvt_pk_bf16_f32 v70, v64, v65
 v_cvt_pk_bf16_f32 v71, v66, v67
 ds_write_b128 v7, v[68:71] offset:5120
 v_accvgpr_read_b32 v48, a48
 v_accvgpr_read_b32 v49, a49
 v_accvgpr_read_b32 v50, a50
 v_accvgpr_read_b32 v51, a51
 v_accvgpr_read_b32 v52, a52
 v_accvgpr_read_b32 v53, a53
 v_accvgpr_read_b32 v54, a54
 v_accvgpr_read_b32 v55, a55
 v_cvt_pk_bf16_f32 v56, v48, v49
 v_cvt_pk_bf16_f32 v57, v50, v51
 v_cvt_pk_bf16_f32 v58, v52, v53
 v_cvt_pk_bf16_f32 v59, v54, v55
 ds_write_b128 v7, v[56:59] offset:6144
 v_accvgpr_read_b32 v60, a56
 v_accvgpr_read_b32 v61, a57
 v_accvgpr_read_b32 v62, a58
 v_accvgpr_read_b32 v63, a59
 v_accvgpr_read_b32 v64, a60
 v_accvgpr_read_b32 v65, a61
 v_accvgpr_read_b32 v66, a62
 v_accvgpr_read_b32 v67, a63
 v_cvt_pk_bf16_f32 v68, v60, v61
 v_cvt_pk_bf16_f32 v69, v62, v63
 v_cvt_pk_bf16_f32 v70, v64, v65
 v_cvt_pk_bf16_f32 v71, v66, v67
 ds_write_b128 v7, v[68:71] offset:7168
 s_waitcnt lgkmcnt(0)
 s_barrier
 ds_read_b128 a[0:3], v6 offset:0
 ds_read_b128 a[4:7], v6 offset:1024
 ds_read_b128 a[8:11], v6 offset:2048
 ds_read_b128 a[12:15], v6 offset:3072
 ds_read_b128 a[16:19], v6 offset:4096
 ds_read_b128 a[20:23], v6 offset:5120
 ds_read_b128 a[24:27], v6 offset:6144
 ds_read_b128 a[28:31], v6 offset:7168
 ds_read_b128 a[32:35], v6 offset:8192
 ds_read_b128 a[36:39], v6 offset:9216
 ds_read_b128 a[40:43], v6 offset:10240
 ds_read_b128 a[44:47], v6 offset:11264
 ds_read_b128 a[48:51], v6 offset:12288
 ds_read_b128 a[52:55], v6 offset:13312
 ds_read_b128 a[56:59], v6 offset:14336
 ds_read_b128 a[60:63], v6 offset:15360
 ds_read_b128 a[64:67], v6 offset:16384
 ds_read_b128 a[68:71], v6 offset:17408
 ds_read_b128 a[72:75], v6 offset:18432
 ds_read_b128 a[76:79], v6 offset:19456
 ds_read_b128 a[80:83], v6 offset:20480
 ds_read_b128 a[84:87], v6 offset:21504
 ds_read_b128 a[88:91], v6 offset:22528
 ds_read_b128 a[92:95], v6 offset:23552
 ds_read_b128 a[96:99], v6 offset:24576
 ds_read_b128 a[100:103], v6 offset:25600
 ds_read_b128 a[104:107], v6 offset:26624
 ds_read_b128 a[108:111], v6 offset:27648
 ds_read_b128 a[112:115], v6 offset:28672
 ds_read_b128 a[116:119], v6 offset:29696
 ds_read_b128 a[120:123], v6 offset:30720
 ds_read_b128 a[124:127], v6 offset:31744
 s_mul_i32 s22, s20, 1792
 s_lshl_b32 s23, s21, 6
 s_add_u32 s22, s22, s23
 s_add_u32 s30, s6, s22
 s_addc_u32 s31, s7, 0
 v_mul_u32_u24 v5, 114688, v3
 v_lshl_add_u32 v5, v4, 4, v5
 s_waitcnt lgkmcnt(15)
 v_mfma_f32_32x32x16_bf16 v[32:47], v[128:131], a[0:3], 0
 s_waitcnt lgkmcnt(15)
 v_mfma_f32_32x32x16_bf16 v[32:47], v[132:135], a[4:7], v[32:47]
 s_waitcnt lgkmcnt(15)
 v_mfma_f32_32x32x16_bf16 v[32:47], v[136:139], a[8:11], v[32:47]
 s_waitcnt lgkmcnt(15)
 v_mfma_f32_32x32x16_bf16 v[32:47], v[140:143], a[12:15], v[32:47]
 s_waitcnt lgkmcnt(15)
 v_mfma_f32_32x32x16_bf16 v[32:47], v[144:147], a[16:19], v[32:47]
 s_waitcnt lgkmcnt(15)
 v_mfma_f32_32x32x16_bf16 v[32:47], v[148:151], a[20:23], v[32:47]
 s_waitcnt lgkmcnt(15)
 v_mfma_f32_32x32x16_bf16 v[32:47], v[152:155], a[24:27], v[32:47]
 s_waitcnt lgkmcnt(15)
 v_mfma_f32_32x32x16_bf16 v[32:47], v[156:159], a[28:31], v[32:47]
 s_waitcnt lgkmcnt(15)
 v_mfma_f32_32x32x16_bf16 v[32:47], v[160:163], a[32:35], v[32:47]
 s_waitcnt lgkmcnt(15)
 v_mfma_f32_32x32x16_bf16 v[32:47], v[164:167], a[36:39], v[32:47]
 s_waitcnt lgkmcnt(15)
 v_mfma_f32_32x32x16_bf16 v[32:47], v[168:171], a[40:43], v[32:47]
 s_waitcnt lgkmcnt(15)
 v_mfma_f32_32x32x16_bf16 v[32:47], v[172:175], a[44:47], v[32:47]
 s_waitcnt lgkmcnt(15)
 v_mfma_f32_32x32x16_bf16 v[32:47], v[176:179], a[48:51], v[32:47]
 s_waitcnt lgkmcnt(15)
 v_mfma_f32_32x32x16_bf16 v[32:47], v[180:183], a[52:55], v[32:47]
 s_waitcnt lgkmcnt(15)
 v_mfma_f32_32x32x16_bf16 v[32:47], v[184:187], a[56:59], v[32:47]
 s_waitcnt lgkmcnt(15)
 v_mfma_f32_32x32x16_bf16 v[32:47], v[188:191], a[60:63], v[32:47]
 s_waitcnt lgkmcnt(15)
 v_mfma_f32_32x32x16_bf16 v[32:47], v[192:195], a[64:67], v[32:47]
 s_waitcnt lgkmcnt(14)
 v_mfma_f32_32x32x16_bf16 v[32:47], v[196:199], a[68:71], v[32:47]
 s_waitcnt lgkmcnt(13)
 v_mfma_f32_32x32x16_bf16 v[32:47], v[200:203], a[72:75], v[32:47]
 s_waitcnt lgkmcnt(12)
 v_mfma_f32_32x32x16_bf16 v[32:47], v[204:207], a[76:79], v[32:47]
 s_waitcnt lgkmcnt(11)
 v_mfma_f32_32x32x16_bf16 v[32:47], v[208:211], a[80:83], v[32:47]
 s_waitcnt lgkmcnt(10)
 v_mfma_f32_32x32x16_bf16 v[32:47], v[212:215], a[84:87], v[32:47]
 s_waitcnt lgkmcnt(9)
 v_mfma_f32_32x32x16_bf16 v[32:47], v[216:219], a[88:91], v[32:47]
 s_waitcnt lgkmcnt(8)
 v_mfma_f32_32x32x16_bf16 v[32:47], v[220:223], a[92:95], v[32:47]
 s_waitcnt lgkmcnt(7)
 v_mfma_f32_32x32x16_bf16 v[32:47], v[224:227], a[96:99], v[32:47]
 s_waitcnt lgkmcnt(6)
 v_mfma_f32_32x32x16_bf16 v[32:47], v[228:231], a[100:103], v[32:47]
 s_waitcnt lgkmcnt(5)
 v_mfma_f32_32x32x16_bf16 v[32:47], v[232:235], a[104:107], v[32:47]
 s_waitcnt lgkmcnt(4)
 v_mfma_f32_32x32x16_bf16 v[32:47], v[236:239], a[108:111], v[32:47]
 s_waitcnt lgkmcnt(3)
 v_mfma_f32_32x32x16_bf16 v[32:47], v[240:243], a[112:115], v[32:47]
 s_waitcnt lgkmcnt(2)
 v_mfma_f32_32x32x16_bf16 v[32:47], v[244:247], a[116:119], v[32:47]
 s_waitcnt lgkmcnt(1)
 v_mfma_f32_32x32x16_bf16 v[32:47], v[248:251], a[120:123], v[32:47]
 s_waitcnt lgkmcnt(0)
 v_mfma_f32_32x32x16_bf16 v[32:47], v[252:255], a[124:127], v[32:47]
 s_nop 11
 v_cvt_pk_bf16_f32 v64, v32, v33
 v_cvt_pk_bf16_f32 v65, v34, v35
 v_cvt_pk_bf16_f32 v66, v36, v37
 v_cvt_pk_bf16_f32 v67, v38, v39
 global_store_dwordx4 v5, v[64:67], s[30:31] offset:0
 v_cvt_pk_bf16_f32 v68, v40, v41
 v_cvt_pk_bf16_f32 v69, v42, v43
 v_cvt_pk_bf16_f32 v70, v44, v45
 v_cvt_pk_bf16_f32 v71, v46, v47
 global_store_dwordx4 v5, v[68:71], s[30:31] offset:32
 s_cmp_eq_u32 s16, 3
 s_cbranch_scc1 F3_4
 v_mfma_f32_32x32x16_bf16 v[48:63], a[128:131], a[0:3], 0
 v_mfma_f32_32x32x16_bf16 v[48:63], a[132:135], a[4:7], v[48:63]
 v_mfma_f32_32x32x16_bf16 v[48:63], a[136:139], a[8:11], v[48:63]
 v_mfma_f32_32x32x16_bf16 v[48:63], a[140:143], a[12:15], v[48:63]
 v_mfma_f32_32x32x16_bf16 v[48:63], a[144:147], a[16:19], v[48:63]
 v_mfma_f32_32x32x16_bf16 v[48:63], a[148:151], a[20:23], v[48:63]
 v_mfma_f32_32x32x16_bf16 v[48:63], a[152:155], a[24:27], v[48:63]
 v_mfma_f32_32x32x16_bf16 v[48:63], a[156:159], a[28:31], v[48:63]
 v_mfma_f32_32x32x16_bf16 v[48:63], a[160:163], a[32:35], v[48:63]
 v_mfma_f32_32x32x16_bf16 v[48:63], a[164:167], a[36:39], v[48:63]
 v_mfma_f32_32x32x16_bf16 v[48:63], a[168:171], a[40:43], v[48:63]
 v_mfma_f32_32x32x16_bf16 v[48:63], a[172:175], a[44:47], v[48:63]
 v_mfma_f32_32x32x16_bf16 v[48:63], a[176:179], a[48:51], v[48:63]
 v_mfma_f32_32x32x16_bf16 v[48:63], a[180:183], a[52:55], v[48:63]
 v_mfma_f32_32x32x16_bf16 v[48:63], a[184:187], a[56:59], v[48:63]
 v_mfma_f32_32x32x16_bf16 v[48:63], a[188:191], a[60:63], v[48:63]
 v_mfma_f32_32x32x16_bf16 v[48:63], a[192:195], a[64:67], v[48:63]
 v_mfma_f32_32x32x16_bf16 v[48:63], a[196:199], a[68:71], v[48:63]
 v_mfma_f32_32x32x16_bf16 v[48:63], a[200:203], a[72:75], v[48:63]
 v_mfma_f32_32x32x16_bf16 v[48:63], a[204:207], a[76:79], v[48:63]
 v_mfma_f32_32x32x16_bf16 v[48:63], a[208:211], a[80:83], v[48:63]
 v_mfma_f32_32x32x16_bf16 v[48:63], a[212:215], a[84:87], v[48:63]
 v_mfma_f32_32x32x16_bf16 v[48:63], a[216:219], a[88:91], v[48:63]
 v_mfma_f32_32x32x16_bf16 v[48:63], a[220:223], a[92:95], v[48:63]
 v_mfma_f32_32x32x16_bf16 v[48:63], a[224:227], a[96:99], v[48:63]
 v_mfma_f32_32x32x16_bf16 v[48:63], a[228:231], a[100:103], v[48:63]
 v_mfma_f32_32x32x16_bf16 v[48:63], a[232:235], a[104:107], v[48:63]
 v_mfma_f32_32x32x16_bf16 v[48:63], a[236:239], a[108:111], v[48:63]
 v_mfma_f32_32x32x16_bf16 v[48:63], a[240:243], a[112:115], v[48:63]
 v_mfma_f32_32x32x16_bf16 v[48:63], a[244:247], a[116:119], v[48:63]
 v_mfma_f32_32x32x16_bf16 v[48:63], a[248:251], a[120:123], v[48:63]
 v_mfma_f32_32x32x16_bf16 v[48:63], a[252:255], a[124:127], v[48:63]
 s_nop 11
 v_cvt_pk_bf16_f32 v72, v48, v49
 v_cvt_pk_bf16_f32 v73, v50, v51
 v_cvt_pk_bf16_f32 v74, v52, v53
 v_cvt_pk_bf16_f32 v75, v54, v55
 global_store_dwordx4 v5, v[72:75], s[30:31] offset:64
 v_cvt_pk_bf16_f32 v76, v56, v57
 v_cvt_pk_bf16_f32 v77, v58, v59
 v_cvt_pk_bf16_f32 v78, v60, v61
 v_cvt_pk_bf16_f32 v79, v62, v63
 global_store_dwordx4 v5, v[76:79], s[30:31] offset:96
F3_4:
 s_branch PF3_L
PF3_X:
 s_barrier
 s_cmp_lg_u32 s16, 0
 s_cbranch_scc1 R1_C1
 v_mov_b32 v1, 85590016
 v_mov_b32 v2, 1
 s_mov_b64 exec, 1
 global_atomic_add v3, v1, v2, s[4:5] sc0 sc1
 v_mov_b32 v1, 0x27F00
 s_waitcnt vmcnt(0)
 ds_write_b32 v1, v3
 s_mov_b64 exec, -1
 s_waitcnt lgkmcnt(0)
R1_C1:
 s_barrier
 v_mov_b32 v1, 0x27F00
 ds_read_b32 v2, v1
 s_waitcnt lgkmcnt(0)
 v_readfirstlane_b32 s17, v2
 s_cmp_lt_u32 s17, 32
 s_cbranch_scc1 K2_TEAM
 s_mov_b32 s17, 0
PPO_L:
 s_waitcnt vmcnt(0)
 s_barrier
 s_cmp_lg_u32 s16, 0
 s_cbranch_scc1 PPO_C1
 s_mov_b64 exec, 1
 v_mov_b32 v2, 1
 s_cmp_eq_u32 s51, 0
 s_cbranch_scc1 PPO_T
 v_mov_b32 v1, s51
 v_mov_b32 v3, s52
 global_atomic_add v1, v3, s[4:5] sc1
PPO_T:
 s_lshl_b32 s20, s17, 8
 s_add_u32 s20, s20, 85601280
 v_mov_b32 v1, s20
 global_atomic_add v3, v1, v2, s[4:5] sc0 sc1
 s_cmp_lt_u32 s17, 4
 s_cselect_b32 s20, 512, 512
 s_waitcnt vmcnt(0)
 v_readfirstlane_b32 s18, v3
 s_cmp_lt_u32 s18, s20
 s_cbranch_scc1 PPO_W
 s_mov_b32 s18, -1
PPO_W:
 v_mov_b32 v1, 0x27F00
 v_mov_b32 v2, s18
 v_mov_b32 v3, s17
 ds_write_b64 v1, v[2:3]
 s_mov_b64 exec, -1
 s_waitcnt lgkmcnt(0)
PPO_C1:
 s_barrier
 v_mov_b32 v1, 0x27F00
 ds_read_b64 v[2:3], v1
 s_mov_b32 s51, 0
 s_mov_b32 s52, 1
 s_waitcnt lgkmcnt(0)
 v_readfirstlane_b32 s18, v2
 v_readfirstlane_b32 s17, v3
 s_cmp_eq_u32 s18, -1
 s_cbranch_scc1 PPO_X
 v_and_b32 v2, 63, v0
 v_and_b32 v3, 15, v2
 v_lshrrev_b32 v4, 4, v2
 s_lshr_b32 s20, s18, 3
 s_bfe_u32 s21, s18, 0x10002
 s_and_b32 s22, s18, 3
 s_lshl_b32 s22, s22, 2
 s_add_u32 s22, s22, s16
 s_lshr_b32 s23, s20, 3
 s_lshl_b32 s23, s23, 8
 s_add_u32 s24, s23, 85610496
 v_mov_b32 v10, s24
 s_mov_b32 s41, 0
PQ_5:
 global_load_dword v12, v10, s[4:5] sc1
 s_add_u32 s41, s41, 1
 s_cmp_gt_u32 s41, 2000000
 s_cbranch_scc1 K2_EXIT
 s_waitcnt vmcnt(0)
 v_readfirstlane_b32 s42, v12
 s_cmp_ge_u32 s42, 32
 s_cbranch_scc1 PQ_5_D
 s_sleep 8
 s_branch PQ_5
PQ_5_D:
 s_add_u32 s24, s23, 85607424
 v_mov_b32 v10, s24
 s_mov_b32 s41, 0
PV_6:
 global_load_dword v12, v10, s[4:5] sc1
 s_add_u32 s41, s41, 1
 s_cmp_gt_u32 s41, 2000000
 s_cbranch_scc1 K2_EXIT
 s_waitcnt vmcnt(0)
 v_readfirstlane_b32 s42, v12
 s_cmp_ge_u32 s42, 224
 s_cbranch_scc1 PV_6_D
 s_sleep 8
 s_branch PV_6
PV_6_D:
 s_mul_i32 s23, s20, 458752
 s_mul_i32 s24, s16, 114688
 s_add_u32 s24, s24, s23
 s_add_u32 s24, s24, 55771136
 s_add_u32 s30, s4, s24
 s_addc_u32 s31, s5, 0
 s_lshl_b32 s24, s22, 15
 s_add_u32 s24, s24, s23
 s_add_u32 s24, s24, 26411008
 s_add_u32 s32, s4, s24
 s_addc_u32 s33, s5, 0
 s_mul_i32 s24, s20, 28672
 s_add_u32 s24, s24, 85655552
 s_add_u32 s34, s4, s24
 s_addc_u32 s35, s5, 0
 v_lshlrev_b32 v5, 9, v4
 s_lshl_b32 s24, s21, 8
 v_lshl_add_u32 v6, v3, 4, v5
 v_add_u32 v6, s24, v6
 v_bfe_u32 v8, v3, 2, 1
 v_lshrrev_b32 v9, 3, v3
 v_and_b32 v10, 3, v3
 v_lshlrev_b32 v7, 8, v8
 v_lshl_add_u32 v7, v9, 6, v7
 v_lshl_add_u32 v7, v10, 4, v7
 v_add_u32 v7, v7, v5
 v_lshlrev_b32 v11, 7, v8
 v_lshl_add_u32 v11, v10, 4, v11
 v_lshl_add_u32 v8, v9, 10, v11
 v_lshl_add_u32 v8, v4, 8, v8
 v_lshl_add_u32 v9, v9, 8, v11
 v_add_u32 v9, v9, v5
 global_load_dwordx4 v[16:19], v7, s[34:35] offset:0
 global_load_dwordx4 v[20:23], v7, s[34:35] offset:128
 global_load_dwordx4 v[24:27], v7, s[34:35] offset:2048
 global_load_dwordx4 v[28:31], v7, s[34:35] offset:2176
 v_add_u32 v7, 4096, v7
 global_load_dwordx4 v[32:35], v7, s[34:35] offset:0
 global_load_dwordx4 v[36:39], v7, s[34:35] offset:128
 global_load_dwordx4 v[40:43], v7, s[34:35] offset:2048
 global_load_dwordx4 v[44:47], v7, s[34:35] offset:2176
 v_add_u32 v7, 4096, v7
 global_load_dwordx4 v[48:51], v7, s[34:35] offset:0
 global_load_dwordx4 v[52:55], v7, s[34:35] offset:128
 global_load_dwordx4 v[56:59], v7, s[34:35] offset:2048
 global_load_dwordx4 v[60:63], v7, s[34:35] offset:2176
 v_add_u32 v7, 4096, v7
 global_load_dwordx4 v[64:67], v7, s[34:35] offset:0
 global_load_dwordx4 v[68:71], v7, s[34:35] offset:128
 global_load_dwordx4 v[72:75], v7, s[34:35] offset:2048
 global_load_dwordx4 v[76:79], v7, s[34:35] offset:2176
 v_add_u32 v7, 4096, v7
 global_load_dwordx4 v[80:83], v7, s[34:35] offset:0
 global_load_dwordx4 v[84:87], v7, s[34:35] offset:128
 global_load_dwordx4 v[88:91], v7, s[34:35] offset:2048
 global_load_dwordx4 v[92:95], v7, s[34:35] offset:2176
 v_add_u32 v7, 4096, v7
 global_load_dwordx4 v[96:99], v7, s[34:35] offset:0
 global_load_dwordx4 v[100:103], v7, s[34:35] offset:128
 global_load_dwordx4 v[104:107], v7, s[34:35] offset:2048
 global_load_dwordx4 v[108:111], v7, s[34:35] offset:2176
 v_add_u32 v7, 4096, v7
 global_load_dwordx4 v[112:115], v7, s[34:35] offset:0
 global_load_dwordx4 v[116:119], v7, s[34:35] offset:128
 global_load_dwordx4 v[120:123], v7, s[34:35] offset:2048
 global_load_dwordx4 v[124:127], v7, s[34:35] offset:2176
 global_load_dwordx4 a[0:3], v6, s[30:31] offset:0
 global_load_dwordx4 a[4:7], v6, s[30:31] offset:2048
 v_add_u32 v6, 4096, v6
 global_load_dwordx4 a[8:11], v6, s[30:31] offset:0
 global_load_dwordx4 a[12:15], v6, s[30:31] offset:2048
 v_add_u32 v6, 4096, v6
 global_load_dwordx4 a[16:19], v6, s[30:31] offset:0
 global_load_dwordx4 a[20:23], v6, s[30:31] offset:2048
 v_add_u32 v6, 4096, v6
 global_load_dwordx4 a[24:27], v6, s[30:31] offset:0
 global_load_dwordx4 a[28:31], v6, s[30:31] offset:2048
 v_add_u32 v6, 4096, v6
 global_load_dwordx4 a[32:35], v6, s[30:31] offset:0
 global_load_dwordx4 a[36:39], v6, s[30:31] offset:2048
 v_add_u32 v6, 4096, v6
 global_load_dwordx4 a[40:43], v6, s[30:31] offset:0
 global_load_dwordx4 a[44:47], v6, s[30:31] offset:2048
 v_add_u32 v6, 4096, v6
 global_load_dwordx4 a[48:51], v6, s[30:31] offset:0
 global_load_dwordx4 a[52:55], v6, s[30:31] offset:2048
 v_add_u32 v6, 4096, v6
 global_load_dwordx4 a[56:59], v6, s[30:31] offset:0
 global_load_dwordx4 a[60:63], v6, s[30:31] offset:2048
 v_add_u32 v6, 4096, v6
 global_load_dwordx4 a[64:67], v6, s[30:31] offset:0
 global_load_dwordx4 a[68:71], v6, s[30:31] offset:2048
 v_add_u32 v6, 4096, v6
 global_load_dwordx4 a[72:75], v6, s[30:31] offset:0
 global_load_dwordx4 a[76:79], v6, s[30:31] offset:2048
 v_add_u32 v6, 4096, v6
 global_load_dwordx4 a[80:83], v6, s[30:31] offset:0
 global_load_dwordx4 a[84:87], v6, s[30:31] offset:2048
 v_add_u32 v6, 4096, v6
 global_load_dwordx4 a[88:91], v6, s[30:31] offset:0
 global_load_dwordx4 a[92:95], v6, s[30:31] offset:2048
 v_add_u32 v6, 4096, v6
 global_load_dwordx4 a[96:99], v6, s[30:31] offset:0
 global_load_dwordx4 a[100:103], v6, s[30:31] offset:2048
 v_add_u32 v6, 4096, v6
 global_load_dwordx4 a[104:107], v6, s[30:31] offset:0
 global_load_dwordx4 a[108:111], v6, s[30:31] offset:2048
 v_add_u32 v6, 4096, v6
 global_load_dwordx4 a[112:115], v6, s[30:31] offset:0
 global_load_dwordx4 a[116:119], v6, s[30:31] offset:2048
 v_add_u32 v6, 4096, v6
 global_load_dwordx4 a[120:123], v6, s[30:31] offset:0
 global_load_dwordx4 a[124:127], v6, s[30:31] offset:2048
 v_add_u32 v6, 4096, v6
 global_load_dwordx4 a[128:131], v6, s[30:31] offset:0
 global_load_dwordx4 a[132:135], v6, s[30:31] offset:2048
 v_add_u32 v6, 4096, v6
 global_load_dwordx4 a[136:139], v6, s[30:31] offset:0
 global_load_dwordx4 a[140:143], v6, s[30:31] offset:2048
 v_add_u32 v6, 4096, v6
 global_load_dwordx4 a[144:147], v6, s[30:31] offset:0
 global_load_dwordx4 a[148:151], v6, s[30:31] offset:2048
 v_add_u32 v6, 4096, v6
 global_load_dwordx4 a[152:155], v6, s[30:31] offset:0
 global_load_dwordx4 a[156:159], v6, s[30:31] offset:2048
 v_add_u32 v6, 4096, v6
 global_load_dwordx4 a[160:163], v6, s[30:31] offset:0
 global_load_dwordx4 a[164:167], v6, s[30:31] offset:2048
 v_add_u32 v6, 4096, v6
 global_load_dwordx4 a[168:171], v6, s[30:31] offset:0
 global_load_dwordx4 a[172:175], v6, s[30:31] offset:2048
 v_add_u32 v6, 4096, v6
 global_load_dwordx4 a[176:179], v6, s[30:31] offset:0
 global_load_dwordx4 a[180:183], v6, s[30:31] offset:2048
 v_add_u32 v6, 4096, v6
 global_load_dwordx4 a[184:187], v6, s[30:31] offset:0
 global_load_dwordx4 a[188:191], v6, s[30:31] offset:2048
 v_add_u32 v6, 4096, v6
 global_load_dwordx4 a[192:195], v6, s[30:31] offset:0
 global_load_dwordx4 a[196:199], v6, s[30:31] offset:2048
 v_add_u32 v6, 4096, v6
 global_load_dwordx4 a[200:203], v6, s[30:31] offset:0
 global_load_dwordx4 a[204:207], v6, s[30:31] offset:2048
 v_add_u32 v6, 4096, v6
 global_load_dwordx4 a[208:211], v6, s[30:31] offset:0
 global_load_dwordx4 a[212:215], v6, s[30:31] offset:2048
 v_add_u32 v6, 4096, v6
 global_load_dwordx4 a[216:219], v6, s[30:31] offset:0
 global_load_dwordx4 a[220:223], v6, s[30:31] offset:2048
 s_waitcnt vmcnt(30)
 s_cmp_ge_u32 s22, 14
 s_cbranch_scc1 PO_7
 global_load_dwordx4 v[128:131], v8, s[32:33] offset:0
 global_load_dwordx4 v[132:135], v8, s[32:33] offset:64
 global_load_dwordx4 v[136:139], v8, s[32:33] offset:2048
 global_load_dwordx4 v[140:143], v8, s[32:33] offset:2112
 v_add_u32 v8, 4096, v8
 global_load_dwordx4 v[144:147], v8, s[32:33] offset:0
 global_load_dwordx4 v[148:151], v8, s[32:33] offset:64
 global_load_dwordx4 v[152:155], v8, s[32:33] offset:2048
 global_load_dwordx4 v[156:159], v8, s[32:33] offset:2112
 v_add_u32 v8, 4096, v8
 global_load_dwordx4 v[160:163], v8, s[32:33] offset:0
 global_load_dwordx4 v[164:167], v8, s[32:33] offset:64
 global_load_dwordx4 v[168:171], v8, s[32:33] offset:2048
 global_load_dwordx4 v[172:175], v8, s[32:33] offset:2112
 v_add_u32 v8, 4096, v8
 global_load_dwordx4 v[176:179], v8, s[32:33] offset:0
 global_load_dwordx4 v[180:183], v8, s[32:33] offset:64
 global_load_dwordx4 v[184:187], v8, s[32:33] offset:2048
 global_load_dwordx4 v[188:191], v8, s[32:33] offset:2112
 v_add_u32 v8, 4096, v8
 global_load_dwordx4 v[192:195], v8, s[32:33] offset:0
 global_load_dwordx4 v[196:199], v8, s[32:33] offset:64
 global_load_dwordx4 v[200:203], v8, s[32:33] offset:2048
 global_load_dwordx4 v[204:207], v8, s[32:33] offset:2112
 v_add_u32 v8, 4096, v8
 global_load_dwordx4 v[208:211], v8, s[32:33] offset:0
 global_load_dwordx4 v[212:215], v8, s[32:33] offset:64
 global_load_dwordx4 v[216:219], v8, s[32:33] offset:2048
 global_load_dwordx4 v[220:223], v8, s[32:33] offset:2112
 v_add_u32 v8, 4096, v8
 global_load_dwordx4 v[224:227], v8, s[32:33] offset:0
 global_load_dwordx4 v[228:231], v8, s[32:33] offset:64
 global_load_dwordx4 v[232:235], v8, s[32:33] offset:2048
 global_load_dwordx4 v[236:239], v8, s[32:33] offset:2112
 v_add_u32 v8, 4096, v8
 global_load_dwordx4 v[240:243], v8, s[32:33] offset:0
 global_load_dwordx4 v[244:247], v8, s[32:33] offset:64
 global_load_dwordx4 v[248:251], v8, s[32:33] offset:2048
 global_load_dwordx4 v[252:255], v8, s[32:33] offset:2112
 s_waitcnt vmcnt(32)
 s_branch PO_7_B
PO_7:
 s_waitcnt vmcnt(0)
PO_7_B:
 v_mfma_f32_16x16x32_bf16 a[224:227], v[16:19], a[0:3], 0
 v_mfma_f32_16x16x32_bf16 a[228:231], v[20:23], a[0:3], 0
 v_mfma_f32_16x16x32_bf16 a[232:235], v[16:19], a[56:59], 0
 v_mfma_f32_16x16x32_bf16 a[236:239], v[20:23], a[56:59], 0
 v_mfma_f32_16x16x32_bf16 a[240:243], v[16:19], a[112:115], 0
 v_mfma_f32_16x16x32_bf16 a[244:247], v[20:23], a[112:115], 0
 v_mfma_f32_16x16x32_bf16 a[248:251], v[16:19], a[168:171], 0
 v_mfma_f32_16x16x32_bf16 a[252:255], v[20:23], a[168:171], 0
 v_mfma_f32_16x16x32_bf16 a[224:227], v[24:27], a[4:7], a[224:227]
 v_mfma_f32_16x16x32_bf16 a[228:231], v[28:31], a[4:7], a[228:231]
 v_mfma_f32_16x16x32_bf16 a[232:235], v[24:27], a[60:63], a[232:235]
 v_mfma_f32_16x16x32_bf16 a[236:239], v[28:31], a[60:63], a[236:239]
 v_mfma_f32_16x16x32_bf16 a[240:243], v[24:27], a[116:119], a[240:243]
 v_mfma_f32_16x16x32_bf16 a[244:247], v[28:31], a[116:119], a[244:247]
 v_mfma_f32_16x16x32_bf16 a[248:251], v[24:27], a[172:175], a[248:251]
 v_mfma_f32_16x16x32_bf16 a[252:255], v[28:31], a[172:175], a[252:255]
 v_mfma_f32_16x16x32_bf16 a[224:227], v[32:35], a[8:11], a[224:227]
 v_mfma_f32_16x16x32_bf16 a[228:231], v[36:39], a[8:11], a[228:231]
 v_mfma_f32_16x16x32_bf16 a[232:235], v[32:35], a[64:67], a[232:235]
 v_mfma_f32_16x16x32_bf16 a[236:239], v[36:39], a[64:67], a[236:239]
 v_mfma_f32_16x16x32_bf16 a[240:243], v[32:35], a[120:123], a[240:243]
 v_mfma_f32_16x16x32_bf16 a[244:247], v[36:39], a[120:123], a[244:247]
 v_mfma_f32_16x16x32_bf16 a[248:251], v[32:35], a[176:179], a[248:251]
 v_mfma_f32_16x16x32_bf16 a[252:255], v[36:39], a[176:179], a[252:255]
 v_mfma_f32_16x16x32_bf16 a[224:227], v[40:43], a[12:15], a[224:227]
 v_mfma_f32_16x16x32_bf16 a[228:231], v[44:47], a[12:15], a[228:231]
 v_mfma_f32_16x16x32_bf16 a[232:235], v[40:43], a[68:71], a[232:235]
 v_mfma_f32_16x16x32_bf16 a[236:239], v[44:47], a[68:71], a[236:239]
 v_mfma_f32_16x16x32_bf16 a[240:243], v[40:43], a[124:127], a[240:243]
 v_mfma_f32_16x16x32_bf16 a[244:247], v[44:47], a[124:127], a[244:247]
 v_mfma_f32_16x16x32_bf16 a[248:251], v[40:43], a[180:183], a[248:251]
 v_mfma_f32_16x16x32_bf16 a[252:255], v[44:47], a[180:183], a[252:255]
 v_mfma_f32_16x16x32_bf16 a[224:227], v[48:51], a[16:19], a[224:227]
 v_mfma_f32_16x16x32_bf16 a[228:231], v[52:55], a[16:19], a[228:231]
 v_mfma_f32_16x16x32_bf16 a[232:235], v[48:51], a[72:75], a[232:235]
 v_mfma_f32_16x16x32_bf16 a[236:239], v[52:55], a[72:75], a[236:239]
 v_mfma_f32_16x16x32_bf16 a[240:243], v[48:51], a[128:131], a[240:243]
 v_mfma_f32_16x16x32_bf16 a[244:247], v[52:55], a[128:131], a[244:247]
 v_mfma_f32_16x16x32_bf16 a[248:251], v[48:51], a[184:187], a[248:251]
 v_mfma_f32_16x16x32_bf16 a[252:255], v[52:55], a[184:187], a[252:255]
 v_mfma_f32_16x16x32_bf16 a[224:227], v[56:59], a[20:23], a[224:227]
 v_mfma_f32_16x16x32_bf16 a[228:231], v[60:63], a[20:23], a[228:231]
 v_mfma_f32_16x16x32_bf16 a[232:235], v[56:59], a[76:79], a[232:235]
 v_mfma_f32_16x16x32_bf16 a[236:239], v[60:63], a[76:79], a[236:239]
 v_mfma_f32_16x16x32_bf16 a[240:243], v[56:59], a[132:135], a[240:243]
 v_mfma_f32_16x16x32_bf16 a[244:247], v[60:63], a[132:135], a[244:247]
 v_mfma_f32_16x16x32_bf16 a[248:251], v[56:59], a[188:191], a[248:251]
 v_mfma_f32_16x16x32_bf16 a[252:255], v[60:63], a[188:191], a[252:255]
 v_mfma_f32_16x16x32_bf16 a[224:227], v[64:67], a[24:27], a[224:227]
 v_mfma_f32_16x16x32_bf16 a[228:231], v[68:71], a[24:27], a[228:231]
 v_mfma_f32_16x16x32_bf16 a[232:235], v[64:67], a[80:83], a[232:235]
 v_mfma_f32_16x16x32_bf16 a[236:239], v[68:71], a[80:83], a[236:239]
 v_mfma_f32_16x16x32_bf16 a[240:243], v[64:67], a[136:139], a[240:243]
 v_mfma_f32_16x16x32_bf16 a[244:247], v[68:71], a[136:139], a[244:247]
 v_mfma_f32_16x16x32_bf16 a[248:251], v[64:67], a[192:195], a[248:251]
 v_mfma_f32_16x16x32_bf16 a[252:255], v[68:71], a[192:195], a[252:255]
 v_mfma_f32_16x16x32_bf16 a[224:227], v[72:75], a[28:31], a[224:227]
 v_mfma_f32_16x16x32_bf16 a[228:231], v[76:79], a[28:31], a[228:231]
 v_mfma_f32_16x16x32_bf16 a[232:235], v[72:75], a[84:87], a[232:235]
 v_mfma_f32_16x16x32_bf16 a[236:239], v[76:79], a[84:87], a[236:239]
 v_mfma_f32_16x16x32_bf16 a[240:243], v[72:75], a[140:143], a[240:243]
 v_mfma_f32_16x16x32_bf16 a[244:247], v[76:79], a[140:143], a[244:247]
 v_mfma_f32_16x16x32_bf16 a[248:251], v[72:75], a[196:199], a[248:251]
 v_mfma_f32_16x16x32_bf16 a[252:255], v[76:79], a[196:199], a[252:255]
 v_mfma_f32_16x16x32_bf16 a[224:227], v[80:83], a[32:35], a[224:227]
 v_mfma_f32_16x16x32_bf16 a[228:231], v[84:87], a[32:35], a[228:231]
 v_mfma_f32_16x16x32_bf16 a[232:235], v[80:83], a[88:91], a[232:235]
 v_mfma_f32_16x16x32_bf16 a[236:239], v[84:87], a[88:91], a[236:239]
 v_mfma_f32_16x16x32_bf16 a[240:243], v[80:83], a[144:147], a[240:243]
 v_mfma_f32_16x16x32_bf16 a[244:247], v[84:87], a[144:147], a[244:247]
 v_mfma_f32_16x16x32_bf16 a[248:251], v[80:83], a[200:203], a[248:251]
 v_mfma_f32_16x16x32_bf16 a[252:255], v[84:87], a[200:203], a[252:255]
 v_mfma_f32_16x16x32_bf16 a[224:227], v[88:91], a[36:39], a[224:227]
 v_mfma_f32_16x16x32_bf16 a[228:231], v[92:95], a[36:39], a[228:231]
 v_mfma_f32_16x16x32_bf16 a[232:235], v[88:91], a[92:95], a[232:235]
 v_mfma_f32_16x16x32_bf16 a[236:239], v[92:95], a[92:95], a[236:239]
 v_mfma_f32_16x16x32_bf16 a[240:243], v[88:91], a[148:151], a[240:243]
 v_mfma_f32_16x16x32_bf16 a[244:247], v[92:95], a[148:151], a[244:247]
 v_mfma_f32_16x16x32_bf16 a[248:251], v[88:91], a[204:207], a[248:251]
 v_mfma_f32_16x16x32_bf16 a[252:255], v[92:95], a[204:207], a[252:255]
 v_mfma_f32_16x16x32_bf16 a[224:227], v[96:99], a[40:43], a[224:227]
 v_mfma_f32_16x16x32_bf16 a[228:231], v[100:103], a[40:43], a[228:231]
 v_mfma_f32_16x16x32_bf16 a[232:235], v[96:99], a[96:99], a[232:235]
 v_mfma_f32_16x16x32_bf16 a[236:239], v[100:103], a[96:99], a[236:239]
 v_mfma_f32_16x16x32_bf16 a[240:243], v[96:99], a[152:155], a[240:243]
 v_mfma_f32_16x16x32_bf16 a[244:247], v[100:103], a[152:155], a[244:247]
 v_mfma_f32_16x16x32_bf16 a[248:251], v[96:99], a[208:211], a[248:251]
 v_mfma_f32_16x16x32_bf16 a[252:255], v[100:103], a[208:211], a[252:255]
 v_mfma_f32_16x16x32_bf16 a[224:227], v[104:107], a[44:47], a[224:227]
 v_mfma_f32_16x16x32_bf16 a[228:231], v[108:111], a[44:47], a[228:231]
 v_mfma_f32_16x16x32_bf16 a[232:235], v[104:107], a[100:103], a[232:235]
 v_mfma_f32_16x16x32_bf16 a[236:239], v[108:111], a[100:103], a[236:239]
 v_mfma_f32_16x16x32_bf16 a[240:243], v[104:107], a[156:159], a[240:243]
 v_mfma_f32_16x16x32_bf16 a[244:247], v[108:111], a[156:159], a[244:247]
 v_mfma_f32_16x16x32_bf16 a[248:251], v[104:107], a[212:215], a[248:251]
 v_mfma_f32_16x16x32_bf16 a[252:255], v[108:111], a[212:215], a[252:255]
 v_mfma_f32_16x16x32_bf16 a[224:227], v[112:115], a[48:51], a[224:227]
 v_mfma_f32_16x16x32_bf16 a[228:231], v[116:119], a[48:51], a[228:231]
 v_mfma_f32_16x16x32_bf16 a[232:235], v[112:115], a[104:107], a[232:235]
 v_mfma_f32_16x16x32_bf16 a[236:239], v[116:119], a[104:107], a[236:239]
 v_mfma_f32_16x16x32_bf16 a[240:243], v[112:115], a[160:163], a[240:243]
 v_mfma_f32_16x16x32_bf16 a[244:247], v[116:119], a[160:163], a[244:247]
 v_mfma_f32_16x16x32_bf16 a[248:251], v[112:115], a[216:219], a[248:251]
 v_mfma_f32_16x16x32_bf16 a[252:255], v[116:119], a[216:219], a[252:255]
 v_mfma_f32_16x16x32_bf16 a[224:227], v[120:123], a[52:55], a[224:227]
 v_mfma_f32_16x16x32_bf16 a[228:231], v[124:127], a[52:55], a[228:231]
 v_mfma_f32_16x16x32_bf16 a[232:235], v[120:123], a[108:111], a[232:235]
 v_mfma_f32_16x16x32_bf16 a[236:239], v[124:127], a[108:111], a[236:239]
 v_mfma_f32_16x16x32_bf16 a[240:243], v[120:123], a[164:167], a[240:243]
 v_mfma_f32_16x16x32_bf16 a[244:247], v[124:127], a[164:167], a[244:247]
 v_mfma_f32_16x16x32_bf16 a[248:251], v[120:123], a[220:223], a[248:251]
 v_mfma_f32_16x16x32_bf16 a[252:255], v[124:127], a[220:223], a[252:255]
 s_lshl_b32 s24, s21, 4
 v_and_b32 v10, 1, v4
 v_lshlrev_b32 v10, 4, v10
 v_lshrrev_b32 v11, 1, v4
 v_lshl_add_u32 v10, v11, 2, v10
 v_sub_u32 v10, v3, v10
 v_add_u32 v10, s24, v10
 v_mov_b32 v11, 0xff800000
 v_cmp_gt_i32 s[60:61], 0, v10
 v_cmp_gt_i32 s[62:63], 1, v10
 v_cmp_gt_i32 s[64:65], 2, v10
 v_cmp_gt_i32 s[66:67], 3, v10
 v_cmp_gt_i32 s[68:69], 8, v10
 v_cmp_gt_i32 s[70:71], 9, v10
 v_cmp_gt_i32 s[72:73], 10, v10
 v_cmp_gt_i32 s[74:75], 11, v10
 v_accvgpr_read_b32 v64, a224
 v_cndmask_b32 v64, v64, v11, s[60:61]
 v_accvgpr_read_b32 v65, a225
 v_cndmask_b32 v65, v65, v11, s[62:63]
 v_accvgpr_read_b32 v66, a226
 v_cndmask_b32 v66, v66, v11, s[64:65]
 v_accvgpr_read_b32 v67, a227
 v_cndmask_b32 v67, v67, v11, s[66:67]
 v_accvgpr_read_b32 v68, a228
 v_cndmask_b32 v68, v68, v11, s[68:69]
 v_accvgpr_read_b32 v69, a229
 v_cndmask_b32 v69, v69, v11, s[70:71]
 v_accvgpr_read_b32 v70, a230
 v_cndmask_b32 v70, v70, v11, s[72:73]
 v_accvgpr_read_b32 v71, a231
 v_cndmask_b32 v71, v71, v11, s[74:75]
 v_accvgpr_read_b32 v72, a232
 v_cndmask_b32 v72, v72, v11, s[60:61]
 v_accvgpr_read_b32 v73, a233
 v_cndmask_b32 v73, v73, v11, s[62:63]
 v_accvgpr_read_b32 v74, a234
 v_cndmask_b32 v74, v74, v11, s[64:65]
 v_accvgpr_read_b32 v75, a235
 v_cndmask_b32 v75, v75, v11, s[66:67]
 v_accvgpr_read_b32 v76, a236
 v_cndmask_b32 v76, v76, v11, s[68:69]
 v_accvgpr_read_b32 v77, a237
 v_cndmask_b32 v77, v77, v11, s[70:71]
 v_accvgpr_read_b32 v78, a238
 v_cndmask_b32 v78, v78, v11, s[72:73]
 v_accvgpr_read_b32 v79, a239
 v_cndmask_b32 v79, v79, v11, s[74:75]
 v_accvgpr_read_b32 v80, a240
 v_cndmask_b32 v80, v80, v11, s[60:61]
 v_accvgpr_read_b32 v81, a241
 v_cndmask_b32 v81, v81, v11, s[62:63]
 v_accvgpr_read_b32 v82, a242
 v_cndmask_b32 v82, v82, v11, s[64:65]
 v_accvgpr_read_b32 v83, a243
 v_cndmask_b32 v83, v83, v11, s[66:67]
 v_accvgpr_read_b32 v84, a244
 v_cndmask_b32 v84, v84, v11, s[68:69]
 v_accvgpr_read_b32 v85, a245
 v_cndmask_b32 v85, v85, v11, s[70:71]
 v_accvgpr_read_b32 v86, a246
 v_cndmask_b32 v86, v86, v11, s[72:73]
 v_accvgpr_read_b32 v87, a247
 v_cndmask_b32 v87, v87, v11, s[74:75]
 v_accvgpr_read_b32 v88, a248
 v_cndmask_b32 v88, v88, v11, s[60:61]
 v_accvgpr_read_b32 v89, a249
 v_cndmask_b32 v89, v89, v11, s[62:63]
 v_accvgpr_read_b32 v90, a250
 v_cndmask_b32 v90, v90, v11, s[64:65]
 v_accvgpr_read_b32 v91, a251
 v_cndmask_b32 v91, v91, v11, s[66:67]
 v_accvgpr_read_b32 v92, a252
 v_cndmask_b32 v92, v92, v11, s[68:69]
 v_accvgpr_read_b32 v93, a253
 v_cndmask_b32 v93, v93, v11, s[70:71]
 v_accvgpr_read_b32 v94, a254
 v_cndmask_b32 v94, v94, v11, s[72:73]
 v_accvgpr_read_b32 v95, a255
 v_cndmask_b32 v95, v95, v11, s[74:75]
 v_max3_f32 v96, v64, v65, v66
 v_max3_f32 v96, v96, v67, v68
 v_max3_f32 v96, v96, v69, v70
 v_max_f32 v96, v96, v71
 v_max3_f32 v97, v72, v73, v74
 v_max3_f32 v97, v97, v75, v76
 v_max3_f32 v97, v97, v77, v78
 v_max_f32 v97, v97, v79
 v_max3_f32 v98, v80, v81, v82
 v_max3_f32 v98, v98, v83, v84
 v_max3_f32 v98, v98, v85, v86
 v_max_f32 v98, v98, v87
 v_max3_f32 v99, v88, v89, v90
 v_max3_f32 v99, v99, v91, v92
 v_max3_f32 v99, v99, v93, v94
 v_max_f32 v99, v99, v95
 v_permlane32_swap_b32 v96, v98
 v_max_f32 v96, v96, v98
 v_permlane32_swap_b32 v97, v99
 v_max_f32 v97, v97, v99
 v_mov_b32 v44, 0
 v_mov_b32 v45, 0
 v_mov_b32 v46, 0
 v_mov_b32 v47, 0
 v_mov_b32 v48, 0
 v_mov_b32 v49, 0
 v_mov_b32 v50, 0
 v_mov_b32 v51, 0
 v_mov_b32 v52, 0
 v_mov_b32 v53, 0
 v_mov_b32 v54, 0
 v_mov_b32 v55, 0
 v_mov_b32 v56, 0
 v_mov_b32 v57, 0
 v_mov_b32 v58, 0
 v_mov_b32 v59, 0
 v_mov_b32 v113, 0x4444
 v_mov_b32 v116, 0xeeee
 v_cmp_gt_u32 vcc, 8, v3
 s_nop 1
 v_cndmask_b32 v113, v116, v113, vcc
 s_mov_b32 s43, 1035512379
 s_mul_i32 s24, s20, 7168
 s_add_u32 s24, s24, 85131264
 s_add_u32 s36, s4, s24
 s_addc_u32 s37, s5, 0
 v_lshlrev_b32 v5, 4, v2
 v_add_u32 v6, 4096, v5
 s_cmp_eq_u32 s20, 0
 s_cbranch_scc1 PO_8
 s_mul_i32 s24, s20, 7168
 s_add_u32 s24, s24, 85131260
 v_mov_b32 v10, s24
 s_mov_b32 s41, 0
PS_9:
 global_load_dword v12, v10, s[4:5] sc1
 s_add_u32 s41, s41, 1
 s_cmp_gt_u32 s41, 2000000
 s_cbranch_scc1 K2_EXIT
 s_waitcnt vmcnt(0)
 v_readfirstlane_b32 s42, v12
 s_cmp_lg_u32 s42, -1
 s_cbranch_scc1 PS_9_D
 s_sleep 8
 s_branch PS_9
PS_9_D:
PO_8:
 s_mov_b32 s41, 0
PM_10:
 global_load_dwordx4 v[16:19], v5, s[36:37] offset:0 sc1
 global_load_dwordx4 v[20:23], v5, s[36:37] offset:1024 sc1
 global_load_dwordx4 v[24:27], v5, s[36:37] offset:2048 sc1
 global_load_dwordx4 v[28:31], v5, s[36:37] offset:3072 sc1
 global_load_dwordx4 v[32:35], v6, s[36:37] offset:0 sc1
 global_load_dwordx4 v[36:39], v6, s[36:37] offset:1024 sc1
 global_load_dwordx4 v[40:43], v6, s[36:37] offset:2048 sc1
 s_add_u32 s41, s41, 1
 s_cmp_gt_u32 s41, 2000000
 s_cbranch_scc1 K2_EXIT
 s_waitcnt vmcnt(0)
 v_max_u32 v12, v16, v17
 v_max3_u32 v12, v12, v18, v19
 v_max3_u32 v12, v12, v20, v21
 v_max3_u32 v12, v12, v22, v23
 v_max3_u32 v12, v12, v24, v25
 v_max3_u32 v12, v12, v26, v27
 v_max3_u32 v12, v12, v28, v29
 v_max3_u32 v12, v12, v30, v31
 v_max3_u32 v12, v12, v32, v33
 v_max3_u32 v12, v12, v34, v35
 v_max3_u32 v12, v12, v36, v37
 v_max3_u32 v12, v12, v38, v39
 v_max3_u32 v12, v12, v40, v41
 v_max3_u32 v12, v12, v42, v43
 v_cmp_eq_u32 vcc, -1, v12
 s_cbranch_vccnz PM_10
 v_smfmac_f32_16x16x64_bf16 v[44:47], v[16:19], a[0:7], v113
 v_smfmac_f32_16x16x64_bf16 v[48:51], v[16:19], a[56:63], v113
 v_smfmac_f32_16x16x64_bf16 v[52:55], v[16:19], a[112:119], v113
 v_smfmac_f32_16x16x64_bf16 v[56:59], v[16:19], a[168:175], v113
 v_smfmac_f32_16x16x64_bf16 v[44:47], v[20:23], a[8:15], v113
 v_smfmac_f32_16x16x64_bf16 v[48:51], v[20:23], a[64:71], v113
 v_smfmac_f32_16x16x64_bf16 v[52:55], v[20:23], a[120:127], v113
 v_smfmac_f32_16x16x64_bf16 v[56:59], v[20:23], a[176:183], v113
 v_smfmac_f32_16x16x64_bf16 v[44:47], v[24:27], a[16:23], v113
 v_smfmac_f32_16x16x64_bf16 v[48:51], v[24:27], a[72:79], v113
 v_smfmac_f32_16x16x64_bf16 v[52:55], v[24:27], a[128:135], v113
 v_smfmac_f32_16x16x64_bf16 v[56:59], v[24:27], a[184:191], v113
 v_smfmac_f32_16x16x64_bf16 v[44:47], v[28:31], a[24:31], v113
 v_smfmac_f32_16x16x64_bf16 v[48:51], v[28:31], a[80:87], v113
 v_smfmac_f32_16x16x64_bf16 v[52:55], v[28:31], a[136:143], v113
 v_smfmac_f32_16x16x64_bf16 v[56:59], v[28:31], a[192:199], v113
 v_smfmac_f32_16x16x64_bf16 v[44:47], v[32:35], a[32:39], v113
 v_smfmac_f32_16x16x64_bf16 v[48:51], v[32:35], a[88:95], v113
 v_smfmac_f32_16x16x64_bf16 v[52:55], v[32:35], a[144:151], v113
 v_smfmac_f32_16x16x64_bf16 v[56:59], v[32:35], a[200:207], v113
 v_smfmac_f32_16x16x64_bf16 v[44:47], v[36:39], a[40:47], v113
 v_smfmac_f32_16x16x64_bf16 v[48:51], v[36:39], a[96:103], v113
 v_smfmac_f32_16x16x64_bf16 v[52:55], v[36:39], a[152:159], v113
 v_smfmac_f32_16x16x64_bf16 v[56:59], v[36:39], a[208:215], v113
 v_smfmac_f32_16x16x64_bf16 v[44:47], v[40:43], a[48:55], v113
 v_smfmac_f32_16x16x64_bf16 v[48:51], v[40:43], a[104:111], v113
 v_smfmac_f32_16x16x64_bf16 v[52:55], v[40:43], a[160:167], v113
 v_smfmac_f32_16x16x64_bf16 v[56:59], v[40:43], a[216:223], v113
 s_nop 3
 v_permlane32_swap_b32 v44, v52
 v_permlane32_swap_b32 v45, v53
 v_permlane32_swap_b32 v46, v54
 v_permlane32_swap_b32 v47, v55
 v_pk_add_f32 v[44:45], v[44:45], v[52:53]
 v_pk_add_f32 v[46:47], v[46:47], v[54:55]
 v_max3_f32 v96, v96, v44, v45
 v_max3_f32 v96, v96, v46, v47
 v_mov_b32 v100, v96
 s_nop 1
 v_permlane16_swap_b32 v96, v100
 v_max_f32 v96, v96, v100
 v_mul_f32 v96, s43, v96
 v_fma_f32 v44, v44, s43, -v96
 v_exp_f32 v44, v44
 v_fma_f32 v45, v45, s43, -v96
 v_exp_f32 v45, v45
 v_fma_f32 v46, v46, s43, -v96
 v_exp_f32 v46, v46
 v_fma_f32 v47, v47, s43, -v96
 v_exp_f32 v47, v47
 v_mov_b32 v100, v96
 s_nop 1
 v_permlane32_swap_b32 v96, v100
 v_fma_f32 v64, v64, s43, -v96
 v_exp_f32 v64, v64
 v_fma_f32 v65, v65, s43, -v96
 v_exp_f32 v65, v65
 v_fma_f32 v66, v66, s43, -v96
 v_exp_f32 v66, v66
 v_fma_f32 v67, v67, s43, -v96
 v_exp_f32 v67, v67
 v_fma_f32 v68, v68, s43, -v96
 v_exp_f32 v68, v68
 v_fma_f32 v69, v69, s43, -v96
 v_exp_f32 v69, v69
 v_fma_f32 v70, v70, s43, -v96
 v_exp_f32 v70, v70
 v_fma_f32 v71, v71, s43, -v96
 v_exp_f32 v71, v71
 v_fma_f32 v80, v80, s43, -v100
 v_exp_f32 v80, v80
 v_fma_f32 v81, v81, s43, -v100
 v_exp_f32 v81, v81
 v_fma_f32 v82, v82, s43, -v100
 v_exp_f32 v82, v82
 v_fma_f32 v83, v83, s43, -v100
 v_exp_f32 v83, v83
 v_fma_f32 v84, v84, s43, -v100
 v_exp_f32 v84, v84
 v_fma_f32 v85, v85, s43, -v100
 v_exp_f32 v85, v85
 v_fma_f32 v86, v86, s43, -v100
 v_exp_f32 v86, v86
 v_fma_f32 v87, v87, s43, -v100
 v_exp_f32 v87, v87
 v_add_f32 v96, v64, v65
 v_add_f32 v96, v96, v66
 v_add_f32 v96, v96, v67
 v_add_f32 v96, v96, v68
 v_add_f32 v96, v96, v69
 v_add_f32 v96, v96, v70
 v_add_f32 v96, v96, v71
 v_add_f32 v100, v80, v81
 v_add_f32 v100, v100, v82
 v_add_f32 v100, v100, v83
 v_add_f32 v100, v100, v84
 v_add_f32 v100, v100, v85
 v_add_f32 v100, v100, v86
 v_add_f32 v100, v100, v87
 s_nop 1
 v_permlane32_swap_b32 v96, v100
 v_add_f32 v96, v96, v100
 v_add_f32 v100, v44, v45
 v_add_f32 v96, v96, v46
 v_add_f32 v100, v100, v47
 v_add_f32 v96, v96, v100
 v_mov_b32 v100, v96
 s_nop 1
 v_permlane16_swap_b32 v96, v100
 v_add_f32 v96, v96, v100
 v_rcp_f32 v96, v96
 s_nop 0
 v_mul_f32 v44, v44, v96
 v_mul_f32 v45, v45, v96
 v_mul_f32 v46, v46, v96
 v_mul_f32 v47, v47, v96
 v_cvt_pk_bf16_f32 v104, v44, v45
 v_cvt_pk_bf16_f32 v105, v46, v47
 v_mov_b32 v100, v96
 s_nop 1
 v_permlane32_swap_b32 v96, v100
 s_lshl_b32 s24, s16, 12
 v_add_u32 v6, s24, v5
 s_lshl_b32 s24, s16, 10
 v_add_u32 v7, s24, v5
 v_mul_f32 v64, v64, v96
 v_mul_f32 v65, v65, v96
 v_mul_f32 v66, v66, v96
 v_mul_f32 v67, v67, v96
 v_mul_f32 v68, v68, v96
 v_mul_f32 v69, v69, v96
 v_mul_f32 v70, v70, v96
 v_mul_f32 v71, v71, v96
 v_cvt_pk_bf16_f32 v64, v64, v65
 v_cvt_pk_bf16_f32 v65, v66, v67
 v_cvt_pk_bf16_f32 v66, v68, v69
 v_cvt_pk_bf16_f32 v67, v70, v71
 ds_write_b128 v6, v[64:67] offset:0
 v_mul_f32 v80, v80, v100
 v_mul_f32 v81, v81, v100
 v_mul_f32 v82, v82, v100
 v_mul_f32 v83, v83, v100
 v_mul_f32 v84, v84, v100
 v_mul_f32 v85, v85, v100
 v_mul_f32 v86, v86, v100
 v_mul_f32 v87, v87, v100
 v_cvt_pk_bf16_f32 v80, v80, v81
 v_cvt_pk_bf16_f32 v81, v82, v83
 v_cvt_pk_bf16_f32 v82, v84, v85
 v_cvt_pk_bf16_f32 v83, v86, v87
 ds_write_b128 v6, v[80:83] offset:2048
 v_permlane32_swap_b32 v48, v56
 v_permlane32_swap_b32 v49, v57
 v_permlane32_swap_b32 v50, v58
 v_permlane32_swap_b32 v51, v59
 v_pk_add_f32 v[48:49], v[48:49], v[56:57]
 v_pk_add_f32 v[50:51], v[50:51], v[58:59]
 v_max3_f32 v97, v97, v48, v49
 v_max3_f32 v97, v97, v50, v51
 v_mov_b32 v100, v97
 s_nop 1
 v_permlane16_swap_b32 v97, v100
 v_max_f32 v97, v97, v100
 v_mul_f32 v97, s43, v97
 v_fma_f32 v48, v48, s43, -v97
 v_exp_f32 v48, v48
 v_fma_f32 v49, v49, s43, -v97
 v_exp_f32 v49, v49
 v_fma_f32 v50, v50, s43, -v97
 v_exp_f32 v50, v50
 v_fma_f32 v51, v51, s43, -v97
 v_exp_f32 v51, v51
 v_mov_b32 v100, v97
 s_nop 1
 v_permlane32_swap_b32 v97, v100
 v_fma_f32 v72, v72, s43, -v97
 v_exp_f32 v72, v72
 v_fma_f32 v73, v73, s43, -v97
 v_exp_f32 v73, v73
 v_fma_f32 v74, v74, s43, -v97
 v_exp_f32 v74, v74
 v_fma_f32 v75, v75, s43, -v97
 v_exp_f32 v75, v75
 v_fma_f32 v76, v76, s43, -v97
 v_exp_f32 v76, v76
 v_fma_f32 v77, v77, s43, -v97
 v_exp_f32 v77, v77
 v_fma_f32 v78, v78, s43, -v97
 v_exp_f32 v78, v78
 v_fma_f32 v79, v79, s43, -v97
 v_exp_f32 v79, v79
 v_fma_f32 v88, v88, s43, -v100
 v_exp_f32 v88, v88
 v_fma_f32 v89, v89, s43, -v100
 v_exp_f32 v89, v89
 v_fma_f32 v90, v90, s43, -v100
 v_exp_f32 v90, v90
 v_fma_f32 v91, v91, s43, -v100
 v_exp_f32 v91, v91
 v_fma_f32 v92, v92, s43, -v100
 v_exp_f32 v92, v92
 v_fma_f32 v93, v93, s43, -v100
 v_exp_f32 v93, v93
 v_fma_f32 v94, v94, s43, -v100
 v_exp_f32 v94, v94
 v_fma_f32 v95, v95, s43, -v100
 v_exp_f32 v95, v95
 v_add_f32 v97, v72, v73
 v_add_f32 v97, v97, v74
 v_add_f32 v97, v97, v75
 v_add_f32 v97, v97, v76
 v_add_f32 v97, v97, v77
 v_add_f32 v97, v97, v78
 v_add_f32 v97, v97, v79
 v_add_f32 v100, v88, v89
 v_add_f32 v100, v100, v90
 v_add_f32 v100, v100, v91
 v_add_f32 v100, v100, v92
 v_add_f32 v100, v100, v93
 v_add_f32 v100, v100, v94
 v_add_f32 v100, v100, v95
 s_nop 1
 v_permlane32_swap_b32 v97, v100
 v_add_f32 v97, v97, v100
 v_add_f32 v100, v48, v49
 v_add_f32 v97, v97, v50
 v_add_f32 v100, v100, v51
 v_add_f32 v97, v97, v100
 v_mov_b32 v100, v97
 s_nop 1
 v_permlane16_swap_b32 v97, v100
 v_add_f32 v97, v97, v100
 v_rcp_f32 v97, v97
 s_nop 0
 v_mul_f32 v48, v48, v97
 v_mul_f32 v49, v49, v97
 v_mul_f32 v50, v50, v97
 v_mul_f32 v51, v51, v97
 v_cvt_pk_bf16_f32 v106, v48, v49
 v_cvt_pk_bf16_f32 v107, v50, v51
 v_mov_b32 v100, v97
 s_nop 1
 v_permlane32_swap_b32 v97, v100
 v_mul_f32 v72, v72, v97
 v_mul_f32 v73, v73, v97
 v_mul_f32 v74, v74, v97
 v_mul_f32 v75, v75, v97
 v_mul_f32 v76, v76, v97
 v_mul_f32 v77, v77, v97
 v_mul_f32 v78, v78, v97
 v_mul_f32 v79, v79, v97
 v_cvt_pk_bf16_f32 v72, v72, v73
 v_cvt_pk_bf16_f32 v73, v74, v75
 v_cvt_pk_bf16_f32 v74, v76, v77
 v_cvt_pk_bf16_f32 v75, v78, v79
 ds_write_b128 v6, v[72:75] offset:1024
 v_mul_f32 v88, v88, v100
 v_mul_f32 v89, v89, v100
 v_mul_f32 v90, v90, v100
 v_mul_f32 v91, v91, v100
 v_mul_f32 v92, v92, v100
 v_mul_f32 v93, v93, v100
 v_mul_f32 v94, v94, v100
 v_mul_f32 v95, v95, v100
 v_cvt_pk_bf16_f32 v88, v88, v89
 v_cvt_pk_bf16_f32 v89, v90, v91
 v_cvt_pk_bf16_f32 v90, v92, v93
 v_cvt_pk_bf16_f32 v91, v94, v95
 ds_write_b128 v6, v[88:91] offset:3072
 ds_write_b128 v7, v[104:107] offset:16384
 s_waitcnt lgkmcnt(0)
 s_barrier
 s_cmp_ge_u32 s22, 14
 s_cbranch_scc1 PE_11
 ds_read_b128 a[0:3], v5 offset:0
 ds_read_b128 a[4:7], v5 offset:1024
 ds_read_b128 a[8:11], v5 offset:2048
 ds_read_b128 a[12:15], v5 offset:3072
 ds_read_b128 a[16:19], v5 offset:4096
 ds_read_b128 a[20:23], v5 offset:5120
 ds_read_b128 a[24:27], v5 offset:6144
 ds_read_b128 a[28:31], v5 offset:7168
 ds_read_b128 a[32:35], v5 offset:8192
 ds_read_b128 a[36:39], v5 offset:9216
 ds_read_b128 a[40:43], v5 offset:10240
 ds_read_b128 a[44:47], v5 offset:11264
 ds_read_b128 a[48:51], v5 offset:12288
 ds_read_b128 a[52:55], v5 offset:13312
 ds_read_b128 a[56:59], v5 offset:14336
 ds_read_b128 a[60:63], v5 offset:15360
 ds_read_b128 a[64:67], v5 offset:16384
 ds_read_b128 a[68:71], v5 offset:17408
 ds_read_b128 a[72:75], v5 offset:18432
 ds_read_b128 a[76:79], v5 offset:19456
 s_waitcnt lgkmcnt(15)
 v_mfma_f32_16x16x32_bf16 v[96:99], v[128:131], a[0:3], 0
 v_mfma_f32_16x16x32_bf16 v[100:103], v[132:135], a[0:3], 0
 s_waitcnt lgkmcnt(15)
 v_mfma_f32_16x16x32_bf16 v[96:99], v[136:139], a[4:7], v[96:99]
 v_mfma_f32_16x16x32_bf16 v[100:103], v[140:143], a[4:7], v[100:103]
 s_waitcnt lgkmcnt(15)
 v_mfma_f32_16x16x32_bf16 v[96:99], v[144:147], a[8:11], v[96:99]
 v_mfma_f32_16x16x32_bf16 v[100:103], v[148:151], a[8:11], v[100:103]
 s_waitcnt lgkmcnt(15)
 v_mfma_f32_16x16x32_bf16 v[96:99], v[152:155], a[12:15], v[96:99]
 v_mfma_f32_16x16x32_bf16 v[100:103], v[156:159], a[12:15], v[100:103]
 s_waitcnt lgkmcnt(15)
 v_mfma_f32_16x16x32_bf16 v[96:99], v[160:163], a[16:19], v[96:99]
 v_mfma_f32_16x16x32_bf16 v[100:103], v[164:167], a[16:19], v[100:103]
 s_waitcnt lgkmcnt(14)
 v_mfma_f32_16x16x32_bf16 v[96:99], v[168:171], a[20:23], v[96:99]
 v_mfma_f32_16x16x32_bf16 v[100:103], v[172:175], a[20:23], v[100:103]
 s_waitcnt lgkmcnt(13)
 v_mfma_f32_16x16x32_bf16 v[96:99], v[176:179], a[24:27], v[96:99]
 v_mfma_f32_16x16x32_bf16 v[100:103], v[180:183], a[24:27], v[100:103]
 s_waitcnt lgkmcnt(12)
 v_mfma_f32_16x16x32_bf16 v[96:99], v[184:187], a[28:31], v[96:99]
 v_mfma_f32_16x16x32_bf16 v[100:103], v[188:191], a[28:31], v[100:103]
 s_waitcnt lgkmcnt(11)
 v_mfma_f32_16x16x32_bf16 v[96:99], v[192:195], a[32:35], v[96:99]
 v_mfma_f32_16x16x32_bf16 v[100:103], v[196:199], a[32:35], v[100:103]
 s_waitcnt lgkmcnt(10)
 v_mfma_f32_16x16x32_bf16 v[96:99], v[200:203], a[36:39], v[96:99]
 v_mfma_f32_16x16x32_bf16 v[100:103], v[204:207], a[36:39], v[100:103]
 s_waitcnt lgkmcnt(9)
 v_mfma_f32_16x16x32_bf16 v[96:99], v[208:211], a[40:43], v[96:99]
 v_mfma_f32_16x16x32_bf16 v[100:103], v[212:215], a[40:43], v[100:103]
 s_waitcnt lgkmcnt(8)
 v_mfma_f32_16x16x32_bf16 v[96:99], v[216:219], a[44:47], v[96:99]
 v_mfma_f32_16x16x32_bf16 v[100:103], v[220:223], a[44:47], v[100:103]
 s_waitcnt lgkmcnt(7)
 v_mfma_f32_16x16x32_bf16 v[96:99], v[224:227], a[48:51], v[96:99]
 v_mfma_f32_16x16x32_bf16 v[100:103], v[228:231], a[48:51], v[100:103]
 s_waitcnt lgkmcnt(6)
 v_mfma_f32_16x16x32_bf16 v[96:99], v[232:235], a[52:55], v[96:99]
 v_mfma_f32_16x16x32_bf16 v[100:103], v[236:239], a[52:55], v[100:103]
 s_waitcnt lgkmcnt(5)
 v_mfma_f32_16x16x32_bf16 v[96:99], v[240:243], a[56:59], v[96:99]
 v_mfma_f32_16x16x32_bf16 v[100:103], v[244:247], a[56:59], v[100:103]
 s_waitcnt lgkmcnt(4)
 v_mfma_f32_16x16x32_bf16 v[96:99], v[248:251], a[60:63], v[96:99]
 v_mfma_f32_16x16x32_bf16 v[100:103], v[252:255], a[60:63], v[100:103]
 s_lshl_b32 s24, s20, 8
 s_lshl_b32 s25, s22, 4
 s_add_u32 s24, s24, s25
 s_add_u32 s24, s24, 85622784
 v_mov_b32 v10, s24
 s_mov_b32 s41, 0
PU_12:
 global_load_dwordx4 v[12:15], v10, s[4:5] sc1
 s_add_u32 s41, s41, 1
 s_cmp_gt_u32 s41, 2000000
 s_cbranch_scc1 K2_EXIT
 s_waitcnt vmcnt(0)
 v_min3_u32 v12, v12, v13, v14
 v_min_u32 v12, v12, v15
 s_nop 0
 v_readfirstlane_b32 s42, v12
 s_cmp_ge_u32 s42, 1
 s_cbranch_scc1 PU_12_D
 s_sleep 2
 s_branch PU_12
PU_12_D:
 s_mul_i32 s24, s20, 114688
 s_lshl_b32 s25, s22, 13
 s_add_u32 s24, s24, s25
 s_add_u32 s24, s24, 19070976
 s_add_u32 s36, s4, s24
 s_addc_u32 s37, s5, 0
 v_add_u32 v10, 4096, v9
 global_load_dwordx4 v[16:19], v9, s[36:37] offset:0 sc1
 global_load_dwordx4 v[20:23], v9, s[36:37] offset:64 sc1
 global_load_dwordx4 v[24:27], v9, s[36:37] offset:2048 sc1
 global_load_dwordx4 v[28:31], v9, s[36:37] offset:2112 sc1
 global_load_dwordx4 v[32:35], v10, s[36:37] offset:0 sc1
 global_load_dwordx4 v[36:39], v10, s[36:37] offset:64 sc1
 global_load_dwordx4 v[40:43], v10, s[36:37] offset:2048 sc1
 global_load_dwordx4 v[44:47], v10, s[36:37] offset:2112 sc1
 s_lshl_b32 s24, s20, 5
 s_lshl_b32 s25, s21, 4
 s_add_u32 s24, s24, s25
 s_mul_i32 s24, s24, 1792
 s_lshl_b32 s25, s22, 6
 s_add_u32 s24, s24, s25
 s_add_u32 s24, s24, 896
 s_add_u32 s30, s6, s24
 s_addc_u32 s31, s7, 0
 v_mul_u32_u24 v5, 1792, v3
 v_lshl_add_u32 v5, v4, 4, v5
 s_waitcnt lgkmcnt(0)
 s_waitcnt vmcnt(6)
 v_mfma_f32_16x16x32_bf16 v[96:99], v[16:19], a[64:67], v[96:99]
 v_mfma_f32_16x16x32_bf16 v[100:103], v[20:23], a[64:67], v[100:103]
 s_waitcnt vmcnt(4)
 v_mfma_f32_16x16x32_bf16 v[96:99], v[24:27], a[68:71], v[96:99]
 v_mfma_f32_16x16x32_bf16 v[100:103], v[28:31], a[68:71], v[100:103]
 s_waitcnt vmcnt(2)
 v_mfma_f32_16x16x32_bf16 v[96:99], v[32:35], a[72:75], v[96:99]
 v_mfma_f32_16x16x32_bf16 v[100:103], v[36:39], a[72:75], v[100:103]
 s_waitcnt vmcnt(0)
 v_mfma_f32_16x16x32_bf16 v[96:99], v[40:43], a[76:79], v[96:99]
 v_mfma_f32_16x16x32_bf16 v[100:103], v[44:47], a[76:79], v[100:103]
 s_nop 3
 v_cvt_pk_bf16_f32 v104, v96, v97
 v_cvt_pk_bf16_f32 v105, v98, v99
 s_nop 1
 v_cvt_pk_bf16_f32 v106, v100, v101
 v_cvt_pk_bf16_f32 v107, v102, v103
 global_store_dwordx4 v5, v[104:107], s[30:31]
PE_11:
 s_branch PPO_L
PPO_X:
K2_EXIT:
 s_waitcnt vmcnt(0)
 s_endpgm
K2_GAMMA:
 s_cmp_ge_u32 s17, 14
 s_cselect_b32 s45, 1, 0
 s_cselect_b32 s20, 14, 0
 s_sub_u32 s17, s17, s20
 s_mul_i32 s20, s17, 458752
 s_mul_i32 s21, s16, 114688
 s_add_u32 s20, s20, s21
 s_add_u32 s20, s20, 6422528
 s_add_u32 s36, s4, s20
 s_addc_u32 s37, s5, 0
 v_and_b32 v118, 63, v0
 v_lshlrev_b32 v118, 4, v118
 s_lshl_b32 s42, s16, 14
 s_add_u32 s42, s42, 0x18000
 v_add_u32 v119, 0, v118
 global_load_dwordx4 a[0:3], v119, s[36:37] offset:0
 global_load_dwordx4 a[4:7], v119, s[36:37] offset:1024
 global_load_dwordx4 a[8:11], v119, s[36:37] offset:2048
 global_load_dwordx4 a[12:15], v119, s[36:37] offset:3072
 v_add_u32 v119, 4096, v119
 global_load_dwordx4 a[16:19], v119, s[36:37] offset:0
 global_load_dwordx4 a[20:23], v119, s[36:37] offset:1024
 global_load_dwordx4 a[24:27], v119, s[36:37] offset:2048
 global_load_dwordx4 a[28:31], v119, s[36:37] offset:3072
 v_add_u32 v119, 4096, v119
 global_load_dwordx4 a[32:35], v119, s[36:37] offset:0
 global_load_dwordx4 a[36:39], v119, s[36:37] offset:1024
 global_load_dwordx4 a[40:43], v119, s[36:37] offset:2048
 global_load_dwordx4 a[44:47], v119, s[36:37] offset:3072
 v_add_u32 v119, 4096, v119
 s_add_u32 m0, s42, 0
 s_nop 0
 global_load_lds_dwordx4 v119, s[36:37] offset:0
 global_load_lds_dwordx4 v119, s[36:37] offset:1024
 v_add_u32 v119, 14336, v118
 global_load_dwordx4 a[48:51], v119, s[36:37] offset:0
 global_load_dwordx4 a[52:55], v119, s[36:37] offset:1024
 global_load_dwordx4 a[56:59], v119, s[36:37] offset:2048
 global_load_dwordx4 a[60:63], v119, s[36:37] offset:3072
 v_add_u32 v119, 4096, v119
 global_load_dwordx4 a[64:67], v119, s[36:37] offset:0
 global_load_dwordx4 a[68:71], v119, s[36:37] offset:1024
 global_load_dwordx4 a[72:75], v119, s[36:37] offset:2048
 global_load_dwordx4 a[76:79], v119, s[36:37] offset:3072
 v_add_u32 v119, 4096, v119
 global_load_dwordx4 a[80:83], v119, s[36:37] offset:0
 global_load_dwordx4 a[84:87], v119, s[36:37] offset:1024
 global_load_dwordx4 a[88:91], v119, s[36:37] offset:2048
 global_load_dwordx4 a[92:95], v119, s[36:37] offset:3072
 v_add_u32 v119, 4096, v119
 s_add_u32 m0, s42, 2048
 s_nop 0
 global_load_lds_dwordx4 v119, s[36:37] offset:0
 global_load_lds_dwordx4 v119, s[36:37] offset:1024
 v_add_u32 v119, 28672, v118
 global_load_dwordx4 a[96:99], v119, s[36:37] offset:0
 global_load_dwordx4 a[100:103], v119, s[36:37] offset:1024
 global_load_dwordx4 a[104:107], v119, s[36:37] offset:2048
 global_load_dwordx4 a[108:111], v119, s[36:37] offset:3072
 v_add_u32 v119, 4096, v119
 global_load_dwordx4 a[112:115], v119, s[36:37] offset:0
 global_load_dwordx4 a[116:119], v119, s[36:37] offset:1024
 global_load_dwordx4 a[120:123], v119, s[36:37] offset:2048
 global_load_dwordx4 a[124:127], v119, s[36:37] offset:3072
 v_add_u32 v119, 4096, v119
 global_load_dwordx4 a[128:131], v119, s[36:37] offset:0
 global_load_dwordx4 a[132:135], v119, s[36:37] offset:1024
 global_load_dwordx4 a[136:139], v119, s[36:37] offset:2048
 global_load_dwordx4 a[140:143], v119, s[36:37] offset:3072
 v_add_u32 v119, 4096, v119
 s_add_u32 m0, s42, 4096
 s_nop 0
 global_load_lds_dwordx4 v119, s[36:37] offset:0
 global_load_lds_dwordx4 v119, s[36:37] offset:1024
 v_add_u32 v119, 43008, v118
 global_load_dwordx4 a[144:147], v119, s[36:37] offset:0
 global_load_dwordx4 a[148:151], v119, s[36:37] offset:1024
 global_load_dwordx4 a[152:155], v119, s[36:37] offset:2048
 global_load_dwordx4 a[156:159], v119, s[36:37] offset:3072
 v_add_u32 v119, 4096, v119
 global_load_dwordx4 a[160:163], v119, s[36:37] offset:0
 global_load_dwordx4 a[164:167], v119, s[36:37] offset:1024
 global_load_dwordx4 a[168:171], v119, s[36:37] offset:2048
 global_load_dwordx4 a[172:175], v119, s[36:37] offset:3072
 v_add_u32 v119, 4096, v119
 global_load_dwordx4 a[176:179], v119, s[36:37] offset:0
 global_load_dwordx4 a[180:183], v119, s[36:37] offset:1024
 global_load_dwordx4 a[184:187], v119, s[36:37] offset:2048
 global_load_dwordx4 a[188:191], v119, s[36:37] offset:3072
 v_add_u32 v119, 4096, v119
 s_add_u32 m0, s42, 6144
 s_nop 0
 global_load_lds_dwordx4 v119, s[36:37] offset:0
 global_load_lds_dwordx4 v119, s[36:37] offset:1024
 v_add_u32 v119, 57344, v118
 global_load_dwordx4 a[192:195], v119, s[36:37] offset:0
 global_load_dwordx4 a[196:199], v119, s[36:37] offset:1024
 global_load_dwordx4 a[200:203], v119, s[36:37] offset:2048
 global_load_dwordx4 a[204:207], v119, s[36:37] offset:3072
 v_add_u32 v119, 4096, v119
 global_load_dwordx4 a[208:211], v119, s[36:37] offset:0
 global_load_dwordx4 a[212:215], v119, s[36:37] offset:1024
 global_load_dwordx4 a[216:219], v119, s[36:37] offset:2048
 global_load_dwordx4 a[220:223], v119, s[36:37] offset:3072
 v_add_u32 v119, 4096, v119
 global_load_dwordx4 a[224:227], v119, s[36:37] offset:0
 global_load_dwordx4 a[228:231], v119, s[36:37] offset:1024
 global_load_dwordx4 a[232:235], v119, s[36:37] offset:2048
 global_load_dwordx4 a[236:239], v119, s[36:37] offset:3072
 v_add_u32 v119, 4096, v119
 s_add_u32 m0, s42, 8192
 s_nop 0
 global_load_lds_dwordx4 v119, s[36:37] offset:0
 global_load_lds_dwordx4 v119, s[36:37] offset:1024
 v_add_u32 v119, 71680, v118
 global_load_dwordx4 a[240:243], v119, s[36:37] offset:0
 global_load_dwordx4 a[244:247], v119, s[36:37] offset:1024
 global_load_dwordx4 a[248:251], v119, s[36:37] offset:2048
 global_load_dwordx4 a[252:255], v119, s[36:37] offset:3072
 v_add_u32 v119, 4096, v119
 global_load_dwordx4 v[128:131], v119, s[36:37] offset:0
 global_load_dwordx4 v[132:135], v119, s[36:37] offset:1024
 global_load_dwordx4 v[136:139], v119, s[36:37] offset:2048
 global_load_dwordx4 v[140:143], v119, s[36:37] offset:3072
 v_add_u32 v119, 4096, v119
 global_load_dwordx4 v[144:147], v119, s[36:37] offset:0
 global_load_dwordx4 v[148:151], v119, s[36:37] offset:1024
 global_load_dwordx4 v[152:155], v119, s[36:37] offset:2048
 global_load_dwordx4 v[156:159], v119, s[36:37] offset:3072
 v_add_u32 v119, 4096, v119
 s_add_u32 m0, s42, 10240
 s_nop 0
 global_load_lds_dwordx4 v119, s[36:37] offset:0
 global_load_lds_dwordx4 v119, s[36:37] offset:1024
 v_add_u32 v119, 86016, v118
 global_load_dwordx4 v[160:163], v119, s[36:37] offset:0
 global_load_dwordx4 v[164:167], v119, s[36:37] offset:1024
 global_load_dwordx4 v[168:171], v119, s[36:37] offset:2048
 global_load_dwordx4 v[172:175], v119, s[36:37] offset:3072
 v_add_u32 v119, 4096, v119
 global_load_dwordx4 v[176:179], v119, s[36:37] offset:0
 global_load_dwordx4 v[180:183], v119, s[36:37] offset:1024
 global_load_dwordx4 v[184:187], v119, s[36:37] offset:2048
 global_load_dwordx4 v[188:191], v119, s[36:37] offset:3072
 v_add_u32 v119, 4096, v119
 global_load_dwordx4 v[192:195], v119, s[36:37] offset:0
 global_load_dwordx4 v[196:199], v119, s[36:37] offset:1024
 global_load_dwordx4 v[200:203], v119, s[36:37] offset:2048
 global_load_dwordx4 v[204:207], v119, s[36:37] offset:3072
 v_add_u32 v119, 4096, v119
 s_add_u32 m0, s42, 12288
 s_nop 0
 global_load_lds_dwordx4 v119, s[36:37] offset:0
 global_load_lds_dwordx4 v119, s[36:37] offset:1024
 v_add_u32 v119, 100352, v118
 global_load_dwordx4 v[208:211], v119, s[36:37] offset:0
 global_load_dwordx4 v[212:215], v119, s[36:37] offset:1024
 global_load_dwordx4 v[216:219], v119, s[36:37] offset:2048
 global_load_dwordx4 v[220:223], v119, s[36:37] offset:3072
 v_add_u32 v119, 4096, v119
 global_load_dwordx4 v[224:227], v119, s[36:37] offset:0
 global_load_dwordx4 v[228:231], v119, s[36:37] offset:1024
 global_load_dwordx4 v[232:235], v119, s[36:37] offset:2048
 global_load_dwordx4 v[236:239], v119, s[36:37] offset:3072
 v_add_u32 v119, 4096, v119
 global_load_dwordx4 v[240:243], v119, s[36:37] offset:0
 global_load_dwordx4 v[244:247], v119, s[36:37] offset:1024
 global_load_dwordx4 v[248:251], v119, s[36:37] offset:2048
 global_load_dwordx4 v[252:255], v119, s[36:37] offset:3072
 v_add_u32 v119, 4096, v119
 s_add_u32 m0, s42, 14336
 s_nop 0
 global_load_lds_dwordx4 v119, s[36:37] offset:0
 global_load_lds_dwordx4 v119, s[36:37] offset:1024
 v_and_b32 v118, 63, v0
 v_lshrrev_b32 v119, 4, v118
 v_and_b32 v117, 15, v118
 s_mul_i32 s20, s16, 112
 v_add_u32 v0, s20, v118
 v_add_u32 v1, 64, v0
 v_min_u32 v1, 447, v1
 v_lshlrev_b32 v0, 4, v0
 v_lshlrev_b32 v1, 4, v1
 v_lshlrev_b32 v2, 4, v118
 v_mov_b32 v113, 0x4444
 v_mov_b32 v116, 0xeeee
 v_cmp_gt_u32 vcc, 8, v117
 s_nop 1
 v_cndmask_b32 v113, v116, v113, vcc
 s_add_u32 s30, s4, 13762560
 s_addc_u32 s31, s5, 0
 s_add_u32 s32, s4, 14221312
 s_addc_u32 s33, s5, 0
 v_add_u32 v3, s42, v2
 s_lshl_b32 s42, s16, 13
 s_add_u32 s42, s42, 0x8000
 v_add_u32 v4, s42, v2
 s_lshl_b32 s20, s16, 13
 v_add_u32 v5, s20, v2
 v_add_u32 v6, 4096, v5
 s_lshl_b32 s20, s17, 15
 s_add_u32 s20, s20, 26411008
 s_add_u32 s34, s4, s20
 s_addc_u32 s35, s5, 0
 v_and_b32 v98, 1, v119
 v_lshrrev_b32 v99, 1, v119
 v_lshlrev_b32 v100, 5, v98
 v_lshl_add_u32 v100, v99, 4, v100
 v_add_u32 v100, v100, v117
 v_lshlrev_b32 v100, 4, v100
 s_lshl_b32 s20, s16, 11
 v_add_u32 v7, s20, v100
 s_lshl_b32 s20, s17, 13
 s_add_u32 s20, s20, 19070976
 s_add_u32 s46, s4, s20
 s_addc_u32 s47, s5, 0
 s_lshl_b32 s20, s16, 10
 s_add_u32 s20, s20, 0x2000
 v_lshlrev_b32 v100, 2, v118
 v_add_u32 v120, s20, v100
 s_lshl_b32 s20, s16, 8
 s_add_u32 s20, s20, 0x2000
 v_and_b32 v100, 31, v118
 v_lshlrev_b32 v101, 3, v100
 v_add_u32 v121, s20, v101
 v_bfe_u32 v101, v118, 4, 1
 v_bfe_u32 v102, v118, 3, 1
 v_lshlrev_b32 v102, 2, v102
 v_add_u32 v102, s16, v102
 v_lshlrev_b32 v102, 4, v102
 v_lshl_add_u32 v102, v101, 8, v102
 s_lshl_b32 s20, s17, 9
 v_add_u32 v102, s20, v102
 v_bfe_u32 v103, v118, 2, 1
 v_lshl_add_u32 v104, v103, 7, v102
 v_and_b32 v105, 3, v118
 v_lshl_add_u32 v122, v105, 2, v104
 v_add_u32 v122, 7168, v122
 v_add_u32 v123, 7168, v122
 v_mov_b32 v126, -1
 s_add_u32 s48, s4, 85131264
 s_addc_u32 s49, s5, 0
 s_lshl_b32 s20, s16, 11
 v_add_u32 v124, s20, v2
 v_lshlrev_b32 v102, 8, v99
 v_lshl_add_u32 v102, v117, 4, v102
 s_lshl_b32 s20, s16, 9
 s_add_u32 s20, s20, 8192
 v_add_u32 v125, s20, v102
 s_mov_b32 s44, 0x80008000
 s_lshl_b32 s20, s17, 4
 s_lshl_b32 s21, s16, 2
 s_add_u32 s20, s20, s21
 s_lshl_b32 s21, s45, 8
 s_add_u32 s20, s20, s21
 s_add_u32 s20, s20, 85622272
 v_mov_b32 v114, s20
 s_mul_i32 s20, s45, 7168
 s_add_u32 s30, s48, s20
 s_addc_u32 s31, s49, 0
 s_mul_i32 s20, s45, 114688
 s_add_u32 s46, s46, s20
 s_addc_u32 s47, s47, 0
 v_mov_b32 v36, 0
 v_mov_b32 v37, 0
 v_mov_b32 v38, 0
 v_mov_b32 v39, 0
 v_mov_b32 v40, 0
 v_mov_b32 v41, 0
 v_mov_b32 v42, 0
 v_mov_b32 v43, 0
 v_mov_b32 v44, 0
 v_mov_b32 v45, 0
 v_mov_b32 v46, 0
 v_mov_b32 v47, 0
 v_mov_b32 v48, 0
 v_mov_b32 v49, 0
 v_mov_b32 v50, 0
 v_mov_b32 v51, 0
GA_LOOP:
 s_mov_b32 s41, 0
GA_PM:
 global_load_dwordx4 v[104:107], v0, s[30:31] sc1
 global_load_dwordx4 v[108:111], v1, s[30:31] sc1
 s_add_u32 s41, s41, 1
 s_cmp_gt_u32 s41, 2000000
 s_cbranch_scc1 GA_EXIT
 s_waitcnt vmcnt(0)
 v_max3_u32 v116, v104, v105, v106
 v_max3_u32 v117, v107, v108, v109
 v_max3_u32 v116, v116, v110, v111
 v_max_u32 v116, v116, v117
 v_cmp_eq_u32 vcc, -1, v116
 s_cbranch_vccnz GA_PM
 ds_write_b128 v0, v[104:107]
 ds_write_b128 v1, v[108:111]
 s_waitcnt lgkmcnt(0)
 s_barrier
 s_cmp_eq_u32 s45, 63
 s_cbranch_scc1 GA_NF
 s_cmp_lt_u32 s45, 2
 s_cbranch_scc1 GA_NF
 global_store_dword v114, v113, s[4:5] sc1
GA_NF:
 v_add_u32 v114, 512, v114
 ds_read_b128 v[8:11], v2 offset:0
 ds_read_b128 v[12:15], v2 offset:1024
 ds_read_b128 v[16:19], v2 offset:2048
 ds_read_b128 v[20:23], v2 offset:3072
 ds_read_b128 v[24:27], v2 offset:4096
 ds_read_b128 v[28:31], v2 offset:5120
 ds_read_b128 v[32:35], v2 offset:6144
 ds_read_b128 v[52:55], v3 offset:0
 ds_read_b128 v[56:59], v3 offset:1024
 ds_read_b128 v[60:63], v3 offset:2048
 ds_read_b128 v[64:67], v3 offset:3072
 s_waitcnt lgkmcnt(10)
 v_smfmac_f32_16x16x64_bf16 v[36:39], v[8:11], a[0:7], v113
 v_smfmac_f32_16x16x64_bf16 v[40:43], v[8:11], a[48:55], v113
 s_waitcnt lgkmcnt(9)
 v_smfmac_f32_16x16x64_bf16 v[36:39], v[12:15], a[8:15], v113
 v_smfmac_f32_16x16x64_bf16 v[40:43], v[12:15], a[56:63], v113
 s_waitcnt lgkmcnt(8)
 v_smfmac_f32_16x16x64_bf16 v[36:39], v[16:19], a[16:23], v113
 v_smfmac_f32_16x16x64_bf16 v[40:43], v[16:19], a[64:71], v113
 s_waitcnt lgkmcnt(7)
 v_smfmac_f32_16x16x64_bf16 v[36:39], v[20:23], a[24:31], v113
 v_smfmac_f32_16x16x64_bf16 v[40:43], v[20:23], a[72:79], v113
 s_waitcnt lgkmcnt(6)
 v_smfmac_f32_16x16x64_bf16 v[36:39], v[24:27], a[32:39], v113
 v_smfmac_f32_16x16x64_bf16 v[40:43], v[24:27], a[80:87], v113
 s_waitcnt lgkmcnt(5)
 v_smfmac_f32_16x16x64_bf16 v[36:39], v[28:31], a[40:47], v113
 v_smfmac_f32_16x16x64_bf16 v[40:43], v[28:31], a[88:95], v113
 s_waitcnt lgkmcnt(0)
 v_smfmac_f32_16x16x64_bf16 v[36:39], v[32:35], v[52:59], v113
 v_smfmac_f32_16x16x64_bf16 v[40:43], v[32:35], v[60:67], v113
 ds_read_b128 v[52:55], v3 offset:4096
 ds_read_b128 v[56:59], v3 offset:5120
 ds_read_b128 v[60:63], v3 offset:6144
 ds_read_b128 v[64:67], v3 offset:7168
 v_smfmac_f32_16x16x64_bf16 v[44:47], v[8:11], a[96:103], v113
 v_smfmac_f32_16x16x64_bf16 v[48:51], v[8:11], a[144:151], v113
 v_smfmac_f32_16x16x64_bf16 v[44:47], v[12:15], a[104:111], v113
 v_smfmac_f32_16x16x64_bf16 v[48:51], v[12:15], a[152:159], v113
 v_smfmac_f32_16x16x64_bf16 v[44:47], v[16:19], a[112:119], v113
 v_permlane32_swap_b32 v36, v40
 v_permlane32_swap_b32 v37, v41
 v_permlane32_swap_b32 v38, v42
 v_smfmac_f32_16x16x64_bf16 v[48:51], v[16:19], a[160:167], v113
 v_permlane32_swap_b32 v39, v43
 v_pk_add_f32 v[36:37], v[36:37], v[40:41]
 v_pk_add_f32 v[38:39], v[38:39], v[42:43]
 v_smfmac_f32_16x16x64_bf16 v[44:47], v[20:23], a[120:127], v113
 v_cvt_pk_bf16_f32 v84, v36, v37
 v_cvt_pk_bf16_f32 v85, v38, v39
 v_mov_b32 v36, 0
 v_smfmac_f32_16x16x64_bf16 v[48:51], v[20:23], a[168:175], v113
 v_mov_b32 v37, 0
 v_mov_b32 v38, 0
 v_mov_b32 v39, 0
 v_smfmac_f32_16x16x64_bf16 v[44:47], v[24:27], a[128:135], v113
 v_mov_b32 v40, 0
 v_mov_b32 v41, 0
 v_mov_b32 v42, 0
 v_smfmac_f32_16x16x64_bf16 v[48:51], v[24:27], a[176:183], v113
 v_mov_b32 v43, 0
 v_smfmac_f32_16x16x64_bf16 v[44:47], v[28:31], a[136:143], v113
 v_smfmac_f32_16x16x64_bf16 v[48:51], v[28:31], a[184:191], v113
 s_waitcnt lgkmcnt(0)
 v_smfmac_f32_16x16x64_bf16 v[44:47], v[32:35], v[52:59], v113
 v_smfmac_f32_16x16x64_bf16 v[48:51], v[32:35], v[60:67], v113
 ds_read_b128 v[52:55], v3 offset:8192
 ds_read_b128 v[56:59], v3 offset:9216
 ds_read_b128 v[60:63], v3 offset:10240
 ds_read_b128 v[64:67], v3 offset:11264
 v_smfmac_f32_16x16x64_bf16 v[36:39], v[8:11], a[192:199], v113
 v_smfmac_f32_16x16x64_bf16 v[40:43], v[8:11], a[240:247], v113
 v_smfmac_f32_16x16x64_bf16 v[36:39], v[12:15], a[200:207], v113
 v_smfmac_f32_16x16x64_bf16 v[40:43], v[12:15], a[248:255], v113
 v_smfmac_f32_16x16x64_bf16 v[36:39], v[16:19], a[208:215], v113
 v_permlane32_swap_b32 v44, v48
 v_permlane32_swap_b32 v45, v49
 v_permlane32_swap_b32 v46, v50
 v_smfmac_f32_16x16x64_bf16 v[40:43], v[16:19], v[128:135], v113
 v_permlane32_swap_b32 v47, v51
 v_pk_add_f32 v[44:45], v[44:45], v[48:49]
 v_pk_add_f32 v[46:47], v[46:47], v[50:51]
 v_smfmac_f32_16x16x64_bf16 v[36:39], v[20:23], a[216:223], v113
 v_cvt_pk_bf16_f32 v86, v44, v45
 v_cvt_pk_bf16_f32 v87, v46, v47
 global_store_dwordx4 v7, v[84:87], s[46:47] offset:0 sc1
 v_smfmac_f32_16x16x64_bf16 v[40:43], v[20:23], v[136:143], v113
 v_mov_b32 v44, 0
 v_mov_b32 v45, 0
 v_mov_b32 v46, 0
 v_smfmac_f32_16x16x64_bf16 v[36:39], v[24:27], a[224:231], v113
 v_mov_b32 v47, 0
 v_mov_b32 v48, 0
 v_mov_b32 v49, 0
 v_smfmac_f32_16x16x64_bf16 v[40:43], v[24:27], v[144:151], v113
 v_mov_b32 v50, 0
 v_mov_b32 v51, 0
 v_smfmac_f32_16x16x64_bf16 v[36:39], v[28:31], a[232:239], v113
 v_smfmac_f32_16x16x64_bf16 v[40:43], v[28:31], v[152:159], v113
 s_waitcnt lgkmcnt(0)
 v_smfmac_f32_16x16x64_bf16 v[36:39], v[32:35], v[52:59], v113
 v_smfmac_f32_16x16x64_bf16 v[40:43], v[32:35], v[60:67], v113
 ds_read_b128 v[52:55], v3 offset:12288
 ds_read_b128 v[56:59], v3 offset:13312
 ds_read_b128 v[60:63], v3 offset:14336
 ds_read_b128 v[64:67], v3 offset:15360
 v_smfmac_f32_16x16x64_bf16 v[44:47], v[8:11], v[160:167], v113
 v_smfmac_f32_16x16x64_bf16 v[48:51], v[8:11], v[208:215], v113
 v_smfmac_f32_16x16x64_bf16 v[44:47], v[12:15], v[168:175], v113
 v_smfmac_f32_16x16x64_bf16 v[48:51], v[12:15], v[216:223], v113
 v_smfmac_f32_16x16x64_bf16 v[44:47], v[16:19], v[176:183], v113
 v_permlane32_swap_b32 v36, v40
 v_permlane32_swap_b32 v37, v41
 v_permlane32_swap_b32 v38, v42
 v_smfmac_f32_16x16x64_bf16 v[48:51], v[16:19], v[224:231], v113
 v_permlane32_swap_b32 v39, v43
 v_pk_add_f32 v[36:37], v[36:37], v[40:41]
 v_pk_add_f32 v[38:39], v[38:39], v[42:43]
 v_smfmac_f32_16x16x64_bf16 v[44:47], v[20:23], v[184:191], v113
 v_cvt_pk_bf16_f32 v88, v36, v37
 v_cvt_pk_bf16_f32 v89, v38, v39
 v_mov_b32 v36, 0
 v_smfmac_f32_16x16x64_bf16 v[48:51], v[20:23], v[232:239], v113
 v_mov_b32 v37, 0
 v_mov_b32 v38, 0
 v_mov_b32 v39, 0
 v_smfmac_f32_16x16x64_bf16 v[44:47], v[24:27], v[192:199], v113
 v_mov_b32 v40, 0
 v_mov_b32 v41, 0
 v_mov_b32 v42, 0
 v_smfmac_f32_16x16x64_bf16 v[48:51], v[24:27], v[240:247], v113
 v_mov_b32 v43, 0
 v_smfmac_f32_16x16x64_bf16 v[44:47], v[28:31], v[200:207], v113
 v_smfmac_f32_16x16x64_bf16 v[48:51], v[28:31], v[248:255], v113
 s_waitcnt lgkmcnt(0)
 v_smfmac_f32_16x16x64_bf16 v[44:47], v[32:35], v[52:59], v113
 v_smfmac_f32_16x16x64_bf16 v[48:51], v[32:35], v[60:67], v113
 s_nop 7
 v_permlane32_swap_b32 v44, v48
 v_permlane32_swap_b32 v45, v49
 v_permlane32_swap_b32 v46, v50
 v_permlane32_swap_b32 v47, v51
 v_pk_add_f32 v[44:45], v[44:45], v[48:49]
 v_pk_add_f32 v[46:47], v[46:47], v[50:51]
 v_cvt_pk_bf16_f32 v90, v44, v45
 v_cvt_pk_bf16_f32 v91, v46, v47
 global_store_dwordx4 v7, v[88:91], s[46:47] offset:1024 sc1
 v_mov_b32 v44, 0
 v_mov_b32 v45, 0
 v_mov_b32 v46, 0
 v_mov_b32 v47, 0
 v_mov_b32 v48, 0
 v_mov_b32 v49, 0
 v_mov_b32 v50, 0
 v_mov_b32 v51, 0
 s_add_u32 s46, s46, 229376
 s_addc_u32 s47, s47, 0
 s_add_u32 s30, s30, 14336
 s_addc_u32 s31, s31, 0
 s_add_u32 s45, s45, 2
 s_barrier
 s_cmp_lt_u32 s45, 63
 s_cbranch_scc1 GA_LOOP
 s_waitcnt vmcnt(0)
 global_store_dword v114, v113, s[4:5] sc1
GA_EXIT:
 s_waitcnt vmcnt(0)
 s_endpgm
K2_TEAM:
 s_add_u32 s20, s19, 1
 v_mov_b32 v2, s20
 s_lshl_b32 s20, s17, 2
 s_add_u32 s20, s20, 85590272
 v_mov_b32 v1, s20
 global_store_dword v1, v2, s[4:5] sc1
 s_cmp_ge_u32 s17, 30
 s_cbranch_scc1 ETA
 s_cmp_ge_u32 s17, 16
 s_cbranch_scc1 BETA
 s_mul_i32 s20, s17, 401408
 s_mul_i32 s21, s16, 100352
 s_add_u32 s20, s20, s21
 s_add_u32 s36, s4, s20
 s_addc_u32 s37, s5, 0
 v_and_b32 v119, 63, v0
 v_lshlrev_b32 v119, 4, v119
 s_cmp_eq_u32 s16, 1
 s_mov_b32 s22, 106181136
 s_cselect_b32 s22, 106172466, s22
 s_cmp_eq_u32 s16, 2
 s_cselect_b32 s22, 103944276, s22
 s_cmp_eq_u32 s16, 3
 s_cselect_b32 s22, 22295046, s22
 s_bfe_u32 s20, s22, 262144
 s_lshl_b32 s20, s20, 11
 v_add_u32 v118, s20, v119
 global_load_dwordx4 a[0:3], v118, s[36:37] offset:0
 global_load_dwordx4 a[4:7], v118, s[36:37] offset:1024
 v_add_u32 v118, 14336, v118
 global_load_dwordx4 a[56:59], v118, s[36:37] offset:0
 global_load_dwordx4 a[60:63], v118, s[36:37] offset:1024
 v_add_u32 v118, 14336, v118
 global_load_dwordx4 a[112:115], v118, s[36:37] offset:0
 global_load_dwordx4 a[116:119], v118, s[36:37] offset:1024
 v_add_u32 v118, 14336, v118
 global_load_dwordx4 a[168:171], v118, s[36:37] offset:0
 global_load_dwordx4 a[172:175], v118, s[36:37] offset:1024
 v_add_u32 v118, 14336, v118
 global_load_dwordx4 a[224:227], v118, s[36:37] offset:0
 global_load_dwordx4 a[228:231], v118, s[36:37] offset:1024
 v_add_u32 v118, 14336, v118
 global_load_dwordx4 v[144:147], v118, s[36:37] offset:0
 global_load_dwordx4 v[148:151], v118, s[36:37] offset:1024
 v_add_u32 v118, 14336, v118
 global_load_dwordx4 v[200:203], v118, s[36:37] offset:0
 global_load_dwordx4 v[204:207], v118, s[36:37] offset:1024
 s_bfe_u32 s20, s22, 262148
 s_lshl_b32 s20, s20, 11
 v_add_u32 v118, s20, v119
 global_load_dwordx4 a[8:11], v118, s[36:37] offset:0
 global_load_dwordx4 a[12:15], v118, s[36:37] offset:1024
 v_add_u32 v118, 14336, v118
 global_load_dwordx4 a[64:67], v118, s[36:37] offset:0
 global_load_dwordx4 a[68:71], v118, s[36:37] offset:1024
 v_add_u32 v118, 14336, v118
 global_load_dwordx4 a[120:123], v118, s[36:37] offset:0
 global_load_dwordx4 a[124:127], v118, s[36:37] offset:1024
 v_add_u32 v118, 14336, v118
 global_load_dwordx4 a[176:179], v118, s[36:37] offset:0
 global_load_dwordx4 a[180:183], v118, s[36:37] offset:1024
 v_add_u32 v118, 14336, v118
 global_load_dwordx4 a[232:235], v118, s[36:37] offset:0
 global_load_dwordx4 a[236:239], v118, s[36:37] offset:1024
 v_add_u32 v118, 14336, v118
 global_load_dwordx4 v[152:155], v118, s[36:37] offset:0
 global_load_dwordx4 v[156:159], v118, s[36:37] offset:1024
 v_add_u32 v118, 14336, v118
 global_load_dwordx4 v[208:211], v118, s[36:37] offset:0
 global_load_dwordx4 v[212:215], v118, s[36:37] offset:1024
 s_bfe_u32 s20, s22, 262152
 s_lshl_b32 s20, s20, 11
 v_add_u32 v118, s20, v119
 global_load_dwordx4 a[16:19], v118, s[36:37] offset:0
 global_load_dwordx4 a[20:23], v118, s[36:37] offset:1024
 v_add_u32 v118, 14336, v118
 global_load_dwordx4 a[72:75], v118, s[36:37] offset:0
 global_load_dwordx4 a[76:79], v118, s[36:37] offset:1024
 v_add_u32 v118, 14336, v118
 global_load_dwordx4 a[128:131], v118, s[36:37] offset:0
 global_load_dwordx4 a[132:135], v118, s[36:37] offset:1024
 v_add_u32 v118, 14336, v118
 global_load_dwordx4 a[184:187], v118, s[36:37] offset:0
 global_load_dwordx4 a[188:191], v118, s[36:37] offset:1024
 v_add_u32 v118, 14336, v118
 global_load_dwordx4 a[240:243], v118, s[36:37] offset:0
 global_load_dwordx4 a[244:247], v118, s[36:37] offset:1024
 v_add_u32 v118, 14336, v118
 global_load_dwordx4 v[160:163], v118, s[36:37] offset:0
 global_load_dwordx4 v[164:167], v118, s[36:37] offset:1024
 v_add_u32 v118, 14336, v118
 global_load_dwordx4 v[216:219], v118, s[36:37] offset:0
 global_load_dwordx4 v[220:223], v118, s[36:37] offset:1024
 s_bfe_u32 s20, s22, 262156
 s_lshl_b32 s20, s20, 11
 v_add_u32 v118, s20, v119
 global_load_dwordx4 a[24:27], v118, s[36:37] offset:0
 global_load_dwordx4 a[28:31], v118, s[36:37] offset:1024
 v_add_u32 v118, 14336, v118
 global_load_dwordx4 a[80:83], v118, s[36:37] offset:0
 global_load_dwordx4 a[84:87], v118, s[36:37] offset:1024
 v_add_u32 v118, 14336, v118
 global_load_dwordx4 a[136:139], v118, s[36:37] offset:0
 global_load_dwordx4 a[140:143], v118, s[36:37] offset:1024
 v_add_u32 v118, 14336, v118
 global_load_dwordx4 a[192:195], v118, s[36:37] offset:0
 global_load_dwordx4 a[196:199], v118, s[36:37] offset:1024
 v_add_u32 v118, 14336, v118
 global_load_dwordx4 a[248:251], v118, s[36:37] offset:0
 global_load_dwordx4 a[252:255], v118, s[36:37] offset:1024
 v_add_u32 v118, 14336, v118
 global_load_dwordx4 v[168:171], v118, s[36:37] offset:0
 global_load_dwordx4 v[172:175], v118, s[36:37] offset:1024
 v_add_u32 v118, 14336, v118
 global_load_dwordx4 v[224:227], v118, s[36:37] offset:0
 global_load_dwordx4 v[228:231], v118, s[36:37] offset:1024
 s_bfe_u32 s20, s22, 262160
 s_lshl_b32 s20, s20, 11
 v_add_u32 v118, s20, v119
 global_load_dwordx4 a[32:35], v118, s[36:37] offset:0
 global_load_dwordx4 a[36:39], v118, s[36:37] offset:1024
 v_add_u32 v118, 14336, v118
 global_load_dwordx4 a[88:91], v118, s[36:37] offset:0
 global_load_dwordx4 a[92:95], v118, s[36:37] offset:1024
 v_add_u32 v118, 14336, v118
 global_load_dwordx4 a[144:147], v118, s[36:37] offset:0
 global_load_dwordx4 a[148:151], v118, s[36:37] offset:1024
 v_add_u32 v118, 14336, v118
 global_load_dwordx4 a[200:203], v118, s[36:37] offset:0
 global_load_dwordx4 a[204:207], v118, s[36:37] offset:1024
 v_add_u32 v118, 14336, v118
 global_load_dwordx4 v[120:123], v118, s[36:37] offset:0
 global_load_dwordx4 v[124:127], v118, s[36:37] offset:1024
 v_add_u32 v118, 14336, v118
 global_load_dwordx4 v[176:179], v118, s[36:37] offset:0
 global_load_dwordx4 v[180:183], v118, s[36:37] offset:1024
 v_add_u32 v118, 14336, v118
 global_load_dwordx4 v[232:235], v118, s[36:37] offset:0
 global_load_dwordx4 v[236:239], v118, s[36:37] offset:1024
 s_bfe_u32 s20, s22, 262164
 s_lshl_b32 s20, s20, 11
 v_add_u32 v118, s20, v119
 global_load_dwordx4 a[40:43], v118, s[36:37] offset:0
 global_load_dwordx4 a[44:47], v118, s[36:37] offset:1024
 v_add_u32 v118, 14336, v118
 global_load_dwordx4 a[96:99], v118, s[36:37] offset:0
 global_load_dwordx4 a[100:103], v118, s[36:37] offset:1024
 v_add_u32 v118, 14336, v118
 global_load_dwordx4 a[152:155], v118, s[36:37] offset:0
 global_load_dwordx4 a[156:159], v118, s[36:37] offset:1024
 v_add_u32 v118, 14336, v118
 global_load_dwordx4 a[208:211], v118, s[36:37] offset:0
 global_load_dwordx4 a[212:215], v118, s[36:37] offset:1024
 v_add_u32 v118, 14336, v118
 global_load_dwordx4 v[128:131], v118, s[36:37] offset:0
 global_load_dwordx4 v[132:135], v118, s[36:37] offset:1024
 v_add_u32 v118, 14336, v118
 global_load_dwordx4 v[184:187], v118, s[36:37] offset:0
 global_load_dwordx4 v[188:191], v118, s[36:37] offset:1024
 v_add_u32 v118, 14336, v118
 global_load_dwordx4 v[240:243], v118, s[36:37] offset:0
 global_load_dwordx4 v[244:247], v118, s[36:37] offset:1024
 s_bfe_u32 s20, s22, 262168
 s_lshl_b32 s20, s20, 11
 v_add_u32 v118, s20, v119
 global_load_dwordx4 a[48:51], v118, s[36:37] offset:0
 global_load_dwordx4 a[52:55], v118, s[36:37] offset:1024
 v_add_u32 v118, 14336, v118
 global_load_dwordx4 a[104:107], v118, s[36:37] offset:0
 global_load_dwordx4 a[108:111], v118, s[36:37] offset:1024
 v_add_u32 v118, 14336, v118
 global_load_dwordx4 a[160:163], v118, s[36:37] offset:0
 global_load_dwordx4 a[164:167], v118, s[36:37] offset:1024
 v_add_u32 v118, 14336, v118
 global_load_dwordx4 a[216:219], v118, s[36:37] offset:0
 global_load_dwordx4 a[220:223], v118, s[36:37] offset:1024
 v_add_u32 v118, 14336, v118
 global_load_dwordx4 v[136:139], v118, s[36:37] offset:0
 global_load_dwordx4 v[140:143], v118, s[36:37] offset:1024
 v_add_u32 v118, 14336, v118
 global_load_dwordx4 v[192:195], v118, s[36:37] offset:0
 global_load_dwordx4 v[196:199], v118, s[36:37] offset:1024
 v_add_u32 v118, 14336, v118
 global_load_dwordx4 v[248:251], v118, s[36:37] offset:0
 global_load_dwordx4 v[252:255], v118, s[36:37] offset:1024
 s_add_u32 s36, s4, 85590272
 s_addc_u32 s37, s5, 0
 v_and_b32 v98, 63, v0
 v_min_u32 v98, 31, v98
 v_lshlrev_b32 v98, 2, v98
 s_mov_b32 s41, 0
AL_TS:
 global_load_dword v99, v98, s[36:37] sc1
 s_add_u32 s41, s41, 1
 s_cmp_gt_u32 s41, 2000000
 s_cbranch_scc1 AL_EXIT
 s_waitcnt vmcnt(0)
 v_cmp_eq_u32 vcc, 0, v99
 s_cbranch_vccnz AL_TS
 s_add_u32 s41, s19, 1
 v_cmp_ne_u32 vcc, s41, v99
 s_mov_b32 s40, 1
 s_cbranch_vccz AL_TS2
 s_mov_b32 s40, 0
AL_TS2:
 v_and_b32 v118, 63, v0
 v_lshrrev_b32 v119, 4, v118
 v_and_b32 v117, 15, v118
 s_mul_i32 s20, s16, 112
 v_add_u32 v0, s20, v118
 v_add_u32 v1, 64, v0
 v_min_u32 v1, 447, v1
 v_lshlrev_b32 v0, 4, v0
 v_lshlrev_b32 v1, 4, v1
 v_lshlrev_b32 v2, 4, v118
 v_mov_b32 v113, 0x4444
 v_mov_b32 v116, 0xeeee
 v_cmp_gt_u32 vcc, 8, v117
 s_nop 1
 v_cndmask_b32 v113, v116, v113, vcc
 s_add_u32 s30, s4, 13762560
 s_addc_u32 s31, s5, 0
 s_add_u32 s32, s4, 14221312
 s_addc_u32 s33, s5, 0
 s_mul_i32 s20, s16, 14
 v_add_u32 v3, s20, v119
 v_lshlrev_b32 v3, 7, v3
 v_and_b32 v116, 7, v118
 v_lshl_add_u32 v3, v116, 4, v3
 s_add_u32 s20, s20, 12
 v_lshrrev_b32 v4, 1, v119
 v_add_u32 v4, s20, v4
 v_lshlrev_b32 v4, 7, v4
 v_lshl_add_u32 v4, v116, 4, v4
 v_and_b32 v98, 1, v119
 v_lshl_add_u32 v4, v98, 3, v4
 s_mul_i32 s20, s16, 7168
 v_add_u32 v5, s20, v2
 v_add_u32 v6, 4096, v5
 s_lshl_b32 s42, s16, 13
 s_add_u32 s42, s42, 0x8000
 v_add_u32 v106, s42, v2
 v_lshrrev_b32 v100, 1, v119
 v_lshl_add_u32 v100, v100, 4, v117
 v_lshlrev_b32 v100, 4, v100
 v_lshl_add_u32 v100, v98, 3, v100
 v_add_u32 v100, 6144, v100
 v_add_u32 v107, s42, v100
 s_mul_i32 s20, s16, 3072
 s_add_u32 s20, s20, 0x4000
 v_add_u32 v108, s20, v2
 v_bfe_u32 v103, v118, 1, 3
 v_bfe_u32 v100, v118, 4, 1
 v_lshrrev_b32 v102, 5, v118
 v_and_b32 v104, 1, v118
 v_lshl_add_u32 v105, v102, 1, v104
 v_lshlrev_b32 v101, 10, v100
 v_lshl_add_u32 v101, v105, 8, v101
 v_lshl_add_u32 v101, v103, 4, v101
 v_add_u32 v109, 0x4000, v101
 v_lshlrev_b32 v101, 8, v100
 v_lshl_add_u32 v101, v103, 4, v101
 v_lshl_add_u32 v101, v105, 2, v101
 v_add_u32 v110, 0x4800, v101
 v_lshlrev_b32 v101, 3, v118
 s_lshl_b32 s20, s17, 9
 v_add_u32 v111, s20, v101
 v_lshlrev_b32 v101, 7, v102
 v_lshl_add_u32 v101, v103, 4, v101
 v_lshl_add_u32 v101, v100, 3, v101
 v_lshl_add_u32 v101, v104, 1, v101
 s_lshr_b32 s20, s17, 1
 s_lshl_b32 s20, s20, 8
 s_and_b32 s21, s17, 1
 s_lshl_b32 s21, s21, 2
 s_add_u32 s20, s20, s21
 s_add_u32 s20, s20, 8192
 v_add_u32 v112, s20, v101
 v_lshlrev_b32 v100, 2, v98
 v_sub_u32 v100, v117, v100
 v_mov_b32 v101, 0x3f80
 v_mov_b32 v102, 0x3f800000
 v_cmp_eq_u32 vcc, 0, v100
 s_nop 1
 v_cndmask_b32 v114, 0, v101, vcc
 v_cmp_eq_u32 vcc, 1, v100
 s_nop 1
 v_cndmask_b32 v114, v114, v102, vcc
 v_cmp_eq_u32 vcc, 2, v100
 s_nop 1
 v_cndmask_b32 v115, 0, v101, vcc
 v_cmp_eq_u32 vcc, 3, v100
 s_nop 1
 v_cndmask_b32 v115, v115, v102, vcc
 s_add_u32 s34, s4, 87490560
 s_addc_u32 s35, s5, 0
 s_mov_b32 s43, 1035512379
 s_mov_b32 s44, 0x7fff7fff
 s_mov_b32 s45, 0
 s_lshl_b32 s20, s16, 11
 v_add_u32 v0, s20, v2
 s_add_u32 s20, s20, 1024
 s_cmp_eq_u32 s16, 3
 s_cselect_b32 s20, 0, s20
 v_add_u32 v1, s20, v2
 s_bfe_u32 s20, s22, 262160
 s_lshl_b32 s20, s20, 10
 v_add_u32 v7, s20, v2
 s_bfe_u32 s20, s22, 262168
 s_lshl_b32 s20, s20, 10
 v_add_u32 v66, s20, v2
 s_bfe_u32 s20, s22, 262152
 s_lshl_b32 s20, s20, 10
 v_add_u32 v2, s20, v2
 s_mul_i32 s20, s17, 28672
 s_mul_i32 s21, s16, 7168
 s_add_u32 s20, s20, s21
 v_min_u32 v67, 55, v118
 v_lshlrev_b32 v67, 7, v67
 v_add_u32 v67, s20, v67
 s_add_u32 s48, s4, 26411008
 s_addc_u32 s49, s5, 0
 s_mov_b32 s38, s4
 s_mov_b32 s39, s5
 s_mov_b32 s59, 1
 s_mov_b32 s46, 0x00ff00ff
 s_mov_b32 s47, 0x00ff00ff
 v_mov_b64 v[56:57], 0
 v_mov_b64 v[58:59], 0
 v_mov_b64 v[60:61], 0
 v_mov_b64 v[62:63], 0
 v_mov_b64 v[64:65], 0
 v_mov_b64 v[116:117], 0
 v_mov_b64 v[118:119], 0
 s_add_u32 m0, s42, 0
 s_nop 0
 global_load_lds_dwordx4 v5, s[34:35] offset:0
 global_load_lds_dwordx4 v5, s[34:35] offset:1024
 global_load_lds_dwordx4 v5, s[34:35] offset:2048
 global_load_lds_dwordx4 v5, s[34:35] offset:3072
 s_add_u32 m0, s42, 4096
 s_nop 0
 global_load_lds_dwordx4 v6, s[34:35] offset:0
 global_load_lds_dwordx4 v6, s[34:35] offset:1024
 global_load_lds_dwordx4 v6, s[34:35] offset:2048
 s_add_u32 s34, s34, 28672
 s_addc_u32 s35, s35, 0
 s_xor_b32 s42, s42, 0x18000
 s_mov_b32 m0, 0x7000
 v_mov_b64 v[36:37], 0
 v_mov_b64 v[38:39], 0
 v_mov_b64 v[40:41], 0
 v_mov_b64 v[42:43], 0
 v_mov_b64 v[44:45], 0
 v_mov_b64 v[46:47], 0
 v_mov_b64 v[48:49], 0
 v_mov_b64 v[50:51], 0
 v_mov_b64 v[52:53], 0
 v_mov_b64 v[54:55], 0
 v_mov_b64 v[98:99], 0
 v_mov_b64 v[100:101], 0
 v_mov_b64 v[102:103], 0
 v_mov_b64 v[104:105], 0
AL_LOOP:
 s_mov_b32 s41, 0
AL_PM:
 global_load_dwordx4 v[8:11], v0, s[30:31] sc1
 global_load_dwordx4 v[12:15], v1, s[30:31] sc1
 s_add_u32 s41, s41, 1
 s_cmp_gt_u32 s41, 2000000
 s_cbranch_scc1 AL_EXIT
 s_waitcnt vmcnt(0)
 v_max3_u32 v32, v8, v9, v10
 v_max3_u32 v33, v11, v12, v13
 v_max3_u32 v32, v32, v14, v15
 v_max_u32 v32, v32, v33
 v_cmp_eq_u32 vcc, -1, v32
 s_cbranch_vccnz AL_PM
 ds_write_b128 v0, v[8:11]
 ds_write_b128 v1, v[12:15]
 v_smfmac_f32_16x16x64_bf16 v[36:39], v[8:11], a[0:7], v113
 v_smfmac_f32_16x16x64_bf16 v[40:43], v[8:11], a[56:63], v113
 v_smfmac_f32_16x16x64_bf16 v[44:47], v[8:11], v[200:207], v113
 s_waitcnt lgkmcnt(0)
 s_barrier
 v_smfmac_f32_16x16x64_bf16 v[48:51], v[8:11], a[112:119], v113
 ds_read_b128 v[16:19], v2 offset:0
 v_smfmac_f32_16x16x64_bf16 v[52:55], v[8:11], a[168:175], v113
 ds_read_b128 v[20:23], v2 offset:1024
 v_smfmac_f32_16x16x64_bf16 v[98:101], v[8:11], a[224:231], v113
 ds_read_b128 v[24:27], v7 offset:0
 v_smfmac_f32_16x16x64_bf16 v[102:105], v[8:11], v[144:151], v113
 ds_read_b128 v[28:31], v7 offset:1024
 v_smfmac_f32_16x16x64_bf16 v[36:39], v[12:15], a[8:15], v113
 ds_read_b128 v[32:35], v66 offset:0
 v_smfmac_f32_16x16x64_bf16 v[40:43], v[12:15], a[64:71], v113
 v_smfmac_f32_16x16x64_bf16 v[44:47], v[12:15], v[208:215], v113
 ds_read_b128 v[68:71], v106 offset:0
 v_smfmac_f32_16x16x64_bf16 v[48:51], v[12:15], a[120:127], v113
 ds_read_b128 v[72:75], v106 offset:1024
 v_smfmac_f32_16x16x64_bf16 v[52:55], v[12:15], a[176:183], v113
 ds_read_b128 v[76:79], v3 offset:0
 v_smfmac_f32_16x16x64_bf16 v[98:101], v[12:15], a[232:239], v113
 ds_read_b64 v[80:81], v107
 v_smfmac_f32_16x16x64_bf16 v[102:105], v[12:15], v[152:159], v113
 s_waitcnt lgkmcnt(7)
 v_smfmac_f32_16x16x64_bf16 v[36:39], v[16:19], a[16:23], v113
 ds_read_b64 v[82:83], v107 offset:512
 v_smfmac_f32_16x16x64_bf16 v[40:43], v[16:19], a[72:79], v113
 ds_read_b64 v[84:85], v4
 v_smfmac_f32_16x16x64_bf16 v[44:47], v[16:19], v[216:223], v113
 v_smfmac_f32_16x16x64_bf16 v[36:39], v[20:23], a[24:31], v113
 v_smfmac_f32_16x16x64_bf16 v[40:43], v[20:23], a[80:87], v113
 v_smfmac_f32_16x16x64_bf16 v[44:47], v[20:23], v[224:231], v113
 s_waitcnt lgkmcnt(6)
 v_smfmac_f32_16x16x64_bf16 v[36:39], v[24:27], a[32:39], v113
 v_smfmac_f32_16x16x64_bf16 v[40:43], v[24:27], a[88:95], v113
 v_smfmac_f32_16x16x64_bf16 v[44:47], v[24:27], v[232:239], v113
 v_smfmac_f32_16x16x64_bf16 v[36:39], v[28:31], a[40:47], v113
 v_smfmac_f32_16x16x64_bf16 v[40:43], v[28:31], a[96:103], v113
 v_smfmac_f32_16x16x64_bf16 v[44:47], v[28:31], v[240:247], v113
 s_waitcnt lgkmcnt(0)
 v_smfmac_f32_16x16x64_bf16 v[36:39], v[32:35], a[48:55], v113
 v_smfmac_f32_16x16x64_bf16 v[40:43], v[32:35], a[104:111], v113
 v_smfmac_f32_16x16x64_bf16 v[44:47], v[32:35], v[248:255], v113
 v_smfmac_f32_16x16x64_bf16 v[48:51], v[16:19], a[128:135], v113
 v_cvt_pk_bf16_f32 v56, v36, v37
 v_smfmac_f32_16x16x64_bf16 v[52:55], v[16:19], a[184:191], v113
 v_cvt_pk_bf16_f32 v57, v38, v39
 v_smfmac_f32_16x16x64_bf16 v[48:51], v[20:23], a[136:143], v113
 v_cvt_pk_bf16_f32 v60, v40, v41
 v_mfma_f32_16x16x32_bf16 v[36:39], v[56:59], v[114:117], 0
 v_cvt_pk_bf16_f32 v61, v42, v43
 v_cvt_pk_bf16_f32 v58, v44, v45
 v_smfmac_f32_16x16x64_bf16 v[52:55], v[20:23], a[192:199], v113
 v_cvt_pk_bf16_f32 v59, v46, v47
 v_mfma_f32_16x16x32_bf16 v[40:43], v[60:63], v[114:117], 0
 s_nop 0
 v_mfma_f32_16x16x32_bf16 v[44:47], v[58:61], v[114:117], 0
 v_cvt_pk_bf16_f32 v62, v36, v37
 v_cvt_pk_bf16_f32 v63, v38, v39
 v_smfmac_f32_16x16x64_bf16 v[48:51], v[24:27], a[144:151], v113
 v_smfmac_f32_16x16x64_bf16 v[52:55], v[24:27], a[200:207], v113
 v_cvt_pk_bf16_f32 v64, v40, v41
 v_smfmac_f32_16x16x64_bf16 v[48:51], v[28:31], a[152:159], v113
 v_cvt_pk_bf16_f32 v65, v42, v43
 v_smfmac_f32_16x16x64_bf16 v[52:55], v[28:31], a[208:215], v113
 v_cvt_pk_bf16_f32 v118, v44, v45
 v_mfma_f32_16x16x32_bf16 v[86:89], v[68:71], v[62:65], 0
 v_cvt_pk_bf16_f32 v119, v46, v47
 v_mfma_f32_16x16x32_bf16 v[90:93], v[72:75], v[62:65], 0
 ds_read_b128 v[68:71], v106 offset:2048
 v_mfma_f32_16x16x32_bf16 v[94:97], v[76:79], v[62:65], 0
 ds_read_b128 v[72:75], v106 offset:3072
 v_smfmac_f32_16x16x64_bf16 v[48:51], v[32:35], a[160:167], v113
 ds_read_b128 v[76:79], v3 offset:512
 v_smfmac_f32_16x16x64_bf16 v[52:55], v[32:35], a[216:223], v113
 v_mfma_f32_16x16x32_bf16 v[86:89], v[78:81], v[116:119], v[86:89]
 v_cvt_pk_bf16_f32 v56, v48, v49
 v_cvt_pk_bf16_f32 v57, v50, v51
 v_mfma_f32_16x16x32_bf16 v[90:93], v[80:83], v[116:119], v[90:93]
 v_mfma_f32_16x16x32_bf16 v[94:97], v[82:85], v[116:119], v[94:97]
 v_cvt_pk_bf16_f32 v60, v52, v53
 v_cvt_pk_bf16_f32 v61, v54, v55
 v_mfma_f32_16x16x32_bf16 v[48:51], v[56:59], v[114:117], 0
 v_smfmac_f32_16x16x64_bf16 v[98:101], v[16:19], a[240:247], v113
 v_mfma_f32_16x16x32_bf16 v[52:55], v[60:63], v[114:117], 0
 v_smfmac_f32_16x16x64_bf16 v[98:101], v[20:23], a[248:255], v113
 s_waitcnt lgkmcnt(0)
 v_smfmac_f32_16x16x64_bf16 v[98:101], v[24:27], v[120:127], v113
 v_cvt_pk_bf16_f32 v62, v48, v49
 v_smfmac_f32_16x16x64_bf16 v[98:101], v[28:31], v[128:135], v113
 v_cvt_pk_bf16_f32 v63, v50, v51
 v_smfmac_f32_16x16x64_bf16 v[98:101], v[32:35], v[136:143], v113
 v_cvt_pk_bf16_f32 v64, v52, v53
 v_smfmac_f32_16x16x64_bf16 v[102:105], v[16:19], v[160:167], v113
 v_cvt_pk_bf16_f32 v65, v54, v55
 v_smfmac_f32_16x16x64_bf16 v[102:105], v[20:23], v[168:175], v113
 v_cvt_pk_bf16_f32 v56, v98, v99
 v_mfma_f32_16x16x32_bf16 v[86:89], v[68:71], v[62:65], v[86:89]
 v_cvt_pk_bf16_f32 v57, v100, v101
 v_mfma_f32_16x16x32_bf16 v[90:93], v[72:75], v[62:65], v[90:93]
 ds_read_b128 v[68:71], v106 offset:4096
 v_mfma_f32_16x16x32_bf16 v[94:97], v[76:79], v[62:65], v[94:97]
 ds_read_b128 v[72:75], v106 offset:5120
 v_mfma_f32_16x16x32_bf16 v[98:101], v[56:59], v[114:117], 0
 ds_read_b128 v[76:79], v3 offset:1024
 v_smfmac_f32_16x16x64_bf16 v[102:105], v[24:27], v[176:183], v113
 v_smfmac_f32_16x16x64_bf16 v[102:105], v[28:31], v[184:191], v113
 v_cvt_pk_bf16_f32 v62, v98, v99
 v_smfmac_f32_16x16x64_bf16 v[102:105], v[32:35], v[192:199], v113
 v_cvt_pk_bf16_f32 v63, v100, v101
 s_nop 6
 v_cvt_pk_bf16_f32 v60, v102, v103
 v_cvt_pk_bf16_f32 v61, v104, v105
 s_nop 1
 v_mfma_f32_16x16x32_bf16 v[102:105], v[60:63], v[114:117], 0
 s_waitcnt lgkmcnt(0)
 s_nop 6
 v_cvt_pk_bf16_f32 v64, v102, v103
 v_cvt_pk_bf16_f32 v65, v104, v105
 s_nop 1
 v_mfma_f32_16x16x32_bf16 v[86:89], v[68:71], v[62:65], v[86:89]
 v_mfma_f32_16x16x32_bf16 v[90:93], v[72:75], v[62:65], v[90:93]
 v_mfma_f32_16x16x32_bf16 v[94:97], v[76:79], v[62:65], v[94:97]
 s_mov_b64 exec, s[46:47]
 ds_write_b128 v108, v[86:89] offset:0
 s_nop 1
 ds_write_b128 v108, v[90:93] offset:1024
 s_nop 2
 ds_write_b128 v108, v[94:97] offset:2048
 s_mov_b64 exec, -1
 s_waitcnt lgkmcnt(0)
 s_barrier
 s_cmp_lg_u32 s16, 0
 s_cbranch_scc1 AL_SKIP
 ds_read_b128 v[36:39], v109 offset:0
 ds_read_b128 v[40:43], v109 offset:3072
 ds_read2st64_b32 v[52:53], v110 offset0:0 offset1:12
 ds_read_b128 v[44:47], v109 offset:6144
 ds_read_b128 v[48:51], v109 offset:9216
 ds_read2st64_b32 v[54:55], v110 offset0:24 offset1:36
 s_waitcnt lgkmcnt(4)
 v_pk_add_f32 v[36:37], v[36:37], v[40:41]
 v_pk_add_f32 v[38:39], v[38:39], v[42:43]
 s_waitcnt lgkmcnt(0)
 v_pk_add_f32 v[44:45], v[44:45], v[48:49]
 v_pk_add_f32 v[46:47], v[46:47], v[50:51]
 v_pk_add_f32 v[52:53], v[52:53], v[54:55]
 v_pk_add_f32 v[36:37], v[36:37], v[44:45]
 v_pk_add_f32 v[38:39], v[38:39], v[46:47]
 v_add_f32 v40, v52, v53
 v_max3_f32 v41, v36, v37, v38
 v_max3_f32 v41, v41, v39, v40
 s_nop 1
 v_max_f32_dpp v41, v41, v41 quad_perm:[1,0,3,2] row_mask:0xf bank_mask:0xf
 v_mov_b32 v42, v41
 s_nop 1
 v_permlane16_swap_b32 v41, v42
 v_max_f32 v41, v41, v42
 v_mov_b32 v42, v41
 s_nop 1
 v_permlane32_swap_b32 v41, v42
 v_max_f32 v41, v41, v42
 v_mul_f32 v41, s43, v41
 v_fma_f32 v36, v36, s43, -v41
 v_fma_f32 v37, v37, s43, -v41
 v_exp_f32 v36, v36
 v_fma_f32 v38, v38, s43, -v41
 v_exp_f32 v37, v37
 v_fma_f32 v39, v39, s43, -v41
 v_exp_f32 v38, v38
 v_fma_f32 v40, v40, s43, -v41
 v_exp_f32 v39, v39
 v_add_f32 v41, v36, v37
 v_exp_f32 v40, v40
 v_add_f32 v41, v41, v38
 v_add_f32 v42, v39, v40
 v_add_f32 v41, v41, v42
 s_nop 1
 v_add_f32_dpp v41, v41, v41 quad_perm:[1,0,3,2] row_mask:0xf bank_mask:0xf
 v_mov_b32 v42, v41
 s_nop 1
 v_permlane16_swap_b32 v41, v42
 v_add_f32 v41, v41, v42
 v_mov_b32 v42, v41
 s_nop 1
 v_permlane32_swap_b32 v41, v42
 v_add_f32 v41, v41, v42
 v_rcp_f32 v41, v41
 s_nop 0
 v_pk_mul_f32 v[36:37], v[36:37], v[40:41] op_sel:[0,1] op_sel_hi:[1,1]
 v_pk_mul_f32 v[38:39], v[38:39], v[40:41] op_sel:[0,1] op_sel_hi:[1,1]
 v_mul_f32 v40, v40, v41
 v_cvt_pk_bf16_f32 v42, |v36|, |v37|
 v_cvt_pk_bf16_f32 v43, |v38|, |v39|
 v_cvt_pk_bf16_f32 v44, |v40|, |v40|
 s_cmp_eq_u32 s40, 0
 s_cbranch_scc1 AL_SLOW
 global_store_dwordx2 v111, v[42:43], s[32:33]
 global_store_short v112, v44, s[32:33]
 s_branch AL_SKIP
AL_SLOW:
 global_store_dwordx2 v111, v[42:43], s[32:33] sc1
 global_store_short v112, v44, s[32:33] sc1
AL_SKIP:
 s_add_u32 m0, s42, 0
 s_nop 0
 global_load_lds_dwordx4 v5, s[34:35] offset:0
 global_load_lds_dwordx4 v5, s[34:35] offset:1024
 global_load_lds_dwordx4 v5, s[34:35] offset:2048
 global_load_lds_dwordx4 v5, s[34:35] offset:3072
 s_add_u32 m0, s42, 4096
 s_nop 0
 global_load_lds_dwordx4 v6, s[34:35] offset:0
 global_load_lds_dwordx4 v6, s[34:35] offset:1024
 global_load_lds_dwordx4 v6, s[34:35] offset:2048
 s_add_u32 s34, s34, 28672
 s_addc_u32 s35, s35, 0
 s_xor_b32 s42, s42, 0x18000
 s_mov_b32 m0, 0x7000
 v_mov_b64 v[36:37], 0
 v_mov_b64 v[38:39], 0
 v_mov_b64 v[40:41], 0
 v_mov_b64 v[42:43], 0
 v_mov_b64 v[44:45], 0
 v_mov_b64 v[46:47], 0
 v_mov_b64 v[48:49], 0
 v_mov_b64 v[50:51], 0
 v_mov_b64 v[52:53], 0
 v_mov_b64 v[54:55], 0
 v_mov_b64 v[98:99], 0
 v_mov_b64 v[100:101], 0
 v_mov_b64 v[102:103], 0
 v_mov_b64 v[104:105], 0
 v_xor_b32 v106, 0x18000, v106
 v_xor_b32 v107, 0x18000, v107
 s_cmp_eq_u32 s16, 0
 s_cbranch_scc1 AL_S0
 s_sleep 8
AL_S0:
 s_sleep 9
 s_add_u32 s30, s30, 7168
 s_addc_u32 s31, s31, 0
 s_add_u32 s32, s32, 10240
 s_addc_u32 s33, s33, 0
 s_add_u32 s45, s45, 1
 s_cmp_lt_u32 s45, 63
 s_cbranch_scc1 AL_LOOP
AL_EXIT:
 s_waitcnt vmcnt(0)
 s_endpgm
BETA:
 s_sub_u32 s17, s17, 16
 s_mul_i32 s20, s17, 458752
 s_mul_i32 s21, s16, 114688
 s_add_u32 s20, s20, s21
 s_add_u32 s20, s20, 6422528
 s_add_u32 s36, s4, s20
 s_addc_u32 s37, s5, 0
 v_and_b32 v118, 63, v0
 v_lshlrev_b32 v118, 4, v118
 s_lshl_b32 s42, s16, 14
 s_add_u32 s42, s42, 0x18000
 v_add_u32 v119, 0, v118
 global_load_dwordx4 a[0:3], v119, s[36:37] offset:0
 global_load_dwordx4 a[4:7], v119, s[36:37] offset:1024
 global_load_dwordx4 a[8:11], v119, s[36:37] offset:2048
 global_load_dwordx4 a[12:15], v119, s[36:37] offset:3072
 v_add_u32 v119, 4096, v119
 global_load_dwordx4 a[16:19], v119, s[36:37] offset:0
 global_load_dwordx4 a[20:23], v119, s[36:37] offset:1024
 global_load_dwordx4 a[24:27], v119, s[36:37] offset:2048
 global_load_dwordx4 a[28:31], v119, s[36:37] offset:3072
 v_add_u32 v119, 4096, v119
 global_load_dwordx4 a[32:35], v119, s[36:37] offset:0
 global_load_dwordx4 a[36:39], v119, s[36:37] offset:1024
 global_load_dwordx4 a[40:43], v119, s[36:37] offset:2048
 global_load_dwordx4 a[44:47], v119, s[36:37] offset:3072
 v_add_u32 v119, 4096, v119
 s_add_u32 m0, s42, 0
 s_nop 0
 global_load_lds_dwordx4 v119, s[36:37] offset:0
 global_load_lds_dwordx4 v119, s[36:37] offset:1024
 v_add_u32 v119, 14336, v118
 global_load_dwordx4 a[48:51], v119, s[36:37] offset:0
 global_load_dwordx4 a[52:55], v119, s[36:37] offset:1024
 global_load_dwordx4 a[56:59], v119, s[36:37] offset:2048
 global_load_dwordx4 a[60:63], v119, s[36:37] offset:3072
 v_add_u32 v119, 4096, v119
 global_load_dwordx4 a[64:67], v119, s[36:37] offset:0
 global_load_dwordx4 a[68:71], v119, s[36:37] offset:1024
 global_load_dwordx4 a[72:75], v119, s[36:37] offset:2048
 global_load_dwordx4 a[76:79], v119, s[36:37] offset:3072
 v_add_u32 v119, 4096, v119
 global_load_dwordx4 a[80:83], v119, s[36:37] offset:0
 global_load_dwordx4 a[84:87], v119, s[36:37] offset:1024
 global_load_dwordx4 a[88:91], v119, s[36:37] offset:2048
 global_load_dwordx4 a[92:95], v119, s[36:37] offset:3072
 v_add_u32 v119, 4096, v119
 s_add_u32 m0, s42, 2048
 s_nop 0
 global_load_lds_dwordx4 v119, s[36:37] offset:0
 global_load_lds_dwordx4 v119, s[36:37] offset:1024
 v_add_u32 v119, 28672, v118
 global_load_dwordx4 a[96:99], v119, s[36:37] offset:0
 global_load_dwordx4 a[100:103], v119, s[36:37] offset:1024
 global_load_dwordx4 a[104:107], v119, s[36:37] offset:2048
 global_load_dwordx4 a[108:111], v119, s[36:37] offset:3072
 v_add_u32 v119, 4096, v119
 global_load_dwordx4 a[112:115], v119, s[36:37] offset:0
 global_load_dwordx4 a[116:119], v119, s[36:37] offset:1024
 global_load_dwordx4 a[120:123], v119, s[36:37] offset:2048
 global_load_dwordx4 a[124:127], v119, s[36:37] offset:3072
 v_add_u32 v119, 4096, v119
 global_load_dwordx4 a[128:131], v119, s[36:37] offset:0
 global_load_dwordx4 a[132:135], v119, s[36:37] offset:1024
 global_load_dwordx4 a[136:139], v119, s[36:37] offset:2048
 global_load_dwordx4 a[140:143], v119, s[36:37] offset:3072
 v_add_u32 v119, 4096, v119
 s_add_u32 m0, s42, 4096
 s_nop 0
 global_load_lds_dwordx4 v119, s[36:37] offset:0
 global_load_lds_dwordx4 v119, s[36:37] offset:1024
 v_add_u32 v119, 43008, v118
 global_load_dwordx4 a[144:147], v119, s[36:37] offset:0
 global_load_dwordx4 a[148:151], v119, s[36:37] offset:1024
 global_load_dwordx4 a[152:155], v119, s[36:37] offset:2048
 global_load_dwordx4 a[156:159], v119, s[36:37] offset:3072
 v_add_u32 v119, 4096, v119
 global_load_dwordx4 a[160:163], v119, s[36:37] offset:0
 global_load_dwordx4 a[164:167], v119, s[36:37] offset:1024
 global_load_dwordx4 a[168:171], v119, s[36:37] offset:2048
 global_load_dwordx4 a[172:175], v119, s[36:37] offset:3072
 v_add_u32 v119, 4096, v119
 global_load_dwordx4 a[176:179], v119, s[36:37] offset:0
 global_load_dwordx4 a[180:183], v119, s[36:37] offset:1024
 global_load_dwordx4 a[184:187], v119, s[36:37] offset:2048
 global_load_dwordx4 a[188:191], v119, s[36:37] offset:3072
 v_add_u32 v119, 4096, v119
 s_add_u32 m0, s42, 6144
 s_nop 0
 global_load_lds_dwordx4 v119, s[36:37] offset:0
 global_load_lds_dwordx4 v119, s[36:37] offset:1024
 v_add_u32 v119, 57344, v118
 global_load_dwordx4 a[192:195], v119, s[36:37] offset:0
 global_load_dwordx4 a[196:199], v119, s[36:37] offset:1024
 global_load_dwordx4 a[200:203], v119, s[36:37] offset:2048
 global_load_dwordx4 a[204:207], v119, s[36:37] offset:3072
 v_add_u32 v119, 4096, v119
 global_load_dwordx4 a[208:211], v119, s[36:37] offset:0
 global_load_dwordx4 a[212:215], v119, s[36:37] offset:1024
 global_load_dwordx4 a[216:219], v119, s[36:37] offset:2048
 global_load_dwordx4 a[220:223], v119, s[36:37] offset:3072
 v_add_u32 v119, 4096, v119
 global_load_dwordx4 a[224:227], v119, s[36:37] offset:0
 global_load_dwordx4 a[228:231], v119, s[36:37] offset:1024
 global_load_dwordx4 a[232:235], v119, s[36:37] offset:2048
 global_load_dwordx4 a[236:239], v119, s[36:37] offset:3072
 v_add_u32 v119, 4096, v119
 s_add_u32 m0, s42, 8192
 s_nop 0
 global_load_lds_dwordx4 v119, s[36:37] offset:0
 global_load_lds_dwordx4 v119, s[36:37] offset:1024
 v_add_u32 v119, 71680, v118
 global_load_dwordx4 a[240:243], v119, s[36:37] offset:0
 global_load_dwordx4 a[244:247], v119, s[36:37] offset:1024
 global_load_dwordx4 a[248:251], v119, s[36:37] offset:2048
 global_load_dwordx4 a[252:255], v119, s[36:37] offset:3072
 v_add_u32 v119, 4096, v119
 global_load_dwordx4 v[128:131], v119, s[36:37] offset:0
 global_load_dwordx4 v[132:135], v119, s[36:37] offset:1024
 global_load_dwordx4 v[136:139], v119, s[36:37] offset:2048
 global_load_dwordx4 v[140:143], v119, s[36:37] offset:3072
 v_add_u32 v119, 4096, v119
 global_load_dwordx4 v[144:147], v119, s[36:37] offset:0
 global_load_dwordx4 v[148:151], v119, s[36:37] offset:1024
 global_load_dwordx4 v[152:155], v119, s[36:37] offset:2048
 global_load_dwordx4 v[156:159], v119, s[36:37] offset:3072
 v_add_u32 v119, 4096, v119
 s_add_u32 m0, s42, 10240
 s_nop 0
 global_load_lds_dwordx4 v119, s[36:37] offset:0
 global_load_lds_dwordx4 v119, s[36:37] offset:1024
 v_add_u32 v119, 86016, v118
 global_load_dwordx4 v[160:163], v119, s[36:37] offset:0
 global_load_dwordx4 v[164:167], v119, s[36:37] offset:1024
 global_load_dwordx4 v[168:171], v119, s[36:37] offset:2048
 global_load_dwordx4 v[172:175], v119, s[36:37] offset:3072
 v_add_u32 v119, 4096, v119
 global_load_dwordx4 v[176:179], v119, s[36:37] offset:0
 global_load_dwordx4 v[180:183], v119, s[36:37] offset:1024
 global_load_dwordx4 v[184:187], v119, s[36:37] offset:2048
 global_load_dwordx4 v[188:191], v119, s[36:37] offset:3072
 v_add_u32 v119, 4096, v119
 global_load_dwordx4 v[192:195], v119, s[36:37] offset:0
 global_load_dwordx4 v[196:199], v119, s[36:37] offset:1024
 global_load_dwordx4 v[200:203], v119, s[36:37] offset:2048
 global_load_dwordx4 v[204:207], v119, s[36:37] offset:3072
 v_add_u32 v119, 4096, v119
 s_add_u32 m0, s42, 12288
 s_nop 0
 global_load_lds_dwordx4 v119, s[36:37] offset:0
 global_load_lds_dwordx4 v119, s[36:37] offset:1024
 v_add_u32 v119, 100352, v118
 global_load_dwordx4 v[208:211], v119, s[36:37] offset:0
 global_load_dwordx4 v[212:215], v119, s[36:37] offset:1024
 global_load_dwordx4 v[216:219], v119, s[36:37] offset:2048
 global_load_dwordx4 v[220:223], v119, s[36:37] offset:3072
 v_add_u32 v119, 4096, v119
 global_load_dwordx4 v[224:227], v119, s[36:37] offset:0
 global_load_dwordx4 v[228:231], v119, s[36:37] offset:1024
 global_load_dwordx4 v[232:235], v119, s[36:37] offset:2048
 global_load_dwordx4 v[236:239], v119, s[36:37] offset:3072
 v_add_u32 v119, 4096, v119
 global_load_dwordx4 v[240:243], v119, s[36:37] offset:0
 global_load_dwordx4 v[244:247], v119, s[36:37] offset:1024
 global_load_dwordx4 v[248:251], v119, s[36:37] offset:2048
 global_load_dwordx4 v[252:255], v119, s[36:37] offset:3072
 v_add_u32 v119, 4096, v119
 s_add_u32 m0, s42, 14336
 s_nop 0
 global_load_lds_dwordx4 v119, s[36:37] offset:0
 global_load_lds_dwordx4 v119, s[36:37] offset:1024
 s_add_u32 s36, s4, 85590272
 s_addc_u32 s37, s5, 0
 v_and_b32 v98, 63, v0
 v_min_u32 v98, 31, v98
 v_lshlrev_b32 v98, 2, v98
 s_mov_b32 s41, 0
BE_TS:
 global_load_dword v99, v98, s[36:37] sc1
 s_add_u32 s41, s41, 1
 s_cmp_gt_u32 s41, 2000000
 s_cbranch_scc1 BE_EXIT
 s_waitcnt vmcnt(0)
 v_cmp_eq_u32 vcc, 0, v99
 s_cbranch_vccnz BE_TS
 s_add_u32 s41, s19, 1
 v_cmp_ne_u32 vcc, s41, v99
 s_mov_b32 s40, 1
 s_cbranch_vccz BE_TS2
 s_mov_b32 s40, 0
BE_TS2:
 v_and_b32 v118, 63, v0
 v_lshrrev_b32 v119, 4, v118
 v_and_b32 v117, 15, v118
 s_mul_i32 s20, s16, 112
 v_add_u32 v0, s20, v118
 v_add_u32 v1, 64, v0
 v_min_u32 v1, 447, v1
 v_lshlrev_b32 v0, 4, v0
 v_lshlrev_b32 v1, 4, v1
 v_lshlrev_b32 v2, 4, v118
 v_mov_b32 v113, 0x4444
 v_mov_b32 v116, 0xeeee
 v_cmp_gt_u32 vcc, 8, v117
 s_nop 1
 v_cndmask_b32 v113, v116, v113, vcc
 s_add_u32 s30, s4, 13762560
 s_addc_u32 s31, s5, 0
 s_add_u32 s32, s4, 14221312
 s_addc_u32 s33, s5, 0
 v_add_u32 v3, s42, v2
 s_lshl_b32 s42, s16, 13
 s_add_u32 s42, s42, 0x8000
 v_add_u32 v4, s42, v2
 s_lshl_b32 s20, s16, 13
 v_add_u32 v5, s20, v2
 v_add_u32 v6, 4096, v5
 s_lshl_b32 s20, s17, 15
 s_add_u32 s20, s20, 26411008
 s_add_u32 s34, s4, s20
 s_addc_u32 s35, s5, 0
 v_and_b32 v98, 1, v119
 v_lshrrev_b32 v99, 1, v119
 v_lshlrev_b32 v100, 5, v98
 v_lshl_add_u32 v100, v99, 4, v100
 v_add_u32 v100, v100, v117
 v_lshlrev_b32 v100, 4, v100
 s_lshl_b32 s20, s16, 11
 v_add_u32 v7, s20, v100
 s_lshl_b32 s20, s17, 13
 s_add_u32 s20, s20, 19070976
 s_add_u32 s46, s4, s20
 s_addc_u32 s47, s5, 0
 s_lshl_b32 s20, s16, 10
 s_add_u32 s20, s20, 0x2000
 v_lshlrev_b32 v100, 2, v118
 v_add_u32 v120, s20, v100
 s_lshl_b32 s20, s16, 8
 s_add_u32 s20, s20, 0x2000
 v_and_b32 v100, 31, v118
 v_lshlrev_b32 v101, 3, v100
 v_add_u32 v121, s20, v101
 v_bfe_u32 v101, v118, 4, 1
 v_bfe_u32 v102, v118, 3, 1
 v_lshlrev_b32 v102, 2, v102
 v_add_u32 v102, s16, v102
 v_lshlrev_b32 v102, 4, v102
 v_lshl_add_u32 v102, v101, 8, v102
 s_lshl_b32 s20, s17, 9
 v_add_u32 v102, s20, v102
 v_bfe_u32 v103, v118, 2, 1
 v_lshl_add_u32 v104, v103, 7, v102
 v_and_b32 v105, 3, v118
 v_lshl_add_u32 v122, v105, 2, v104
 v_add_u32 v122, 7168, v122
 v_add_u32 v123, 7168, v122
 v_mov_b32 v126, -1
 s_add_u32 s48, s4, 85131264
 s_addc_u32 s49, s5, 0
 s_lshl_b32 s20, s16, 11
 v_add_u32 v124, s20, v2
 v_lshlrev_b32 v102, 8, v99
 v_lshl_add_u32 v102, v117, 4, v102
 s_lshl_b32 s20, s16, 9
 s_add_u32 s20, s20, 8192
 v_add_u32 v125, s20, v102
 s_mov_b32 s44, 0x80008000
 s_mov_b32 s45, 0
 v_min_u32 v112, 7, v118
 v_lshlrev_b32 v112, 8, v112
 v_add_u32 v112, 85607424, v112
 s_mov_b32 s41, 0
BE_V0:
 global_load_dword v115, v112, s[4:5] sc1
 s_add_u32 s41, s41, 1
 s_cmp_gt_u32 s41, 2000000
 s_cbranch_scc1 BE_EXIT
 s_waitcnt vmcnt(0)
 v_cmp_gt_u32 vcc, 224, v115
 s_mov_b32 s59, vcc_lo
 s_bitcmp1_b32 s59, 0
 s_cbranch_scc1 BE_V0
 s_add_u32 m0, s42, 0
 s_nop 0
 global_load_lds_dwordx4 v5, s[34:35] offset:0
 global_load_lds_dwordx4 v5, s[34:35] offset:1024
 global_load_lds_dwordx4 v5, s[34:35] offset:2048
 global_load_lds_dwordx4 v5, s[34:35] offset:3072
 s_add_u32 m0, s42, 4096
 s_nop 0
 global_load_lds_dwordx4 v6, s[34:35] offset:0
 global_load_lds_dwordx4 v6, s[34:35] offset:1024
 global_load_lds_dwordx4 v6, s[34:35] offset:2048
 global_load_lds_dwordx4 v6, s[34:35] offset:3072
 s_add_u32 s34, s34, 458752
 s_addc_u32 s35, s35, 0
 s_xor_b32 s42, s42, 0x18000
 v_mov_b32 v36, 0
 v_mov_b32 v37, 0
 v_mov_b32 v38, 0
 v_mov_b32 v39, 0
 v_mov_b32 v40, 0
 v_mov_b32 v41, 0
 v_mov_b32 v42, 0
 v_mov_b32 v43, 0
 v_mov_b32 v44, 0
 v_mov_b32 v45, 0
 v_mov_b32 v46, 0
 v_mov_b32 v47, 0
 v_mov_b32 v48, 0
 v_mov_b32 v49, 0
 v_mov_b32 v50, 0
 v_mov_b32 v51, 0
 v_mov_b32 v84, 0
 v_mov_b32 v85, 0
 v_mov_b32 v86, 0
 v_mov_b32 v87, 0
 v_mov_b32 v88, 0
 v_mov_b32 v89, 0
 v_mov_b32 v90, 0
 v_mov_b32 v91, 0
 v_mov_b32 v104, 0
 v_mov_b32 v105, 0
 v_mov_b32 v106, 0
 v_mov_b32 v107, 0
 v_mov_b32 v108, 0
 v_mov_b32 v109, 0
 v_mov_b32 v110, 0
 v_mov_b32 v111, 0
BE_LOOP:
 s_cmp_ge_u32 s45, 61
 s_cselect_b32 s58, 0, 458752
 s_mov_b32 s41, 0
BE_PM:
 global_load_dwordx4 v[92:95], v0, s[30:31] sc1
 global_load_dwordx4 v[96:99], v1, s[30:31] sc1
 s_add_u32 s41, s41, 1
 s_cmp_gt_u32 s41, 2000000
 s_cbranch_scc1 BE_EXIT
 s_waitcnt vmcnt(0)
 v_max3_u32 v116, v92, v93, v94
 v_max3_u32 v117, v95, v96, v97
 v_max3_u32 v116, v116, v98, v99
 v_max_u32 v116, v116, v117
 v_cmp_eq_u32 vcc, -1, v116
 s_cbranch_vccnz BE_PM
 ds_write_b128 v0, v[92:95]
 ds_write_b128 v1, v[96:99]
 s_waitcnt lgkmcnt(0)
 s_barrier
 ds_read_b128 v[8:11], v2 offset:0
 ds_read_b128 v[12:15], v2 offset:1024
 ds_read_b128 v[16:19], v2 offset:2048
 ds_read_b128 v[20:23], v2 offset:3072
 ds_read_b128 v[24:27], v2 offset:4096
 ds_read_b128 v[28:31], v2 offset:5120
 ds_read_b128 v[32:35], v2 offset:6144
 s_cmp_eq_u32 s59, 0
 s_cbranch_scc1 BE_V1
 global_load_dword v115, v112, s[4:5] sc1
BE_V1:
 s_cmp_ge_u32 s45, 61
 s_cselect_b32 s58, 0, 458752
 s_mov_b32 m0, s42
 ds_read_b128 v[52:55], v3 offset:0
 ds_read_b128 v[56:59], v3 offset:1024
 ds_read_b128 v[60:63], v3 offset:2048
 ds_read_b128 v[64:67], v3 offset:3072
 s_waitcnt lgkmcnt(10)
 v_smfmac_f32_16x16x64_bf16 v[36:39], v[8:11], a[0:7], v113
 global_load_lds_dwordx4 v5, s[34:35] offset:0
 v_smfmac_f32_16x16x64_bf16 v[40:43], v[8:11], a[48:55], v113
 s_waitcnt lgkmcnt(9)
 v_smfmac_f32_16x16x64_bf16 v[36:39], v[12:15], a[8:15], v113
 global_load_lds_dwordx4 v5, s[34:35] offset:1024
 v_smfmac_f32_16x16x64_bf16 v[40:43], v[12:15], a[56:63], v113
 s_waitcnt lgkmcnt(8)
 v_smfmac_f32_16x16x64_bf16 v[36:39], v[16:19], a[16:23], v113
 global_load_lds_dwordx4 v5, s[34:35] offset:2048
 v_smfmac_f32_16x16x64_bf16 v[40:43], v[16:19], a[64:71], v113
 s_waitcnt lgkmcnt(7)
 v_smfmac_f32_16x16x64_bf16 v[36:39], v[20:23], a[24:31], v113
 global_load_lds_dwordx4 v5, s[34:35] offset:3072
 v_smfmac_f32_16x16x64_bf16 v[40:43], v[20:23], a[72:79], v113
 s_waitcnt lgkmcnt(6)
 v_smfmac_f32_16x16x64_bf16 v[36:39], v[24:27], a[32:39], v113
 s_add_u32 m0, s42, 4096
 v_smfmac_f32_16x16x64_bf16 v[40:43], v[24:27], a[80:87], v113
 s_waitcnt lgkmcnt(5)
 v_smfmac_f32_16x16x64_bf16 v[36:39], v[28:31], a[40:47], v113
 global_load_lds_dwordx4 v6, s[34:35] offset:0
 v_smfmac_f32_16x16x64_bf16 v[40:43], v[28:31], a[88:95], v113
 s_waitcnt lgkmcnt(0)
 v_smfmac_f32_16x16x64_bf16 v[36:39], v[32:35], v[52:59], v113
 global_load_lds_dwordx4 v6, s[34:35] offset:1024
 v_smfmac_f32_16x16x64_bf16 v[40:43], v[32:35], v[60:67], v113
 global_load_lds_dwordx4 v6, s[34:35] offset:2048
 v_smfmac_f32_16x16x64_bf16 v[44:47], v[8:11], a[96:103], v113
 ds_read_b128 v[52:55], v3 offset:4096
 v_smfmac_f32_16x16x64_bf16 v[48:51], v[8:11], a[144:151], v113
 ds_read_b128 v[56:59], v3 offset:5120
 v_smfmac_f32_16x16x64_bf16 v[44:47], v[12:15], a[104:111], v113
 ds_read_b128 v[60:63], v3 offset:6144
 v_smfmac_f32_16x16x64_bf16 v[48:51], v[12:15], a[152:159], v113
 ds_read_b128 v[64:67], v3 offset:7168
 v_smfmac_f32_16x16x64_bf16 v[44:47], v[16:19], a[112:119], v113
 v_cvt_pk_bf16_f32 v68, v36, v37
 v_smfmac_f32_16x16x64_bf16 v[48:51], v[16:19], a[160:167], v113
 v_cvt_pk_bf16_f32 v69, v38, v39
 v_smfmac_f32_16x16x64_bf16 v[44:47], v[20:23], a[120:127], v113
 v_cvt_pk_bf16_f32 v76, v40, v41
 v_smfmac_f32_16x16x64_bf16 v[48:51], v[20:23], a[168:175], v113
 v_cvt_pk_bf16_f32 v77, v42, v43
 v_smfmac_f32_16x16x64_bf16 v[44:47], v[24:27], a[128:135], v113
 global_load_lds_dwordx4 v6, s[34:35] offset:3072
 v_smfmac_f32_16x16x64_bf16 v[48:51], v[24:27], a[176:183], v113
 s_add_u32 s34, s34, s58
 v_smfmac_f32_16x16x64_bf16 v[44:47], v[28:31], a[136:143], v113
 s_addc_u32 s35, s35, 0
 v_smfmac_f32_16x16x64_bf16 v[48:51], v[28:31], a[184:191], v113
 s_waitcnt lgkmcnt(0)
 v_smfmac_f32_16x16x64_bf16 v[44:47], v[32:35], v[52:59], v113
 s_xor_b32 s42, s42, 0x18000
 v_smfmac_f32_16x16x64_bf16 v[48:51], v[32:35], v[60:67], v113
 v_smfmac_f32_16x16x64_bf16 v[84:87], v[8:11], a[192:199], v113
 ds_read_b128 v[52:55], v3 offset:8192
 v_smfmac_f32_16x16x64_bf16 v[88:91], v[8:11], a[240:247], v113
 ds_read_b128 v[56:59], v3 offset:9216
 v_smfmac_f32_16x16x64_bf16 v[84:87], v[12:15], a[200:207], v113
 ds_read_b128 v[60:63], v3 offset:10240
 v_smfmac_f32_16x16x64_bf16 v[88:91], v[12:15], a[248:255], v113
 ds_read_b128 v[64:67], v3 offset:11264
 v_smfmac_f32_16x16x64_bf16 v[84:87], v[16:19], a[208:215], v113
 v_cvt_pk_bf16_f32 v70, v44, v45
 v_smfmac_f32_16x16x64_bf16 v[88:91], v[16:19], v[128:135], v113
 v_cvt_pk_bf16_f32 v71, v46, v47
 v_smfmac_f32_16x16x64_bf16 v[84:87], v[20:23], a[216:223], v113
 v_cvt_pk_bf16_f32 v78, v48, v49
 v_smfmac_f32_16x16x64_bf16 v[88:91], v[20:23], v[136:143], v113
 v_cvt_pk_bf16_f32 v79, v50, v51
 v_smfmac_f32_16x16x64_bf16 v[84:87], v[24:27], a[224:231], v113
 v_smfmac_f32_16x16x64_bf16 v[88:91], v[24:27], v[144:151], v113
 v_smfmac_f32_16x16x64_bf16 v[84:87], v[28:31], a[232:239], v113
 v_smfmac_f32_16x16x64_bf16 v[88:91], v[28:31], v[152:159], v113
 s_waitcnt lgkmcnt(0)
 v_smfmac_f32_16x16x64_bf16 v[84:87], v[32:35], v[52:59], v113
 v_smfmac_f32_16x16x64_bf16 v[88:91], v[32:35], v[60:67], v113
 v_smfmac_f32_16x16x64_bf16 v[104:107], v[8:11], v[160:167], v113
 ds_read_b128 v[52:55], v3 offset:12288
 v_smfmac_f32_16x16x64_bf16 v[108:111], v[8:11], v[208:215], v113
 ds_read_b128 v[56:59], v3 offset:13312
 v_smfmac_f32_16x16x64_bf16 v[104:107], v[12:15], v[168:175], v113
 ds_read_b128 v[60:63], v3 offset:14336
 v_smfmac_f32_16x16x64_bf16 v[108:111], v[12:15], v[216:223], v113
 ds_read_b128 v[64:67], v3 offset:15360
 v_smfmac_f32_16x16x64_bf16 v[104:107], v[16:19], v[176:183], v113
 v_cvt_pk_bf16_f32 v72, v84, v85
 v_smfmac_f32_16x16x64_bf16 v[108:111], v[16:19], v[224:231], v113
 v_cvt_pk_bf16_f32 v73, v86, v87
 v_smfmac_f32_16x16x64_bf16 v[104:107], v[20:23], v[184:191], v113
 v_cvt_pk_bf16_f32 v80, v88, v89
 v_smfmac_f32_16x16x64_bf16 v[108:111], v[20:23], v[232:239], v113
 v_cvt_pk_bf16_f32 v81, v90, v91
 v_smfmac_f32_16x16x64_bf16 v[104:107], v[24:27], v[192:199], v113
 v_smfmac_f32_16x16x64_bf16 v[108:111], v[24:27], v[240:247], v113
 v_smfmac_f32_16x16x64_bf16 v[104:107], v[28:31], v[200:207], v113
 v_smfmac_f32_16x16x64_bf16 v[108:111], v[28:31], v[248:255], v113
 s_waitcnt lgkmcnt(0)
 v_smfmac_f32_16x16x64_bf16 v[104:107], v[32:35], v[52:59], v113
 ds_read_b128 v[8:11], v4 offset:0
 v_smfmac_f32_16x16x64_bf16 v[108:111], v[32:35], v[60:67], v113
 s_mov_b32 s41, 0
 global_load_dwordx4 v[92:95], v124, s[32:33] sc1
 global_load_dwordx4 v[96:99], v124, s[32:33] offset:1024 sc1
 global_load_dwordx4 v[100:103], v125, s[32:33] sc1
 ds_read_b128 v[12:15], v4 offset:2048
 ds_read_b128 v[16:19], v4 offset:1024
 ds_read_b128 v[20:23], v4 offset:3072
 ds_read_b128 v[24:27], v4 offset:4096
 ds_read_b128 v[28:31], v4 offset:6144
 ds_read_b128 v[32:35], v4 offset:5120
 ds_read_b128 v[36:39], v4 offset:7168
 v_cvt_pk_bf16_f32 v74, v104, v105
 v_cvt_pk_bf16_f32 v75, v106, v107
 v_cvt_pk_bf16_f32 v82, v108, v109
 v_cvt_pk_bf16_f32 v83, v110, v111
 v_mov_b64 v[104:105], 0
 v_mov_b64 v[106:107], 0
 v_mov_b64 v[108:109], 0
 v_mov_b64 v[110:111], 0
 v_xor_b32 v4, 0x18000, v4
 s_branch BE_PQ
BE_PP:
 global_load_dwordx4 v[92:95], v124, s[32:33] sc1
 global_load_dwordx4 v[96:99], v124, s[32:33] offset:1024 sc1
 global_load_dwordx4 v[100:103], v125, s[32:33] sc1
BE_PQ:
 s_add_u32 s41, s41, 1
 s_cmp_gt_u32 s41, 2000000
 s_cbranch_scc1 BE_EXIT
 s_waitcnt vmcnt(0) lgkmcnt(0)
 v_or3_b32 v116, v92, v93, v94
 v_or3_b32 v117, v95, v96, v97
 v_or3_b32 v116, v116, v98, v99
 v_or3_b32 v117, v117, v100, v101
 v_or3_b32 v116, v116, v102, v103
 v_or_b32 v116, v116, v117
 v_and_b32 v116, s44, v116
 v_cmp_ne_u32 vcc, 0, v116
 s_cbranch_vccnz BE_PP
 v_smfmac_f32_16x16x64_bf16 v[104:107], v[92:95], v[8:15], v113
 v_smfmac_f32_16x16x64_bf16 v[108:111], v[92:95], v[16:23], v113
 v_smfmac_f32_16x16x64_bf16 v[104:107], v[96:99], v[24:31], v113
 v_smfmac_f32_16x16x64_bf16 v[108:111], v[96:99], v[32:39], v113
 v_smfmac_f32_16x16x64_bf16 v[104:107], v[100:103], v[68:75], v113
 v_smfmac_f32_16x16x64_bf16 v[108:111], v[100:103], v[76:83], v113
 s_nop 7
 v_permlane32_swap_b32 v104, v108
 v_permlane32_swap_b32 v105, v109
 v_permlane32_swap_b32 v106, v110
 v_permlane32_swap_b32 v107, v111
 v_pk_add_f32 v[104:105], v[104:105], v[108:109]
 v_pk_add_f32 v[106:107], v[106:107], v[110:111]
 ds_write2st64_b32 v120, v104, v105 offset0:0 offset1:1
 ds_write2st64_b32 v120, v106, v107 offset0:2 offset1:3
 s_waitcnt lgkmcnt(0)
 s_barrier
 ds_read2st64_b64 v[8:11], v121 offset0:0 offset1:2
 ds_read2st64_b64 v[12:15], v121 offset0:4 offset1:6
 s_mov_b32 exec_hi, 0
 s_waitcnt lgkmcnt(1)
 v_pk_add_f32 v[8:9], v[8:9], v[10:11]
 s_waitcnt lgkmcnt(0)
 v_pk_add_f32 v[12:13], v[12:13], v[14:15]
 v_pk_add_f32 v[8:9], v[8:9], v[12:13]
 v_cvt_pk_bf16_f32 v8, v8, v9
 v_min_u32 v8, -2, v8
 s_cmp_eq_u32 s40, 0
 s_cbranch_scc1 BE_SLOW
 global_store_dword v122, v8, s[30:31]
 s_branch BE_PUB
BE_SLOW:
 global_store_dword v122, v8, s[30:31] sc1
BE_PUB:
 s_mov_b32 exec_hi, -1
 v_mov_b64 v[36:37], 0
 v_mov_b64 v[38:39], 0
 v_mov_b64 v[40:41], 0
 v_mov_b64 v[42:43], 0
 v_mov_b64 v[44:45], 0
 v_mov_b64 v[46:47], 0
 v_mov_b64 v[48:49], 0
 v_mov_b64 v[50:51], 0
 v_mov_b64 v[84:85], 0
 v_mov_b64 v[86:87], 0
 v_mov_b64 v[88:89], 0
 v_mov_b64 v[90:91], 0
 v_mov_b64 v[104:105], 0
 v_mov_b64 v[106:107], 0
 v_mov_b64 v[108:109], 0
 v_mov_b64 v[110:111], 0
 s_cmp_eq_u32 s59, 0
 s_cbranch_scc1 BE_V3
 s_add_u32 s20, s45, 2
 s_lshr_b32 s20, s20, 3
 s_mov_b32 s41, 0
BE_V2:
 v_cmp_gt_u32 vcc, 224, v115
 s_mov_b32 s59, vcc_lo
 s_bitcmp0_b32 s59, s20
 s_cbranch_scc1 BE_V3
 global_load_dword v115, v112, s[4:5] sc1
 s_add_u32 s41, s41, 1
 s_cmp_gt_u32 s41, 2000000
 s_cbranch_scc1 BE_EXIT
 s_waitcnt vmcnt(0)
 s_branch BE_V2
BE_V3:
 s_add_u32 s30, s30, 7168
 s_addc_u32 s31, s31, 0
 s_add_u32 s32, s32, 10240
 s_addc_u32 s33, s33, 0
 s_add_u32 s45, s45, 1
 s_cmp_lt_u32 s45, 63
 s_cbranch_scc1 BE_LOOP
 s_lshl_b32 s20, s17, 4
 s_lshl_b32 s21, s16, 2
 s_add_u32 s20, s20, s21
 s_add_u32 s20, s20, 85638400
 v_mov_b32 v114, s20
 s_add_u32 s46, s46, 7225344
 s_addc_u32 s47, s47, 0
 s_branch GA_LOOP
BE_EXIT:
 s_waitcnt vmcnt(0)
 s_endpgm
ETA:
 s_add_u32 s36, s4, 85590272
 s_addc_u32 s37, s5, 0
 v_and_b32 v98, 63, v0
 v_min_u32 v98, 31, v98
 v_lshlrev_b32 v98, 2, v98
 s_mov_b32 s41, 0
ET_TS:
 global_load_dword v99, v98, s[36:37] sc1
 s_add_u32 s41, s41, 1
 s_cmp_gt_u32 s41, 2000000
 s_cbranch_scc1 ET_EXIT
 s_waitcnt vmcnt(0)
 v_cmp_eq_u32 vcc, 0, v99
 s_cbranch_vccnz ET_TS
 s_add_u32 s41, s19, 1
 v_cmp_ne_u32 vcc, s41, v99
 s_mov_b32 s40, 1
 s_cbranch_vccz ET_TS2
 s_mov_b32 s40, 0
ET_TS2:
 s_sub_u32 s17, s17, 30
 s_lshl_b32 s17, s17, 2
 s_add_u32 s17, s17, s16
 v_and_b32 v2, 63, v0
 s_cmp_lg_u32 s17, 0
 s_cbranch_scc1 ET_PF
 v_lshlrev_b32 v3, 4, v2
 v_add_u32 v4, 4096, v3
 s_add_u32 s30, s4, 13769728
 s_addc_u32 s31, s5, 0
 s_add_u32 s32, s4, 85138432
 s_addc_u32 s33, s5, 0
 s_mov_b32 s45, 1
ET_CL:
 s_mov_b32 s41, 0
ET_CP:
 global_load_dwordx4 v[8:11], v3, s[30:31] offset:0 sc1
 global_load_dwordx4 v[12:15], v3, s[30:31] offset:1024 sc1
 global_load_dwordx4 v[16:19], v3, s[30:31] offset:2048 sc1
 global_load_dwordx4 v[20:23], v3, s[30:31] offset:3072 sc1
 global_load_dwordx4 v[24:27], v4, s[30:31] offset:0 sc1
 global_load_dwordx4 v[28:31], v4, s[30:31] offset:1024 sc1
 global_load_dwordx4 v[32:35], v4, s[30:31] offset:2048 sc1
 s_add_u32 s41, s41, 1
 s_cmp_gt_u32 s41, 2000000
 s_cbranch_scc1 ET_EXIT
 s_waitcnt vmcnt(0)
 v_max_u32 v5, v8, v9
 v_max3_u32 v5, v5, v10, v11
 v_max3_u32 v5, v5, v12, v13
 v_max3_u32 v5, v5, v14, v15
 v_max3_u32 v5, v5, v16, v17
 v_max3_u32 v5, v5, v18, v19
 v_max3_u32 v5, v5, v20, v21
 v_max3_u32 v5, v5, v22, v23
 v_max3_u32 v5, v5, v24, v25
 v_max3_u32 v5, v5, v26, v27
 v_max3_u32 v5, v5, v28, v29
 v_max3_u32 v5, v5, v30, v31
 v_max3_u32 v5, v5, v32, v33
 v_max3_u32 v5, v5, v34, v35
 v_cmp_eq_u32 vcc, -1, v5
 s_cbranch_vccz ET_CS
 s_sleep 1
 s_branch ET_CP
ET_CS:
 global_store_dwordx4 v3, v[8:11], s[32:33] offset:0 sc1
 global_store_dwordx4 v3, v[12:15], s[32:33] offset:1024 sc1
 global_store_dwordx4 v3, v[16:19], s[32:33] offset:2048 sc1
 global_store_dwordx4 v3, v[20:23], s[32:33] offset:3072 sc1
 global_store_dwordx4 v4, v[24:27], s[32:33] offset:0 sc1
 global_store_dwordx4 v4, v[28:31], s[32:33] offset:1024 sc1
 global_store_dwordx4 v4, v[32:35], s[32:33] offset:2048 sc1
 s_add_u32 s30, s30, 7168
 s_addc_u32 s31, s31, 0
 s_add_u32 s32, s32, 7168
 s_addc_u32 s33, s33, 0
 s_add_u32 s45, s45, 1
 s_cmp_lt_u32 s45, 63
 s_cbranch_scc0 ET_C2
 s_sleep 20
ET_C2:
 s_cmp_lt_u32 s45, 64
 s_cbranch_scc1 ET_CL
 s_branch ET_EXIT
ET_PF:
 s_sub_u32 s17, s17, 1
 s_lshl_b32 s20, s17, 16
 s_add_u32 s20, s20, 26411008
 s_add_u32 s30, s4, s20
 s_addc_u32 s31, s5, 0
 s_lshl_b32 s20, s17, 12
 s_add_u32 s20, s20, 87490560
 s_add_u32 s32, s4, s20
 s_addc_u32 s33, s5, 0
 v_mul_u32_u24 v3, 128, v2
 v_lshlrev_b32 v4, 6, v2
 s_mov_b32 s45, 0
ET_PL:
 s_and_b32 s20, s45, 7
 s_cmp_lg_u32 s20, 0
 s_cbranch_scc1 ET_P1
 s_lshl_b32 s24, s45, 5
 s_add_u32 s24, s24, 85607424
 v_mov_b32 v10, s24
 s_mov_b32 s41, 0
EV_13:
 global_load_dword v12, v10, s[4:5] sc1
 s_add_u32 s41, s41, 1
 s_cmp_gt_u32 s41, 2000000
 s_cbranch_scc1 ET_EXIT
 s_waitcnt vmcnt(0)
 v_readfirstlane_b32 s42, v12
 s_cmp_ge_u32 s42, 224
 s_cbranch_scc1 EV_13_D
 s_sleep 4
 s_branch EV_13
EV_13_D:
ET_P1:
 s_cmp_lt_u32 s45, 5
 s_cbranch_scc1 ET_P2
 s_sub_u32 s24, s45, 4
 s_mul_i32 s24, s24, 7168
 s_add_u32 s24, s24, 13762560
 v_mov_b32 v10, s24
 s_mov_b32 s41, 0
EM_14:
 global_load_dword v12, v10, s[4:5] sc1
 s_add_u32 s41, s41, 1
 s_cmp_gt_u32 s41, 2000000
 s_cbranch_scc1 ET_EXIT
 s_waitcnt vmcnt(0)
 v_readfirstlane_b32 s42, v12
 s_cmp_lg_u32 s42, -1
 s_cbranch_scc1 EM_14_D
 s_sleep 8
 s_branch EM_14
EM_14_D:
ET_P2:
 global_load_dword v31, v4, s[32:33]
 v_mov_b32 v5, v3
 s_add_u32 s30, s30, 458752
 s_addc_u32 s31, s31, 0
 s_add_u32 s32, s32, 28672
 s_addc_u32 s33, s33, 0
 s_add_u32 s45, s45, 1
 s_cmp_lt_u32 s45, 63
 s_cbranch_scc1 ET_PL
ET_EXIT:
 s_waitcnt vmcnt(0)
 s_endpgm
K2_END:
 s_endpgm
.section .rodata,"a"
.p2align 6
.amdhsa_kernel k1_kernel
  .amdhsa_next_free_vgpr 192
  .amdhsa_next_free_sgpr 102
  .amdhsa_accum_offset 192
  .amdhsa_group_segment_fixed_size 0
  .amdhsa_kernarg_size 104
  .amdhsa_user_sgpr_count 2
  .amdhsa_user_sgpr_kernarg_segment_ptr 1
  .amdhsa_system_sgpr_workgroup_id_x 1
.end_amdhsa_kernel
.p2align 6
.amdhsa_kernel k2_kernel
  .amdhsa_next_free_vgpr 512
  .amdhsa_next_free_sgpr 102
  .amdhsa_accum_offset 256
  .amdhsa_group_segment_fixed_size 0
  .amdhsa_kernarg_size 104
  .amdhsa_user_sgpr_count 2
  .amdhsa_user_sgpr_kernarg_segment_ptr 1
  .amdhsa_system_sgpr_workgroup_id_x 1
.end_amdhsa_kernel
```
